```python
import torch

def _softmax(x, axis=-1):
    return torch.softmax(x, dim=axis)
def _gelu(x):
    return torch.nn.functional.gelu(x, approximate="tanh")
def _silu(x):
    return torch.nn.functional.silu(x)
def _sigmoid(x):
    return torch.sigmoid(x)
def _layernorm(x, axis=-1, eps=1e-5):
    m = x.mean(dim=axis, keepdim=True)
    v = x.var(dim=axis, keepdim=True, unbiased=False)
    return (x - m) / torch.sqrt(v + eps)
def _scatter_add(tgt, idx, src, axis=0):
    return tgt.clone().index_add_(axis, idx, src)
def _segment_sum(src, seg, n):
    out = torch.zeros((n,) + src.shape[1:], dtype=src.dtype)
    return out.index_add_(0, seg, src)
def _pad(x, pw):
    flat = tuple(v for pair in reversed(pw) for v in pair)
    return torch.nn.functional.pad(x, flat)

kernel_name = 'concat_heads__sliding_block__softmax_full_mha__prompt'

def setup_inputs():

    _w = (lambda a: (lambda t: t.to(torch.bfloat16) if t.is_floating_point() else t)(torch.as_tensor(a)))
    def _A_setup():
        B, S, D = 1, 2048, 640
        return {
            "x": _w((lambda *s: torch.randn(*s, dtype=torch.bfloat16) * 0.4)(B, S, D)),
            "wqkv": _w((lambda *s: torch.randn(*s, dtype=torch.bfloat16) * 0.4)(D, 3 * D)),
            "wo": _w((lambda *s: torch.randn(*s, dtype=torch.bfloat16) * 0.05)(D, D)),
        }
    _A_in = _A_setup()

    def _B_setup():
        B, S, D = 1, 2048, 640
        return {
            "x": _w((lambda *s: torch.randn(*s, dtype=torch.bfloat16) * 0.2)(B, S, D)),
            "wqkv": _w((lambda *s: torch.randn(*s, dtype=torch.bfloat16) * 0.4)(D, 3 * D)),
            "wo": _w((lambda *s: torch.randn(*s, dtype=torch.bfloat16) * 0.1)(D, D)),
        }
    _B_in = _B_setup()

    return {
        "A_x": _A_in["x"],
        "A_wqkv": _A_in["wqkv"],
        "A_wo": _A_in["wo"],
        "B_x": _B_in["x"],
        "B_wqkv": _B_in["wqkv"],
        "B_wo": _B_in["wo"],
    }

def reference(A_x, A_wqkv, A_wo, B_x, B_wqkv, B_wo):
    def _A_ref(x, wqkv, wo):
        B, S, D = x.shape
        H = 32; Dh = D // H; W = 256
        qkv = (lambda x, *d: x.permute(*d))((x @ wqkv).reshape(B, S, 3, H, Dh), 2, 0, 3, 1, 4)
        q, k, v = qkv[0], qkv[1], qkv[2]
        scores = torch.einsum("bhqd,bhkd->bhqk", q, k) * (Dh ** -0.5)
        idx = torch.arange(S)
        mask = (idx[:, None] - idx[None, :] >= 0) & (idx[:, None] - idx[None, :] < W)
        scores = torch.where(mask[None, None], scores, -1e9)
        p = _softmax(scores, axis=-1)
        o = torch.einsum("bhqk,bhkd->bhqd", p, v)
        return (lambda x, *d: x.permute(*d))(o, 0, 2, 1, 3).reshape(B, S, D) @ wo

    def _B_ref(x, wqkv, wo):
        B, S, D = x.shape
        H = 32; Dh = D // H
        qkv = (lambda x, *d: x.permute(*d))((x @ wqkv).reshape(B, S, 3, H, Dh), 2, 0, 3, 1, 4)
        q, k, v = qkv[0], qkv[1], qkv[2]
        scale = Dh ** -0.5
        scores = torch.einsum("bhqd,bhkd->bhqk", q, k) * scale
        p = _softmax(scores, axis=-1)
        o = torch.einsum("bhqk,bhkd->bhqd", p, v)
        return (lambda x, *d: x.permute(*d))(o, 0, 2, 1, 3).reshape(B, S, D) @ wo

    a = _A_ref(A_x, A_wqkv, A_wo)
    b = _B_ref(B_x, B_wqkv, B_wo)
    return torch.concatenate([a, b], axis=-1)
```

```asm
; @launch grid=(256,1,1) block=(512,1,1) lds=163840
.amdgcn_target "amdgcn-amd-amdhsa--gfx950"
.text
.globl concat_heads__sliding_block__softmax_full_mha__prompt_kernel
.p2align 8
.type concat_heads__sliding_block__softmax_full_mha__prompt_kernel,@function
concat_heads__sliding_block__softmax_full_mha__prompt_kernel:
    s_cmp_ge_u32 s2, 256
    s_cbranch_scc1 L_done
    s_and_b32 s67, s2, 7
    s_lshr_b32 s16, s67, 2
    s_mul_i32 s48, s16, 24
    s_add_u32 s49, s48, 8
    s_load_dwordx2 s[4:5], s[0:1], s48
    s_load_dwordx2 s[8:9], s[0:1], s49
    s_add_u32 s49, s48, 16
    s_load_dwordx2 s[28:29], s[0:1], s49
    s_load_dwordx2 s[36:37], s[0:1], 48
    s_load_dwordx2 s[20:21], s[0:1], 64
    v_lshrrev_b32 v1, 6, v0
    v_and_b32 v0, 63, v0
    s_lshr_b32 s68, s2, 3
    v_readfirstlane_b32 s40, v1
    s_bfe_u32 s48, s67, 0x10001
    s_mul_i32 s48, s48, 30
    s_add_u32 s48, s48, s68
    s_and_b32 s49, s48, 3
    s_lshr_b32 s50, s48, 2
    s_and_b32 s48, s67, 1
    s_lshl_b32 s48, s48, 2
    s_add_u32 s42, s48, s49
    s_and_b32 s48, s67, 3
    s_lshl_b32 s48, s48, 1
    s_add_u32 s48, s48, s68
    s_sub_u32 s48, s48, 30
    s_cmp_ge_u32 s68, 30
    s_cselect_b32 s43, 15, s50
    s_cselect_b32 s42, s48, s42
    s_add_u32 s44, s49, s50
    s_and_b32 s44, s44, 1
    s_mul_i32 s44, s44, 5
    s_mov_b32 s6, 2621440
    s_mov_b32 s7, 131072
    s_mov_b32 s10, 2457600
    s_mov_b32 s11, 131072
    s_mov_b32 s30, 819200
    s_mov_b32 s31, 131072
    s_mov_b32 s38, 5242880
    s_mov_b32 s39, 131072
    s_mov_b32 s22, 24117248
    s_mov_b32 s23, 131072
    s_and_b32 s41, s40, 3
    v_lshrrev_b32 v10, 3, v0
    v_mul_u32_u24 v2, 1280, v10
    v_lshrrev_b32 v17, 4, v0
    v_and_b32 v11, 7, v0
    v_xor_b32 v11, v11, v17
    v_lshl_add_u32 v2, v11, 4, v2
    v_xor_b32 v3, 64, v2
    v_mul_u32_u24 v12, 3840, v17
    v_and_b32 v16, 15, v0
    v_lshlrev_b32 v13, 1, v17
    v_xor_b32 v11, v16, v13
    v_lshl_add_u32 v4, v11, 4, v12
    s_and_b32 s48, s40, 1
    s_lshl_b32 s48, s48, 7
    v_xor_b32 v4, s48, v4
    s_lshl_b32 s48, s42, 7
    s_lshl_b32 s49, s40, 4
    s_add_u32 s48, s48, s49
    s_mul_i32 s45, s48, 1280
    s_mul_i32 s46, s40, 30720
    s_lshl_b32 s48, s43, 8
    s_add_u32 s46, s46, s48
    s_lshl_b32 s47, s40, 11
    s_waitcnt lgkmcnt(0)
    s_cmp_eq_u32 s43, 15
    s_cbranch_scc1 L_setup1
    s_add_u32 s15, s44, 0
    s_cmp_ge_u32 s15, 10
    s_cselect_b32 s14, 10, 0
    s_sub_u32 s15, s15, s14
    s_lshl_b32 s14, s15, 7
    s_add_u32 s14, s14, s45
    s_mul_i32 s15, s15, 245760
    s_add_u32 s15, s15, s46
    s_add_u32 m0, s47, 131072
    s_add_u32 s50, s14, 0
    buffer_load_dwordx4 v2, s[4:7], s50 offen lds
    s_add_u32 m0, s47, 147456
    s_add_u32 s50, s15, 0
    buffer_load_dwordx4 v4, s[8:11], s50 offen lds
    s_add_u32 m0, s47, 132096
    s_add_u32 s50, s14, 10240
    buffer_load_dwordx4 v3, s[4:7], s50 offen lds
    s_add_u32 m0, s47, 148480
    s_add_u32 s50, s15, 15360
    buffer_load_dwordx4 v4, s[8:11], s50 offen lds
    s_add_u32 s15, s44, 1
    s_cmp_ge_u32 s15, 10
    s_cselect_b32 s14, 10, 0
    s_sub_u32 s15, s15, s14
    s_lshl_b32 s14, s15, 7
    s_add_u32 s14, s14, s45
    s_mul_i32 s15, s15, 245760
    s_add_u32 s15, s15, s46
    s_add_u32 m0, s47, 65536
    s_add_u32 s50, s14, 0
    buffer_load_dwordx4 v2, s[4:7], s50 offen lds
    s_add_u32 m0, s47, 81920
    s_add_u32 s50, s15, 0
    buffer_load_dwordx4 v4, s[8:11], s50 offen lds
    s_add_u32 m0, s47, 66560
    s_add_u32 s50, s14, 10240
    buffer_load_dwordx4 v3, s[4:7], s50 offen lds
    s_add_u32 m0, s47, 82944
    s_add_u32 s50, s15, 15360
    buffer_load_dwordx4 v4, s[8:11], s50 offen lds
L_setup1:
    s_lshl_b32 s48, s67, 2
    s_and_b32 s49, s68, 3
    s_add_u32 s56, s48, s49
    s_lshr_b32 s57, s68, 2
    s_add_u32 s48, s20, 21008384
    s_addc_u32 s49, s21, 0
    s_load_dword s3, s[48:49], 0
    v_lshrrev_b32 v10, 1, v16
    v_xor_b32 v10, v10, v17
    v_lshlrev_b32 v10, 4, v10
    v_lshl_add_u32 v10, v16, 7, v10
    s_lshr_b32 s48, s40, 2
    s_lshl_b32 s48, s48, 13
    v_add_u32 v20, s48, v10
    v_xor_b32 v21, 64, v20
    v_bfe_u32 v10, v0, 2, 2
    v_lshl_add_u32 v11, v17, 3, v10
    v_lshlrev_b32 v11, 8, v11
    v_and_b32 v12, 1, v17
    v_lshl_add_u32 v12, v12, 2, v10
    v_lshlrev_b32 v12, 1, v12
    v_bfe_u32 v13, v0, 1, 1
    s_lshl_b32 s48, s41, 2
    v_or_b32 v13, s48, v13
    v_xor_b32 v13, v13, v12
    v_lshl_add_u32 v13, v13, 4, v11
    v_and_b32 v14, 1, v0
    v_lshl_add_u32 v26, v14, 3, v13
    v_xor_b32 v27, 32, v26
    v_add_u32 v22, 65536, v20
    v_add_u32 v28, 65536, v26
    v_add_u32 v23, 65536, v21
    v_add_u32 v29, 65536, v27
    v_add_u32 v24, 131072, v20
    v_add_u32 v30, 131072, v26
    v_add_u32 v25, 131072, v21
    v_add_u32 v31, 131072, v27
    s_waitcnt lgkmcnt(0)
    s_cmp_eq_u32 s43, 15
    s_cbranch_scc1 L_idle
    s_waitcnt vmcnt(4)
    s_barrier
    ds_read_b64_tr_b16 v[64:65], v30 offset:16384
    ds_read_b64_tr_b16 v[66:67], v30 offset:17408
    ds_read_b64_tr_b16 v[68:69], v31 offset:16384
    ds_read_b64_tr_b16 v[70:71], v31 offset:17408
    ds_read_b128 v[32:35], v24 offset:0
    ds_read_b128 v[36:39], v24 offset:2048
    ds_read_b128 v[40:43], v24 offset:4096
    ds_read_b128 v[44:47], v24 offset:6144
    s_cmp_ge_u32 s43, 10
    s_cbranch_scc1 L_comp1
    s_waitcnt lgkmcnt(3)
    v_mfma_f32_16x16x32_bf16 v[224:227], v[64:67], v[32:35], 0
    ds_read_b64_tr_b16 v[72:73], v30 offset:24576
    ds_read_b64_tr_b16 v[74:75], v30 offset:25600
    s_lshl_b32 s48, s42, 2
    v_mfma_f32_16x16x32_bf16 v[240:243], v[68:71], v[32:35], 0
    ds_read_b64_tr_b16 v[76:77], v31 offset:24576
    ds_read_b64_tr_b16 v[78:79], v31 offset:25600
    s_lshr_b32 s49, s40, 2
    s_waitcnt lgkmcnt(6)
    v_mfma_f32_16x16x32_bf16 v[228:231], v[64:67], v[36:39], 0
    ds_read_b128 v[48:51], v25 offset:0
    s_lshl_b32 s49, s49, 1
    v_mfma_f32_16x16x32_bf16 v[244:247], v[68:71], v[36:39], 0
    ds_read_b128 v[52:55], v25 offset:2048
    s_add_u32 s48, s48, s49
    s_add_u32 s15, s44, 2
    s_cmp_ge_u32 s15, 10
    s_cselect_b32 s14, 10, 0
    s_sub_u32 s15, s15, s14
    s_lshl_b32 s14, s15, 7
    s_add_u32 s14, s14, s45
    s_mul_i32 s15, s15, 245760
    s_add_u32 s15, s15, s46
    s_add_u32 m0, s47, 98304
    s_add_u32 s50, s14, 0
    buffer_load_dwordx4 v2, s[4:7], s50 offen lds
    s_waitcnt lgkmcnt(7)
    v_mfma_f32_16x16x32_bf16 v[232:235], v[64:67], v[40:43], 0
    ds_read_b128 v[56:59], v25 offset:4096
    s_lshl_b32 s49, s16, 11
    v_mfma_f32_16x16x32_bf16 v[248:251], v[68:71], v[40:43], 0
    ds_read_b128 v[60:63], v25 offset:6144
    s_add_u32 s48, s48, s49
    s_waitcnt lgkmcnt(8)
    v_mfma_f32_16x16x32_bf16 v[236:239], v[64:67], v[44:47], 0
    s_mul_i32 s52, s43, 52
    v_mfma_f32_16x16x32_bf16 v[252:255], v[68:71], v[44:47], 0
    s_add_u32 m0, s47, 114688
    s_add_u32 s50, s15, 0
    buffer_load_dwordx4 v4, s[8:11], s50 offen lds
    s_add_u32 m0, s47, 99328
    s_add_u32 s50, s14, 10240
    buffer_load_dwordx4 v3, s[4:7], s50 offen lds
    s_add_u32 m0, s47, 115712
    s_add_u32 s50, s15, 15360
    buffer_load_dwordx4 v4, s[8:11], s50 offen lds
    s_waitcnt lgkmcnt(0)
    s_waitcnt vmcnt(4)
    s_barrier
    v_mfma_f32_16x16x32_bf16 v[224:227], v[72:75], v[48:51], v[224:227]
    ds_read_b64_tr_b16 v[80:81], v28 offset:16384
    ds_read_b64_tr_b16 v[82:83], v28 offset:17408
    s_lshr_b32 s52, s52, 8
    v_mfma_f32_16x16x32_bf16 v[240:243], v[76:79], v[48:51], v[240:243]
    ds_read_b64_tr_b16 v[84:85], v29 offset:16384
    ds_read_b64_tr_b16 v[86:87], v29 offset:17408
    s_min_u32 s49, s52, 1
    v_mfma_f32_16x16x32_bf16 v[228:231], v[72:75], v[52:55], v[228:231]
    ds_read_b128 v[32:35], v22 offset:0
    s_lshl_b32 s51, 1280, s49
    v_mfma_f32_16x16x32_bf16 v[244:247], v[76:79], v[52:55], v[244:247]
    ds_read_b128 v[36:39], v22 offset:2048
    s_mul_i32 s54, s48, s51
    s_add_u32 s15, s44, 3
    s_cmp_ge_u32 s15, 10
    s_cselect_b32 s14, 10, 0
    s_sub_u32 s15, s15, s14
    s_lshl_b32 s14, s15, 7
    s_add_u32 s14, s14, s45
    s_mul_i32 s15, s15, 245760
    s_add_u32 s15, s15, s46
    s_add_u32 m0, s47, 131072
    s_add_u32 s50, s14, 0
    buffer_load_dwordx4 v2, s[4:7], s50 offen lds
    v_mfma_f32_16x16x32_bf16 v[232:235], v[72:75], v[56:59], v[232:235]
    ds_read_b128 v[40:43], v22 offset:4096
    s_mul_i32 s48, s49, 5242880
    v_mfma_f32_16x16x32_bf16 v[248:251], v[76:79], v[56:59], v[248:251]
    ds_read_b128 v[44:47], v22 offset:6144
    s_add_u32 s54, s54, s48
    v_mfma_f32_16x16x32_bf16 v[236:239], v[72:75], v[60:63], v[236:239]
    s_mov_b32 s55, s51
    v_mfma_f32_16x16x32_bf16 v[252:255], v[76:79], v[60:63], v[252:255]
    s_add_u32 m0, s47, 147456
    s_add_u32 s50, s15, 0
    buffer_load_dwordx4 v4, s[8:11], s50 offen lds
    s_waitcnt lgkmcnt(3)
    v_mfma_f32_16x16x32_bf16 v[224:227], v[80:83], v[32:35], v[224:227]
    ds_read_b64_tr_b16 v[88:89], v28 offset:24576
    ds_read_b64_tr_b16 v[90:91], v28 offset:25600
    s_lshl_b32 s51, s51, 6
    v_mfma_f32_16x16x32_bf16 v[240:243], v[84:87], v[32:35], v[240:243]
    ds_read_b64_tr_b16 v[92:93], v29 offset:24576
    ds_read_b64_tr_b16 v[94:95], v29 offset:25600
    s_mul_i32 s48, s52, 5
    s_waitcnt lgkmcnt(6)
    v_mfma_f32_16x16x32_bf16 v[228:231], v[80:83], v[36:39], v[228:231]
    ds_read_b128 v[48:51], v23 offset:0
    s_sub_u32 s53, s43, s48
    v_mfma_f32_16x16x32_bf16 v[244:247], v[84:87], v[36:39], v[244:247]
    ds_read_b128 v[52:55], v23 offset:2048
    s_lshl_b32 s48, s53, 5
    s_add_u32 m0, s47, 132096
    s_add_u32 s50, s14, 10240
    buffer_load_dwordx4 v3, s[4:7], s50 offen lds
    s_waitcnt lgkmcnt(7)
    v_mfma_f32_16x16x32_bf16 v[232:235], v[80:83], v[40:43], v[232:235]
    ds_read_b128 v[56:59], v23 offset:4096
    s_lshl_b32 s49, s41, 3
    v_mfma_f32_16x16x32_bf16 v[248:251], v[84:87], v[40:43], v[248:251]
    ds_read_b128 v[60:63], v23 offset:6144
    s_add_u32 s48, s48, s49
    s_waitcnt lgkmcnt(8)
    v_mfma_f32_16x16x32_bf16 v[236:239], v[80:83], v[44:47], v[236:239]
    v_add_u32 v10, s48, v17
    v_mfma_f32_16x16x32_bf16 v[252:255], v[84:87], v[44:47], v[252:255]
    s_add_u32 m0, s47, 148480
    s_add_u32 s50, s15, 15360
    buffer_load_dwordx4 v4, s[8:11], s50 offen lds
    s_waitcnt lgkmcnt(0)
    s_waitcnt vmcnt(4)
    s_barrier
    v_mfma_f32_16x16x32_bf16 v[224:227], v[88:91], v[48:51], v[224:227]
    ds_read_b64_tr_b16 v[96:97], v28 offset:49152
    ds_read_b64_tr_b16 v[98:99], v28 offset:50176
    s_lshl_b32 s48, s48, 2
    v_mfma_f32_16x16x32_bf16 v[240:243], v[92:95], v[48:51], v[240:243]
    ds_read_b64_tr_b16 v[100:101], v29 offset:49152
    ds_read_b64_tr_b16 v[102:103], v29 offset:50176
    v_add_u32 v11, s48, v16
    v_mfma_f32_16x16x32_bf16 v[228:231], v[88:91], v[52:55], v[228:231]
    ds_read_b128 v[32:35], v22 offset:32768
    v_lshlrev_b32 v12, 4, v16
    v_mfma_f32_16x16x32_bf16 v[244:247], v[92:95], v[52:55], v[244:247]
    ds_read_b128 v[36:39], v22 offset:34816
    v_mul_u32_u24 v13, 320, v17
    s_add_u32 s15, s44, 4
    s_cmp_ge_u32 s15, 10
    s_cselect_b32 s14, 10, 0
    s_sub_u32 s15, s15, s14
    s_lshl_b32 s14, s15, 7
    s_add_u32 s14, s14, s45
    s_mul_i32 s15, s15, 245760
    s_add_u32 s15, s15, s46
    s_add_u32 m0, s47, 65536
    s_add_u32 s50, s14, 0
    buffer_load_dwordx4 v2, s[4:7], s50 offen lds
    v_mfma_f32_16x16x32_bf16 v[232:235], v[88:91], v[56:59], v[232:235]
    ds_read_b128 v[40:43], v22 offset:36864
    v_add_u32 v13, 1280, v13
    v_mfma_f32_16x16x32_bf16 v[248:251], v[92:95], v[56:59], v[248:251]
    ds_read_b128 v[44:47], v22 offset:38912
    v_mul_u32_u24 v14, 205, v10
    v_mfma_f32_16x16x32_bf16 v[236:239], v[88:91], v[60:63], v[236:239]
    v_lshrrev_b32 v14, 10, v14
    v_mfma_f32_16x16x32_bf16 v[252:255], v[92:95], v[60:63], v[252:255]
    s_add_u32 m0, s47, 81920
    s_add_u32 s50, s15, 0
    buffer_load_dwordx4 v4, s[8:11], s50 offen lds
    s_waitcnt lgkmcnt(3)
    v_mfma_f32_16x16x32_bf16 v[224:227], v[96:99], v[32:35], v[224:227]
    ds_read_b64_tr_b16 v[104:105], v28 offset:57344
    ds_read_b64_tr_b16 v[106:107], v28 offset:58368
    v_mul_u32_u24 v15, 5, v14
    v_mfma_f32_16x16x32_bf16 v[240:243], v[100:103], v[32:35], v[240:243]
    ds_read_b64_tr_b16 v[108:109], v29 offset:57344
    ds_read_b64_tr_b16 v[110:111], v29 offset:58368
    v_sub_u32 v15, v10, v15
    s_waitcnt lgkmcnt(6)
    v_mfma_f32_16x16x32_bf16 v[228:231], v[96:99], v[36:39], v[228:231]
    ds_read_b128 v[48:51], v23 offset:32768
    v_mul_lo_u32 v14, v14, s51
    v_mfma_f32_16x16x32_bf16 v[244:247], v[100:103], v[36:39], v[244:247]
    ds_read_b128 v[52:55], v23 offset:34816
    v_lshl_add_u32 v15, v15, 8, v12
    s_add_u32 m0, s47, 66560
    s_add_u32 s50, s14, 10240
    buffer_load_dwordx4 v3, s[4:7], s50 offen lds
    s_waitcnt lgkmcnt(7)
    v_mfma_f32_16x16x32_bf16 v[232:235], v[96:99], v[40:43], v[232:235]
    ds_read_b128 v[56:59], v23 offset:36864
    v_add_u32 v18, v14, v15
    v_mfma_f32_16x16x32_bf16 v[248:251], v[100:103], v[40:43], v[248:251]
    ds_read_b128 v[60:63], v23 offset:38912
    v_mul_u32_u24 v14, 3277, v11
    s_waitcnt lgkmcnt(8)
    v_mfma_f32_16x16x32_bf16 v[236:239], v[96:99], v[44:47], v[236:239]
    v_lshrrev_b32 v14, 16, v14
    v_mfma_f32_16x16x32_bf16 v[252:255], v[100:103], v[44:47], v[252:255]
    s_add_u32 m0, s47, 82944
    s_add_u32 s50, s15, 15360
    buffer_load_dwordx4 v4, s[8:11], s50 offen lds
    s_waitcnt lgkmcnt(0)
    s_waitcnt vmcnt(4)
    s_barrier
    v_mfma_f32_16x16x32_bf16 v[224:227], v[104:107], v[48:51], v[224:227]
    ds_read_b64_tr_b16 v[112:113], v30 offset:16384
    ds_read_b64_tr_b16 v[114:115], v30 offset:17408
    v_mul_u32_u24 v15, 20, v14
    s_add_u32 s15, s44, 5
    s_cmp_ge_u32 s15, 10
    s_cselect_b32 s14, 10, 0
    s_sub_u32 s15, s15, s14
    s_lshl_b32 s14, s15, 7
    s_add_u32 s14, s14, s45
    s_mul_i32 s15, s15, 245760
    s_add_u32 s15, s15, s46
    s_add_u32 m0, s47, 98304
    s_add_u32 s50, s14, 0
    buffer_load_dwordx4 v2, s[4:7], s50 offen lds
    v_mfma_f32_16x16x32_bf16 v[240:243], v[108:111], v[48:51], v[240:243]
    ds_read_b64_tr_b16 v[116:117], v31 offset:16384
    ds_read_b64_tr_b16 v[118:119], v31 offset:17408
    v_sub_u32 v15, v11, v15
    s_add_u32 m0, s47, 114688
    s_add_u32 s50, s15, 0
    buffer_load_dwordx4 v4, s[8:11], s50 offen lds
    v_mfma_f32_16x16x32_bf16 v[228:231], v[104:107], v[52:55], v[228:231]
    ds_read_b128 v[32:35], v24 offset:0
    v_mul_lo_u32 v14, v14, s51
    v_mfma_f32_16x16x32_bf16 v[244:247], v[108:111], v[52:55], v[244:247]
    ds_read_b128 v[36:39], v24 offset:2048
    v_lshl_add_u32 v15, v15, 4, v13
    s_add_u32 m0, s47, 99328
    s_add_u32 s50, s14, 10240
    buffer_load_dwordx4 v3, s[4:7], s50 offen lds
    v_mfma_f32_16x16x32_bf16 v[232:235], v[104:107], v[56:59], v[232:235]
    ds_read_b128 v[40:43], v24 offset:4096
    v_add_u32 v1, v14, v15
    v_mfma_f32_16x16x32_bf16 v[248:251], v[108:111], v[56:59], v[248:251]
    ds_read_b128 v[44:47], v24 offset:6144
    v_cmp_le_u32 vcc, 2, s52
    v_mfma_f32_16x16x32_bf16 v[236:239], v[104:107], v[60:63], v[236:239]
    v_add_u32 v10, 4, v10
    v_mfma_f32_16x16x32_bf16 v[252:255], v[108:111], v[60:63], v[252:255]
    s_add_u32 m0, s47, 115712
    s_add_u32 s50, s15, 15360
    buffer_load_dwordx4 v4, s[8:11], s50 offen lds
    s_waitcnt lgkmcnt(3)
    v_mfma_f32_16x16x32_bf16 v[224:227], v[112:115], v[32:35], v[224:227]
    ds_read_b64_tr_b16 v[120:121], v30 offset:24576
    ds_read_b64_tr_b16 v[122:123], v30 offset:25600
    v_add_u32 v11, 16, v11
    v_mfma_f32_16x16x32_bf16 v[240:243], v[116:119], v[32:35], v[240:243]
    ds_read_b64_tr_b16 v[124:125], v31 offset:24576
    ds_read_b64_tr_b16 v[126:127], v31 offset:25600
    v_cndmask_b32 v18, v18, v1, vcc
    s_waitcnt lgkmcnt(6)
    v_mfma_f32_16x16x32_bf16 v[228:231], v[112:115], v[36:39], v[228:231]
    ds_read_b128 v[48:51], v25 offset:0
    v_mul_u32_u24 v14, 205, v10
    v_mfma_f32_16x16x32_bf16 v[244:247], v[116:119], v[36:39], v[244:247]
    ds_read_b128 v[52:55], v25 offset:2048
    v_lshrrev_b32 v14, 10, v14
    s_add_u32 s15, s44, 0
    s_cmp_ge_u32 s15, 10
    s_cselect_b32 s14, 10, 0
    s_sub_u32 s15, s15, s14
    s_lshl_b32 s14, s15, 7
    s_add_u32 s14, s14, s45
    s_add_u32 m0, s47, 0
    s_add_u32 s50, s14, 1310720
    buffer_load_dwordx4 v2, s[4:7], s50 offen lds
    s_waitcnt lgkmcnt(7)
    v_mfma_f32_16x16x32_bf16 v[232:235], v[112:115], v[40:43], v[232:235]
    ds_read_b128 v[56:59], v25 offset:4096
    v_mul_u32_u24 v15, 5, v14
    v_mfma_f32_16x16x32_bf16 v[248:251], v[116:119], v[40:43], v[248:251]
    ds_read_b128 v[60:63], v25 offset:6144
    v_sub_u32 v15, v10, v15
    s_waitcnt lgkmcnt(8)
    v_mfma_f32_16x16x32_bf16 v[236:239], v[112:115], v[44:47], v[236:239]
    v_mul_lo_u32 v14, v14, s51
    v_mfma_f32_16x16x32_bf16 v[252:255], v[116:119], v[44:47], v[252:255]
    s_add_u32 m0, s47, 1024
    s_add_u32 s50, s14, 1320960
    buffer_load_dwordx4 v3, s[4:7], s50 offen lds
    s_waitcnt lgkmcnt(0)
    s_waitcnt vmcnt(6)
    s_barrier
    v_mfma_f32_16x16x32_bf16 v[224:227], v[120:123], v[48:51], v[224:227]
    ds_read_b64_tr_b16 v[128:129], v28 offset:16384
    ds_read_b64_tr_b16 v[130:131], v28 offset:17408
    v_lshl_add_u32 v15, v15, 8, v12
    s_add_u32 s15, s44, 6
    s_cmp_ge_u32 s15, 10
    s_cselect_b32 s14, 10, 0
    s_sub_u32 s15, s15, s14
    s_lshl_b32 s14, s15, 7
    s_add_u32 s14, s14, s45
    s_mul_i32 s15, s15, 245760
    s_add_u32 s15, s15, s46
    s_add_u32 m0, s47, 131072
    s_add_u32 s50, s14, 0
    buffer_load_dwordx4 v2, s[4:7], s50 offen lds
    v_mfma_f32_16x16x32_bf16 v[240:243], v[124:127], v[48:51], v[240:243]
    ds_read_b64_tr_b16 v[132:133], v29 offset:16384
    ds_read_b64_tr_b16 v[134:135], v29 offset:17408
    v_add_u32 v19, v14, v15
    s_add_u32 m0, s47, 147456
    s_add_u32 s50, s15, 0
    buffer_load_dwordx4 v4, s[8:11], s50 offen lds
    v_mfma_f32_16x16x32_bf16 v[228:231], v[120:123], v[52:55], v[228:231]
    ds_read_b128 v[32:35], v22 offset:0
    v_mul_u32_u24 v14, 3277, v11
    v_mfma_f32_16x16x32_bf16 v[244:247], v[124:127], v[52:55], v[244:247]
    ds_read_b128 v[36:39], v22 offset:2048
    v_lshrrev_b32 v14, 16, v14
    s_add_u32 m0, s47, 132096
    s_add_u32 s50, s14, 10240
    buffer_load_dwordx4 v3, s[4:7], s50 offen lds
    v_mfma_f32_16x16x32_bf16 v[232:235], v[120:123], v[56:59], v[232:235]
    ds_read_b128 v[40:43], v22 offset:4096
    v_mul_u32_u24 v15, 20, v14
    v_mfma_f32_16x16x32_bf16 v[248:251], v[124:127], v[56:59], v[248:251]
    ds_read_b128 v[44:47], v22 offset:6144
    v_sub_u32 v15, v11, v15
    v_mfma_f32_16x16x32_bf16 v[236:239], v[120:123], v[60:63], v[236:239]
    v_mul_lo_u32 v14, v14, s51
    v_mfma_f32_16x16x32_bf16 v[252:255], v[124:127], v[60:63], v[252:255]
    s_add_u32 m0, s47, 148480
    s_add_u32 s50, s15, 15360
    buffer_load_dwordx4 v4, s[8:11], s50 offen lds
    s_waitcnt lgkmcnt(3)
    v_mfma_f32_16x16x32_bf16 v[224:227], v[128:131], v[32:35], v[224:227]
    ds_read_b64_tr_b16 v[136:137], v28 offset:24576
    ds_read_b64_tr_b16 v[138:139], v28 offset:25600
    v_lshl_add_u32 v15, v15, 4, v13
    v_mfma_f32_16x16x32_bf16 v[240:243], v[132:135], v[32:35], v[240:243]
    ds_read_b64_tr_b16 v[140:141], v29 offset:24576
    ds_read_b64_tr_b16 v[142:143], v29 offset:25600
    v_add_u32 v1, v14, v15
    s_waitcnt lgkmcnt(6)
    v_mfma_f32_16x16x32_bf16 v[228:231], v[128:131], v[36:39], v[228:231]
    ds_read_b128 v[48:51], v23 offset:0
    v_cmp_le_u32 vcc, 2, s52
    v_mfma_f32_16x16x32_bf16 v[244:247], v[132:135], v[36:39], v[244:247]
    ds_read_b128 v[52:55], v23 offset:2048
    v_add_u32 v10, 4, v10
    s_add_u32 s15, s44, 1
    s_cmp_ge_u32 s15, 10
    s_cselect_b32 s14, 10, 0
    s_sub_u32 s15, s15, s14
    s_lshl_b32 s14, s15, 7
    s_add_u32 s14, s14, s45
    s_add_u32 m0, s47, 16384
    s_add_u32 s50, s14, 1310720
    buffer_load_dwordx4 v2, s[4:7], s50 offen lds
    s_waitcnt lgkmcnt(7)
    v_mfma_f32_16x16x32_bf16 v[232:235], v[128:131], v[40:43], v[232:235]
    ds_read_b128 v[56:59], v23 offset:4096
    v_add_u32 v11, 16, v11
    v_mfma_f32_16x16x32_bf16 v[248:251], v[132:135], v[40:43], v[248:251]
    ds_read_b128 v[60:63], v23 offset:6144
    v_cndmask_b32 v19, v19, v1, vcc
    s_waitcnt lgkmcnt(8)
    v_mfma_f32_16x16x32_bf16 v[236:239], v[128:131], v[44:47], v[236:239]
    s_mul_i32 s48, s53, 205
    v_mfma_f32_16x16x32_bf16 v[252:255], v[132:135], v[44:47], v[252:255]
    s_add_u32 m0, s47, 17408
    s_add_u32 s50, s14, 1320960
    buffer_load_dwordx4 v3, s[4:7], s50 offen lds
    s_waitcnt lgkmcnt(0)
    s_waitcnt vmcnt(8)
    s_barrier
    v_mfma_f32_16x16x32_bf16 v[224:227], v[136:139], v[48:51], v[224:227]
    ds_read_b64_tr_b16 v[144:145], v28 offset:49152
    ds_read_b64_tr_b16 v[146:147], v28 offset:50176
    s_lshr_b32 s48, s48, 5
    s_add_u32 s15, s44, 7
    s_cmp_ge_u32 s15, 10
    s_cselect_b32 s14, 10, 0
    s_sub_u32 s15, s15, s14
    s_lshl_b32 s14, s15, 7
    s_add_u32 s14, s14, s45
    s_mul_i32 s15, s15, 245760
    s_add_u32 s15, s15, s46
    s_add_u32 m0, s47, 65536
    s_add_u32 s50, s14, 0
    buffer_load_dwordx4 v2, s[4:7], s50 offen lds
    v_mfma_f32_16x16x32_bf16 v[240:243], v[140:143], v[48:51], v[240:243]
    ds_read_b64_tr_b16 v[148:149], v29 offset:49152
    ds_read_b64_tr_b16 v[150:151], v29 offset:50176
    s_lshl_b32 s48, s48, 9
    s_add_u32 m0, s47, 81920
    s_add_u32 s50, s15, 0
    buffer_load_dwordx4 v4, s[8:11], s50 offen lds
    v_mfma_f32_16x16x32_bf16 v[228:231], v[136:139], v[52:55], v[228:231]
    ds_read_b128 v[32:35], v22 offset:32768
    s_lshl_b32 s49, s52, 7
    v_mfma_f32_16x16x32_bf16 v[244:247], v[140:143], v[52:55], v[244:247]
    ds_read_b128 v[36:39], v22 offset:34816
    s_add_u32 s48, s48, s49
    s_add_u32 m0, s47, 66560
    s_add_u32 s50, s14, 10240
    buffer_load_dwordx4 v3, s[4:7], s50 offen lds
    v_mfma_f32_16x16x32_bf16 v[232:235], v[136:139], v[56:59], v[232:235]
    ds_read_b128 v[40:43], v22 offset:36864
    s_lshl_b32 s49, s42, 3
    v_mfma_f32_16x16x32_bf16 v[248:251], v[140:143], v[56:59], v[248:251]
    ds_read_b128 v[44:47], v22 offset:38912
    s_add_u32 s48, s48, s49
    v_mfma_f32_16x16x32_bf16 v[236:239], v[136:139], v[60:63], v[236:239]
    s_lshl_b32 s49, s16, 14
    v_mfma_f32_16x16x32_bf16 v[252:255], v[140:143], v[60:63], v[252:255]
    s_add_u32 m0, s47, 82944
    s_add_u32 s50, s15, 15360
    buffer_load_dwordx4 v4, s[8:11], s50 offen lds
    s_waitcnt lgkmcnt(3)
    v_mfma_f32_16x16x32_bf16 v[224:227], v[144:147], v[32:35], v[224:227]
    ds_read_b64_tr_b16 v[152:153], v28 offset:57344
    ds_read_b64_tr_b16 v[154:155], v28 offset:58368
    s_add_u32 s48, s48, s49
    v_mfma_f32_16x16x32_bf16 v[240:243], v[148:151], v[32:35], v[240:243]
    ds_read_b64_tr_b16 v[156:157], v29 offset:57344
    ds_read_b64_tr_b16 v[158:159], v29 offset:58368
    v_lshl_add_u32 v5, v0, 9, s48
    s_waitcnt lgkmcnt(6)
    v_mfma_f32_16x16x32_bf16 v[228:231], v[144:147], v[36:39], v[228:231]
    ds_read_b128 v[48:51], v23 offset:32768
    s_min_u32 s49, s53, 1
    v_mfma_f32_16x16x32_bf16 v[244:247], v[148:151], v[36:39], v[244:247]
    ds_read_b128 v[52:55], v23 offset:34816
    s_lshl_b32 s49, s49, 2
    s_add_u32 s15, s44, 2
    s_cmp_ge_u32 s15, 10
    s_cselect_b32 s14, 10, 0
    s_sub_u32 s15, s15, s14
    s_lshl_b32 s14, s15, 7
    s_add_u32 s14, s14, s45
    s_add_u32 m0, s47, 32768
    s_add_u32 s50, s14, 1310720
    buffer_load_dwordx4 v2, s[4:7], s50 offen lds
    s_waitcnt lgkmcnt(7)
    v_mfma_f32_16x16x32_bf16 v[232:235], v[144:147], v[40:43], v[232:235]
    ds_read_b128 v[56:59], v23 offset:36864
    v_mov_b32 v10, s49
    v_mfma_f32_16x16x32_bf16 v[248:251], v[148:151], v[40:43], v[248:251]
    ds_read_b128 v[60:63], v23 offset:38912
    v_cmp_eq_u32 vcc, 0, v0
    s_waitcnt lgkmcnt(8)
    v_mfma_f32_16x16x32_bf16 v[236:239], v[144:147], v[44:47], v[236:239]
    s_xor_b32 s48, s53, 2
    v_mfma_f32_16x16x32_bf16 v[252:255], v[148:151], v[44:47], v[252:255]
    s_add_u32 m0, s47, 33792
    s_add_u32 s50, s14, 1320960
    buffer_load_dwordx4 v3, s[4:7], s50 offen lds
    s_waitcnt lgkmcnt(0)
    s_waitcnt vmcnt(8)
    s_barrier
    v_mfma_f32_16x16x32_bf16 v[224:227], v[152:155], v[48:51], v[224:227]
    ds_read_b64_tr_b16 v[160:161], v30 offset:16384
    ds_read_b64_tr_b16 v[162:163], v30 offset:17408
    s_min_u32 s48, s48, 1
    s_add_u32 s15, s44, 8
    s_cmp_ge_u32 s15, 10
    s_cselect_b32 s14, 10, 0
    s_sub_u32 s15, s15, s14
    s_lshl_b32 s14, s15, 7
    s_add_u32 s14, s14, s45
    s_mul_i32 s15, s15, 245760
    s_add_u32 s15, s15, s46
    s_add_u32 m0, s47, 98304
    s_add_u32 s50, s14, 0
    buffer_load_dwordx4 v2, s[4:7], s50 offen lds
    v_mfma_f32_16x16x32_bf16 v[240:243], v[156:159], v[48:51], v[240:243]
    ds_read_b64_tr_b16 v[164:165], v31 offset:16384
    ds_read_b64_tr_b16 v[166:167], v31 offset:17408
    v_cndmask_b32 v10, 0, v10, vcc
    s_add_u32 m0, s47, 114688
    s_add_u32 s50, s15, 0
    buffer_load_dwordx4 v4, s[8:11], s50 offen lds
    v_mfma_f32_16x16x32_bf16 v[228:231], v[152:155], v[52:55], v[228:231]
    ds_read_b128 v[32:35], v24 offset:0
    v_add_u32 v5, v10, v5
    v_mfma_f32_16x16x32_bf16 v[244:247], v[156:159], v[52:55], v[244:247]
    ds_read_b128 v[36:39], v24 offset:2048
    s_lshr_b32 s24, 0xff, s48
    s_add_u32 m0, s47, 99328
    s_add_u32 s50, s14, 10240
    buffer_load_dwordx4 v3, s[4:7], s50 offen lds
    v_mfma_f32_16x16x32_bf16 v[232:235], v[152:155], v[56:59], v[232:235]
    ds_read_b128 v[40:43], v24 offset:4096
    s_mov_b32 s25, 0
    v_mfma_f32_16x16x32_bf16 v[248:251], v[156:159], v[56:59], v[248:251]
    ds_read_b128 v[44:47], v24 offset:6144
    s_mul_i32 s48, s56, 20
    v_mfma_f32_16x16x32_bf16 v[236:239], v[152:155], v[60:63], v[236:239]
    s_add_u32 s49, s48, 19
    v_mfma_f32_16x16x32_bf16 v[252:255], v[156:159], v[60:63], v[252:255]
    s_add_u32 m0, s47, 115712
    s_add_u32 s50, s15, 15360
    buffer_load_dwordx4 v4, s[8:11], s50 offen lds
    s_waitcnt lgkmcnt(3)
    v_mfma_f32_16x16x32_bf16 v[224:227], v[160:163], v[32:35], v[224:227]
    ds_read_b64_tr_b16 v[168:169], v30 offset:24576
    ds_read_b64_tr_b16 v[170:171], v30 offset:25600
    s_xor_b32 s48, s48, s49
    v_mfma_f32_16x16x32_bf16 v[240:243], v[164:167], v[32:35], v[240:243]
    ds_read_b64_tr_b16 v[172:173], v31 offset:24576
    ds_read_b64_tr_b16 v[174:175], v31 offset:25600
    s_lshr_b32 s48, s48, 7
    s_waitcnt lgkmcnt(6)
    v_mfma_f32_16x16x32_bf16 v[228:231], v[160:163], v[36:39], v[228:231]
    ds_read_b128 v[48:51], v25 offset:0
    s_min_u32 s48, s48, 1
    v_mfma_f32_16x16x32_bf16 v[244:247], v[164:167], v[36:39], v[244:247]
    ds_read_b128 v[52:55], v25 offset:2048
    s_sub_u32 s26, 0, s48
    s_add_u32 s15, s44, 3
    s_cmp_ge_u32 s15, 10
    s_cselect_b32 s14, 10, 0
    s_sub_u32 s15, s15, s14
    s_lshl_b32 s14, s15, 7
    s_add_u32 s14, s14, s45
    s_add_u32 m0, s47, 49152
    s_add_u32 s50, s14, 1310720
    buffer_load_dwordx4 v2, s[4:7], s50 offen lds
    s_waitcnt lgkmcnt(7)
    v_mfma_f32_16x16x32_bf16 v[232:235], v[160:163], v[40:43], v[232:235]
    ds_read_b128 v[56:59], v25 offset:4096
    s_mov_b32 s27, s26
    v_mfma_f32_16x16x32_bf16 v[248:251], v[164:167], v[40:43], v[248:251]
    ds_read_b128 v[60:63], v25 offset:6144
    s_lshl_b32 s48, s56, 9
    s_waitcnt lgkmcnt(8)
    v_mfma_f32_16x16x32_bf16 v[236:239], v[160:163], v[44:47], v[236:239]
    v_lshl_add_u32 v6, v0, 3, s48
    v_mfma_f32_16x16x32_bf16 v[252:255], v[164:167], v[44:47], v[252:255]
    s_add_u32 m0, s47, 50176
    s_add_u32 s50, s14, 1320960
    buffer_load_dwordx4 v3, s[4:7], s50 offen lds
    s_waitcnt lgkmcnt(0)
    s_waitcnt vmcnt(8)
    s_barrier
    v_mfma_f32_16x16x32_bf16 v[224:227], v[168:171], v[48:51], v[224:227]
    ds_read_b64_tr_b16 v[176:177], v28 offset:16384
    ds_read_b64_tr_b16 v[178:179], v28 offset:17408
    s_lshl_b32 s58, s57, 2
    v_mfma_f32_16x16x32_bf16 v[240:243], v[172:175], v[48:51], v[240:243]
    ds_read_b64_tr_b16 v[180:181], v29 offset:16384
    ds_read_b64_tr_b16 v[182:183], v29 offset:17408
    s_add_u32 s58, s58, s41
    v_mfma_f32_16x16x32_bf16 v[228:231], v[168:171], v[52:55], v[228:231]
    ds_read_b128 v[32:35], v22 offset:0
    s_and_b32 s48, s40, 4
    v_mfma_f32_16x16x32_bf16 v[244:247], v[172:175], v[52:55], v[244:247]
    ds_read_b128 v[36:39], v22 offset:2048
    s_lshl_b32 s48, s48, 3
    s_add_u32 s15, s44, 9
    s_cmp_ge_u32 s15, 10
    s_cselect_b32 s14, 10, 0
    s_sub_u32 s15, s15, s14
    s_lshl_b32 s14, s15, 7
    s_add_u32 s14, s14, s45
    s_mul_i32 s15, s15, 245760
    s_add_u32 s15, s15, s46
    s_add_u32 m0, s47, 131072
    s_add_u32 s50, s14, 0
    buffer_load_dwordx4 v2, s[4:7], s50 offen lds
    v_mfma_f32_16x16x32_bf16 v[232:235], v[168:171], v[56:59], v[232:235]
    ds_read_b128 v[40:43], v22 offset:4096
    s_add_u32 s58, s58, s48
    v_mfma_f32_16x16x32_bf16 v[248:251], v[172:175], v[56:59], v[248:251]
    ds_read_b128 v[44:47], v22 offset:6144
    s_lshl_b32 s59, s40, 10
    v_mfma_f32_16x16x32_bf16 v[236:239], v[168:171], v[60:63], v[236:239]
    s_mov_b32 s60, 0x000fffff
    v_mfma_f32_16x16x32_bf16 v[252:255], v[172:175], v[60:63], v[252:255]
    s_add_u32 m0, s47, 147456
    s_add_u32 s50, s15, 0
    buffer_load_dwordx4 v4, s[8:11], s50 offen lds
    s_waitcnt lgkmcnt(3)
    v_mfma_f32_16x16x32_bf16 v[224:227], v[176:179], v[32:35], v[224:227]
    ds_read_b64_tr_b16 v[184:185], v28 offset:24576
    ds_read_b64_tr_b16 v[186:187], v28 offset:25600
    s_mov_b32 s61, 0x000fffff
    v_mfma_f32_16x16x32_bf16 v[240:243], v[180:183], v[32:35], v[240:243]
    ds_read_b64_tr_b16 v[188:189], v29 offset:24576
    ds_read_b64_tr_b16 v[190:191], v29 offset:25600
    s_mov_b32 s62, -1
    s_waitcnt lgkmcnt(6)
    v_mfma_f32_16x16x32_bf16 v[228:231], v[176:179], v[36:39], v[228:231]
    ds_read_b128 v[48:51], v23 offset:0
    s_mov_b32 s63, 0
    v_mfma_f32_16x16x32_bf16 v[244:247], v[180:183], v[36:39], v[244:247]
    ds_read_b128 v[52:55], v23 offset:2048
    s_mov_b32 s12, 0x00ff00ff
    s_add_u32 m0, s47, 132096
    s_add_u32 s50, s14, 10240
    buffer_load_dwordx4 v3, s[4:7], s50 offen lds
    s_waitcnt lgkmcnt(7)
    v_mfma_f32_16x16x32_bf16 v[232:235], v[176:179], v[40:43], v[232:235]
    ds_read_b128 v[56:59], v23 offset:4096
    s_mov_b32 s13, 0x000000ff
    v_mfma_f32_16x16x32_bf16 v[248:251], v[180:183], v[40:43], v[248:251]
    ds_read_b128 v[60:63], v23 offset:6144
    s_mov_b32 s64, 1051011932
    s_waitcnt lgkmcnt(8)
    v_mfma_f32_16x16x32_bf16 v[236:239], v[176:179], v[44:47], v[236:239]
    s_mov_b32 s65, 0x3f80
    v_mfma_f32_16x16x32_bf16 v[252:255], v[180:183], v[44:47], v[252:255]
    s_add_u32 m0, s47, 148480
    s_add_u32 s50, s15, 15360
    buffer_load_dwordx4 v4, s[8:11], s50 offen lds
    s_waitcnt lgkmcnt(0)
    s_waitcnt vmcnt(6)
    s_barrier
    v_mfma_f32_16x16x32_bf16 v[224:227], v[184:187], v[48:51], v[224:227]
    ds_read_b64_tr_b16 v[192:193], v28 offset:49152
    ds_read_b64_tr_b16 v[194:195], v28 offset:50176
    s_mul_i32 s66, s56, 163840
    v_mfma_f32_16x16x32_bf16 v[240:243], v[188:191], v[48:51], v[240:243]
    ds_read_b64_tr_b16 v[196:197], v29 offset:49152
    ds_read_b64_tr_b16 v[198:199], v29 offset:50176
    s_add_u32 s66, s66, 5242880
    v_mfma_f32_16x16x32_bf16 v[228:231], v[184:187], v[52:55], v[228:231]
    ds_read_b128 v[32:35], v22 offset:32768
    s_add_u32 s71, s66, s59
    v_mfma_f32_16x16x32_bf16 v[244:247], v[188:191], v[52:55], v[244:247]
    ds_read_b128 v[36:39], v22 offset:34816
    s_add_u32 s3, s3, 0x9e3779b1
    s_add_u32 s15, s44, 5
    s_cmp_ge_u32 s15, 10
    s_cselect_b32 s14, 10, 0
    s_sub_u32 s15, s15, s14
    s_lshl_b32 s14, s15, 7
    s_add_u32 s14, s14, s45
    s_add_u32 m0, s47, 65536
    s_add_u32 s50, s14, 1310720
    buffer_load_dwordx4 v2, s[4:7], s50 offen lds
    v_mfma_f32_16x16x32_bf16 v[232:235], v[184:187], v[56:59], v[232:235]
    ds_read_b128 v[40:43], v22 offset:36864
    v_mfma_f32_16x16x32_bf16 v[248:251], v[188:191], v[56:59], v[248:251]
    ds_read_b128 v[44:47], v22 offset:38912
    v_mfma_f32_16x16x32_bf16 v[236:239], v[184:187], v[60:63], v[236:239]
    v_mfma_f32_16x16x32_bf16 v[252:255], v[188:191], v[60:63], v[252:255]
    s_add_u32 m0, s47, 66560
    s_add_u32 s50, s14, 1320960
    buffer_load_dwordx4 v3, s[4:7], s50 offen lds
    s_waitcnt lgkmcnt(3)
    v_mfma_f32_16x16x32_bf16 v[224:227], v[192:195], v[32:35], v[224:227]
    ds_read_b64_tr_b16 v[200:201], v28 offset:57344
    ds_read_b64_tr_b16 v[202:203], v28 offset:58368
    s_mul_i32 s48, s58, 40960
    v_mfma_f32_16x16x32_bf16 v[240:243], v[196:199], v[32:35], v[240:243]
    ds_read_b64_tr_b16 v[204:205], v29 offset:57344
    ds_read_b64_tr_b16 v[206:207], v29 offset:58368
    s_add_u32 s48, s48, 15728640
    s_waitcnt lgkmcnt(6)
    v_mfma_f32_16x16x32_bf16 v[228:231], v[192:195], v[36:39], v[228:231]
    ds_read_b128 v[48:51], v23 offset:32768
    s_lshl_b32 s28, s56, 10
    v_mfma_f32_16x16x32_bf16 v[244:247], v[196:199], v[36:39], v[244:247]
    ds_read_b128 v[52:55], v23 offset:34816
    s_add_u32 s28, s28, s48
    s_add_u32 s15, s44, 6
    s_cmp_ge_u32 s15, 10
    s_cselect_b32 s14, 10, 0
    s_sub_u32 s15, s15, s14
    s_lshl_b32 s14, s15, 7
    s_add_u32 s14, s14, s45
    s_add_u32 m0, s47, 81920
    s_add_u32 s50, s14, 1310720
    buffer_load_dwordx4 v2, s[4:7], s50 offen lds
    s_waitcnt lgkmcnt(7)
    v_mfma_f32_16x16x32_bf16 v[232:235], v[192:195], v[40:43], v[232:235]
    ds_read_b128 v[56:59], v23 offset:36864
    s_lshr_b32 s29, s56, 2
    v_mfma_f32_16x16x32_bf16 v[248:251], v[196:199], v[40:43], v[248:251]
    ds_read_b128 v[60:63], v23 offset:38912
    s_add_u32 s29, s29, 32
    s_waitcnt lgkmcnt(8)
    v_mfma_f32_16x16x32_bf16 v[236:239], v[192:195], v[44:47], v[236:239]
    s_lshl_b32 s29, s29, 10
    v_mfma_f32_16x16x32_bf16 v[252:255], v[196:199], v[44:47], v[252:255]
    s_add_u32 s29, s29, s48
    s_add_u32 m0, s47, 82944
    s_add_u32 s50, s14, 1320960
    buffer_load_dwordx4 v3, s[4:7], s50 offen lds
    s_waitcnt lgkmcnt(0)
    s_waitcnt vmcnt(4)
    s_barrier
    v_mfma_f32_16x16x32_bf16 v[224:227], v[200:203], v[48:51], v[224:227]
    ds_read_b64_tr_b16 v[208:209], v30 offset:16384
    ds_read_b64_tr_b16 v[210:211], v30 offset:17408
    s_and_b32 s48, s56, 1
    v_mfma_f32_16x16x32_bf16 v[240:243], v[204:207], v[48:51], v[240:243]
    ds_read_b64_tr_b16 v[212:213], v31 offset:16384
    ds_read_b64_tr_b16 v[214:215], v31 offset:17408
    s_lshl_b32 s48, s48, 9
    v_mfma_f32_16x16x32_bf16 v[228:231], v[200:203], v[52:55], v[228:231]
    ds_read_b128 v[32:35], v24 offset:0
    s_add_u32 s29, s29, s48
    v_mfma_f32_16x16x32_bf16 v[244:247], v[204:207], v[52:55], v[244:247]
    ds_read_b128 v[36:39], v24 offset:2048
    s_and_b32 s48, s56, 2
    s_add_u32 s15, s44, 7
    s_cmp_ge_u32 s15, 10
    s_cselect_b32 s14, 10, 0
    s_sub_u32 s15, s15, s14
    s_lshl_b32 s14, s15, 7
    s_add_u32 s14, s14, s45
    s_add_u32 m0, s47, 98304
    s_add_u32 s50, s14, 1310720
    buffer_load_dwordx4 v2, s[4:7], s50 offen lds
    v_mfma_f32_16x16x32_bf16 v[232:235], v[200:203], v[56:59], v[232:235]
    ds_read_b128 v[40:43], v24 offset:4096
    s_lshl_b32 s48, s48, 2
    v_mfma_f32_16x16x32_bf16 v[248:251], v[204:207], v[56:59], v[248:251]
    ds_read_b128 v[44:47], v24 offset:6144
    s_add_u32 s29, s29, s48
    v_mfma_f32_16x16x32_bf16 v[236:239], v[200:203], v[60:63], v[236:239]
    s_lshl_b32 s48, s56, 1
    v_mfma_f32_16x16x32_bf16 v[252:255], v[204:207], v[60:63], v[252:255]
    s_lshr_b32 s49, s41, 1
    s_add_u32 m0, s47, 99328
    s_add_u32 s50, s14, 1320960
    buffer_load_dwordx4 v3, s[4:7], s50 offen lds
    s_waitcnt lgkmcnt(3)
    v_mfma_f32_16x16x32_bf16 v[224:227], v[208:211], v[32:35], v[224:227]
    ds_read_b64_tr_b16 v[216:217], v30 offset:24576
    ds_read_b64_tr_b16 v[218:219], v30 offset:25600
    s_add_u32 s48, s48, s49
    v_mfma_f32_16x16x32_bf16 v[240:243], v[212:215], v[32:35], v[240:243]
    ds_read_b64_tr_b16 v[220:221], v31 offset:24576
    ds_read_b64_tr_b16 v[222:223], v31 offset:25600
    s_mul_i32 s48, s48, 40960
    s_waitcnt lgkmcnt(6)
    v_mfma_f32_16x16x32_bf16 v[228:231], v[208:211], v[36:39], v[228:231]
    ds_read_b128 v[48:51], v25 offset:0
    s_and_b32 s49, s41, 1
    v_mfma_f32_16x16x32_bf16 v[244:247], v[212:215], v[36:39], v[244:247]
    ds_read_b128 v[52:55], v25 offset:2048
    s_lshl_b32 s49, s49, 8
    s_add_u32 s15, s44, 8
    s_cmp_ge_u32 s15, 10
    s_cselect_b32 s14, 10, 0
    s_sub_u32 s15, s15, s14
    s_lshl_b32 s14, s15, 7
    s_add_u32 s14, s14, s45
    s_add_u32 m0, s47, 114688
    s_add_u32 s50, s14, 1310720
    buffer_load_dwordx4 v2, s[4:7], s50 offen lds
    s_waitcnt lgkmcnt(7)
    v_mfma_f32_16x16x32_bf16 v[232:235], v[208:211], v[40:43], v[232:235]
    ds_read_b128 v[56:59], v25 offset:4096
    s_add_u32 s48, s48, s49
    v_mfma_f32_16x16x32_bf16 v[248:251], v[212:215], v[40:43], v[248:251]
    ds_read_b128 v[60:63], v25 offset:6144
    s_add_u32 s48, s48, 15728640
    s_waitcnt lgkmcnt(8)
    v_mfma_f32_16x16x32_bf16 v[236:239], v[208:211], v[44:47], v[236:239]
    s_lshr_b32 s49, s40, 2
    v_mfma_f32_16x16x32_bf16 v[252:255], v[212:215], v[44:47], v[252:255]
    s_lshl_b32 s31, s49, 12
    s_add_u32 m0, s47, 115712
    s_add_u32 s50, s14, 1320960
    buffer_load_dwordx4 v3, s[4:7], s50 offen lds
    s_waitcnt lgkmcnt(0)
    s_waitcnt vmcnt(30)
    s_barrier
    v_mfma_f32_16x16x32_bf16 v[224:227], v[216:219], v[48:51], v[224:227]
    ds_read_b128 v[32:35], v20 offset:0
    s_add_u32 s31, s31, s48
    v_mfma_f32_16x16x32_bf16 v[240:243], v[220:223], v[48:51], v[240:243]
    ds_read_b128 v[36:39], v20 offset:2048
    s_add_u32 s31, s31, 32768
    v_mfma_f32_16x16x32_bf16 v[228:231], v[216:219], v[52:55], v[228:231]
    ds_read_b128 v[40:43], v20 offset:4096
    s_mul_i32 s67, s49, 2560
    v_mfma_f32_16x16x32_bf16 v[244:247], v[220:223], v[52:55], v[244:247]
    ds_read_b128 v[44:47], v20 offset:6144
    s_mul_i32 s69, s49, 28160
    v_mfma_f32_16x16x32_bf16 v[232:235], v[216:219], v[56:59], v[232:235]
    s_lshl_b32 s49, s49, 14
    v_mfma_f32_16x16x32_bf16 v[248:251], v[220:223], v[56:59], v[248:251]
    s_add_u32 s30, s48, s49
    v_mfma_f32_16x16x32_bf16 v[236:239], v[216:219], v[60:63], v[236:239]
    s_mul_i32 s48, s41, 2560
    v_mfma_f32_16x16x32_bf16 v[252:255], v[220:223], v[60:63], v[252:255]
    s_add_u32 s69, s69, s48
    s_nop 5
    s_add_u32 s50, s54, s55
    v_cvt_pk_bf16_f32 v48, v224, v225
    v_cvt_pk_bf16_f32 v49, v226, v227
    v_cvt_pk_bf16_f32 v50, v228, v229
    v_cvt_pk_bf16_f32 v51, v230, v231
    buffer_store_dwordx4 v[48:51], v18, s[20:23], s54 offen sc1
    v_cvt_pk_bf16_f32 v52, v232, v233
    v_cvt_pk_bf16_f32 v53, v234, v235
    v_cvt_pk_bf16_f32 v54, v236, v237
    v_cvt_pk_bf16_f32 v55, v238, v239
    buffer_store_dwordx4 v[52:55], v18, s[20:23], s50 offen sc1
    v_cvt_pk_bf16_f32 v56, v240, v241
    v_cvt_pk_bf16_f32 v57, v242, v243
    v_cvt_pk_bf16_f32 v58, v244, v245
    v_cvt_pk_bf16_f32 v59, v246, v247
    buffer_store_dwordx4 v[56:59], v19, s[20:23], s54 offen sc1
    v_cvt_pk_bf16_f32 v60, v248, v249
    v_cvt_pk_bf16_f32 v61, v250, v251
    v_cvt_pk_bf16_f32 v62, v252, v253
    v_cvt_pk_bf16_f32 v63, v254, v255
    buffer_store_dwordx4 v[60:63], v19, s[20:23], s50 offen sc1
    s_lshl_b32 s50, s55, 5
    s_add_u32 s54, s54, s50
    s_waitcnt lgkmcnt(3)
    v_mfma_f32_16x16x32_bf16 v[224:227], v[64:67], v[32:35], 0
    ds_read_b128 v[48:51], v21 offset:0
    s_mul_i32 s34, s57, 102400
    v_mfma_f32_16x16x32_bf16 v[240:243], v[68:71], v[32:35], 0
    ds_read_b128 v[52:55], v21 offset:2048
    s_add_u32 s34, s34, s59
    s_waitcnt lgkmcnt(4)
    v_mfma_f32_16x16x32_bf16 v[228:231], v[64:67], v[36:39], 0
    ds_read_b128 v[56:59], v21 offset:4096
    s_mul_i32 s35, s57, 10240
    v_mfma_f32_16x16x32_bf16 v[244:247], v[68:71], v[36:39], 0
    ds_read_b128 v[60:63], v21 offset:6144
    s_sub_u32 s35, s35, 20480
    s_waitcnt lgkmcnt(5)
    v_mfma_f32_16x16x32_bf16 v[232:235], v[64:67], v[40:43], 0
    s_add_u32 s35, s35, s59
    v_mfma_f32_16x16x32_bf16 v[248:251], v[68:71], v[40:43], 0
    v_lshrrev_b32 v11, 5, v0
    s_waitcnt lgkmcnt(4)
    v_mfma_f32_16x16x32_bf16 v[236:239], v[64:67], v[44:47], 0
    v_and_b32 v12, 31, v0
    v_mfma_f32_16x16x32_bf16 v[252:255], v[68:71], v[44:47], 0
    v_and_b32 v17, 0x1b, v12
    s_waitcnt vmcnt(28)
    s_barrier
    s_waitcnt lgkmcnt(3)
    v_mfma_f32_16x16x32_bf16 v[224:227], v[72:75], v[48:51], v[224:227]
    ds_read_b128 v[32:35], v20 offset:16384
    v_cmp_eq_u32 vcc, 24, v17
    v_mfma_f32_16x16x32_bf16 v[240:243], v[76:79], v[48:51], v[240:243]
    ds_read_b128 v[36:39], v20 offset:18432
    v_mov_b32 v16, 0x3f803f80
    s_waitcnt lgkmcnt(4)
    v_mfma_f32_16x16x32_bf16 v[228:231], v[72:75], v[52:55], v[228:231]
    ds_read_b128 v[40:43], v20 offset:20480
    v_lshlrev_b32 v13, 4, v11
    v_mfma_f32_16x16x32_bf16 v[244:247], v[76:79], v[52:55], v[244:247]
    ds_read_b128 v[44:47], v20 offset:22528
    v_cndmask_b32 v17, 0, v16, vcc
    s_waitcnt lgkmcnt(5)
    v_mfma_f32_16x16x32_bf16 v[232:235], v[72:75], v[56:59], v[232:235]
    v_sub_u32 v13, v12, v13
    v_mfma_f32_16x16x32_bf16 v[248:251], v[76:79], v[56:59], v[248:251]
    v_mov_b32 v14, 4048155338
    s_waitcnt lgkmcnt(4)
    v_mfma_f32_16x16x32_bf16 v[236:239], v[72:75], v[60:63], v[236:239]
    v_mfma_f32_16x16x32_bf16 v[252:255], v[76:79], v[60:63], v[252:255]
    s_waitcnt lgkmcnt(3)
    v_mfma_f32_16x16x32_bf16 v[224:227], v[80:83], v[32:35], v[224:227]
    ds_read_b128 v[48:51], v21 offset:16384
    v_lshlrev_b32 v67, 4, v0
    v_mfma_f32_16x16x32_bf16 v[240:243], v[84:87], v[32:35], v[240:243]
    ds_read_b128 v[52:55], v21 offset:18432
    v_and_b32 v15, 15, v12
    s_waitcnt lgkmcnt(4)
    v_mfma_f32_16x16x32_bf16 v[228:231], v[80:83], v[36:39], v[228:231]
    ds_read_b128 v[56:59], v21 offset:20480
    v_lshlrev_b32 v15, 4, v15
    v_mfma_f32_16x16x32_bf16 v[244:247], v[84:87], v[36:39], v[244:247]
    ds_read_b128 v[60:63], v21 offset:22528
    v_lshrrev_b32 v16, 4, v12
    s_waitcnt lgkmcnt(5)
    v_mfma_f32_16x16x32_bf16 v[232:235], v[80:83], v[40:43], v[232:235]
    v_lshl_add_u32 v15, v16, 3, v15
    v_mfma_f32_16x16x32_bf16 v[248:251], v[84:87], v[40:43], v[248:251]
    v_lshl_add_u32 v68, v11, 8, v15
    s_waitcnt lgkmcnt(4)
    v_mfma_f32_16x16x32_bf16 v[236:239], v[80:83], v[44:47], v[236:239]
    v_and_b32 v10, 3, v12
    v_mfma_f32_16x16x32_bf16 v[252:255], v[84:87], v[44:47], v[252:255]
    v_lshrrev_b32 v15, 3, v12
    s_waitcnt vmcnt(0)
    s_barrier
    s_cmp_lg_u32 s40, 1
    s_cbranch_scc1 L_w_1
    s_cmp_eq_u32 s43, 15
    s_cbranch_scc1 L_w_1
    v_mov_b32 v1, s3
    s_mov_b32 s50, 20971520
    s_mov_b64 exec, s[24:25]
    buffer_store_dword v1, v5, s[20:23], s50 offen sc1
    s_mov_b64 exec, -1
L_w_1:
    s_waitcnt lgkmcnt(3)
    v_mfma_f32_16x16x32_bf16 v[224:227], v[88:91], v[48:51], v[224:227]
    ds_read_b128 v[32:35], v20 offset:32768
    v_lshl_add_u32 v10, v15, 2, v10
    v_mfma_f32_16x16x32_bf16 v[240:243], v[92:95], v[48:51], v[240:243]
    ds_read_b128 v[36:39], v20 offset:34816
    v_bfe_u32 v15, v12, 2, 1
    s_waitcnt lgkmcnt(4)
    v_mfma_f32_16x16x32_bf16 v[228:231], v[88:91], v[52:55], v[228:231]
    ds_read_b128 v[40:43], v20 offset:36864
    v_lshlrev_b32 v10, 4, v10
    v_mfma_f32_16x16x32_bf16 v[244:247], v[92:95], v[52:55], v[244:247]
    ds_read_b128 v[44:47], v20 offset:38912
    v_lshl_add_u32 v16, v15, 3, v10
    s_add_u32 s15, s44, 4
    s_cmp_ge_u32 s15, 10
    s_cselect_b32 s14, 10, 0
    s_sub_u32 s15, s15, s14
    s_lshl_b32 s14, s15, 7
    s_add_u32 s14, s14, s45
    s_add_u32 m0, s47, 131072
    s_add_u32 s50, s14, 1310720
    buffer_load_dwordx4 v2, s[4:7], s50 offen lds
    s_waitcnt lgkmcnt(5)
    v_mfma_f32_16x16x32_bf16 v[232:235], v[88:91], v[56:59], v[232:235]
    v_lshl_add_u32 v16, v11, 8, v16
    v_mfma_f32_16x16x32_bf16 v[248:251], v[92:95], v[56:59], v[248:251]
    v_add_u32 v64, s67, v16
    s_waitcnt lgkmcnt(4)
    v_mfma_f32_16x16x32_bf16 v[236:239], v[88:91], v[60:63], v[236:239]
    v_mul_u32_u24 v16, 20, v11
    v_mfma_f32_16x16x32_bf16 v[252:255], v[92:95], v[60:63], v[252:255]
    v_add_u32 v16, v16, v12
    s_add_u32 m0, s47, 132096
    s_add_u32 s50, s14, 1320960
    buffer_load_dwordx4 v3, s[4:7], s50 offen lds
    s_waitcnt lgkmcnt(3)
    v_mfma_f32_16x16x32_bf16 v[224:227], v[96:99], v[32:35], v[224:227]
    ds_read_b128 v[48:51], v21 offset:32768
    v_lshlrev_b32 v16, 4, v16
    v_mfma_f32_16x16x32_bf16 v[240:243], v[100:103], v[32:35], v[240:243]
    ds_read_b128 v[52:55], v21 offset:34816
    s_add_u32 s48, s67, 1280
    s_waitcnt lgkmcnt(4)
    v_mfma_f32_16x16x32_bf16 v[228:231], v[96:99], v[36:39], v[228:231]
    ds_read_b128 v[56:59], v21 offset:36864
    v_add_u32 v65, s48, v16
    v_mfma_f32_16x16x32_bf16 v[244:247], v[100:103], v[36:39], v[244:247]
    ds_read_b128 v[60:63], v21 offset:38912
    v_mov_b32 v66, 0xdddddddd
    s_add_u32 s15, s44, 9
    s_cmp_ge_u32 s15, 10
    s_cselect_b32 s14, 10, 0
    s_sub_u32 s15, s15, s14
    s_lshl_b32 s14, s15, 7
    s_add_u32 s14, s14, s45
    s_add_u32 m0, s47, 147456
    s_add_u32 s50, s14, 1310720
    buffer_load_dwordx4 v2, s[4:7], s50 offen lds
    s_waitcnt lgkmcnt(5)
    v_mfma_f32_16x16x32_bf16 v[232:235], v[96:99], v[40:43], v[232:235]
    v_lshrrev_b32 v10, 4, v0
    v_mfma_f32_16x16x32_bf16 v[248:251], v[100:103], v[40:43], v[248:251]
    v_lshlrev_b32 v16, 9, v10
    s_waitcnt lgkmcnt(4)
    v_mfma_f32_16x16x32_bf16 v[236:239], v[96:99], v[44:47], v[236:239]
    v_and_b32 v15, 15, v0
    v_mfma_f32_16x16x32_bf16 v[252:255], v[100:103], v[44:47], v[252:255]
    v_lshl_add_u32 v69, v15, 4, v16
    s_add_u32 m0, s47, 148480
    s_add_u32 s50, s14, 1320960
    buffer_load_dwordx4 v3, s[4:7], s50 offen lds
    s_waitcnt lgkmcnt(3)
    v_mfma_f32_16x16x32_bf16 v[224:227], v[104:107], v[48:51], v[224:227]
    ds_read_b128 v[32:35], v20 offset:49152
    v_mul_u32_u24 v15, 2560, v15
    v_mfma_f32_16x16x32_bf16 v[240:243], v[108:111], v[48:51], v[240:243]
    ds_read_b128 v[36:39], v20 offset:51200
    v_lshl_add_u32 v71, v10, 4, v15
    s_waitcnt lgkmcnt(4)
    v_mfma_f32_16x16x32_bf16 v[228:231], v[104:107], v[52:55], v[228:231]
    ds_read_b128 v[40:43], v20 offset:53248
    v_lshl_add_u32 v73, v10, 3, v15
    v_mfma_f32_16x16x32_bf16 v[244:247], v[108:111], v[52:55], v[244:247]
    ds_read_b128 v[44:47], v20 offset:55296
    s_lshl_b32 s48, s67, 1
    s_waitcnt lgkmcnt(5)
    v_mfma_f32_16x16x32_bf16 v[232:235], v[104:107], v[56:59], v[232:235]
    v_add_u32 v70, s48, v67
    v_mfma_f32_16x16x32_bf16 v[248:251], v[108:111], v[56:59], v[248:251]
    s_mul_i32 s48, s41, 5120
    s_waitcnt lgkmcnt(4)
    v_mfma_f32_16x16x32_bf16 v[236:239], v[104:107], v[60:63], v[236:239]
    v_add_u32 v72, s48, v67
    v_mfma_f32_16x16x32_bf16 v[252:255], v[108:111], v[60:63], v[252:255]
    s_and_b32 s48, s56, 14
    s_waitcnt lgkmcnt(3)
    v_mfma_f32_16x16x32_bf16 v[224:227], v[112:115], v[32:35], v[224:227]
    ds_read_b128 v[48:51], v21 offset:49152
    s_lshl_b32 s48, s48, 7
    v_mfma_f32_16x16x32_bf16 v[240:243], v[116:119], v[32:35], v[240:243]
    ds_read_b128 v[52:55], v21 offset:51200
    v_lshl_add_u32 v74, v12, 2, s48
    s_waitcnt lgkmcnt(4)
    v_mfma_f32_16x16x32_bf16 v[228:231], v[112:115], v[36:39], v[228:231]
    ds_read_b128 v[56:59], v21 offset:53248
    v_mov_b32 v76, 0x3f803f80
    v_mfma_f32_16x16x32_bf16 v[244:247], v[116:119], v[36:39], v[244:247]
    ds_read_b128 v[60:63], v21 offset:55296
    v_mov_b32 v77, 0x00003f80
    s_waitcnt lgkmcnt(5)
    v_mfma_f32_16x16x32_bf16 v[232:235], v[112:115], v[40:43], v[232:235]
    v_mov_b32 v78, 0x3f803f80
    v_mfma_f32_16x16x32_bf16 v[248:251], v[116:119], v[40:43], v[248:251]
    v_mov_b32 v79, 0x00003f80
    s_waitcnt lgkmcnt(4)
    v_mfma_f32_16x16x32_bf16 v[236:239], v[112:115], v[44:47], v[236:239]
    v_mov_b32 v80, v17
    v_mfma_f32_16x16x32_bf16 v[252:255], v[116:119], v[44:47], v[252:255]
    v_mov_b32 v81, v17
    s_waitcnt lgkmcnt(3)
    v_mfma_f32_16x16x32_bf16 v[224:227], v[120:123], v[48:51], v[224:227]
    ds_read_b128 v[32:35], v22 offset:0
    v_mov_b32 v82, v17
    v_mfma_f32_16x16x32_bf16 v[240:243], v[124:127], v[48:51], v[240:243]
    ds_read_b128 v[36:39], v22 offset:2048
    v_mov_b32 v83, v17
    s_waitcnt lgkmcnt(4)
    v_mfma_f32_16x16x32_bf16 v[228:231], v[120:123], v[52:55], v[228:231]
    ds_read_b128 v[40:43], v22 offset:4096
    v_mov_b32 v84, v17
    v_mfma_f32_16x16x32_bf16 v[244:247], v[124:127], v[52:55], v[244:247]
    ds_read_b128 v[44:47], v22 offset:6144
    v_mov_b32 v85, v17
    s_waitcnt lgkmcnt(5)
    v_mfma_f32_16x16x32_bf16 v[232:235], v[120:123], v[56:59], v[232:235]
    v_mov_b32 v86, v17
    v_mfma_f32_16x16x32_bf16 v[248:251], v[124:127], v[56:59], v[248:251]
    v_mov_b32 v87, v17
    s_waitcnt lgkmcnt(4)
    v_mfma_f32_16x16x32_bf16 v[236:239], v[120:123], v[60:63], v[236:239]
    v_mov_b32 v88, v17
    v_mfma_f32_16x16x32_bf16 v[252:255], v[124:127], v[60:63], v[252:255]
    v_mov_b32 v89, v17
    s_waitcnt lgkmcnt(3)
    v_mfma_f32_16x16x32_bf16 v[224:227], v[144:147], v[32:35], v[224:227]
    ds_read_b128 v[48:51], v23 offset:0
    v_mov_b32 v90, v17
    v_mfma_f32_16x16x32_bf16 v[240:243], v[148:151], v[32:35], v[240:243]
    ds_read_b128 v[52:55], v23 offset:2048
    v_mov_b32 v91, v17
    s_waitcnt lgkmcnt(4)
    v_mfma_f32_16x16x32_bf16 v[228:231], v[144:147], v[36:39], v[228:231]
    ds_read_b128 v[56:59], v23 offset:4096
    v_mov_b32 v92, v17
    v_mfma_f32_16x16x32_bf16 v[244:247], v[148:151], v[36:39], v[244:247]
    ds_read_b128 v[60:63], v23 offset:6144
    v_mov_b32 v93, v17
    s_waitcnt lgkmcnt(5)
    v_mfma_f32_16x16x32_bf16 v[232:235], v[144:147], v[40:43], v[232:235]
    v_mov_b32 v94, v17
    v_mfma_f32_16x16x32_bf16 v[248:251], v[148:151], v[40:43], v[248:251]
    v_mov_b32 v95, v17
    s_waitcnt lgkmcnt(4)
    v_mfma_f32_16x16x32_bf16 v[236:239], v[144:147], v[44:47], v[236:239]
    v_cmp_le_i32 vcc, 0, v13
    v_mfma_f32_16x16x32_bf16 v[252:255], v[148:151], v[44:47], v[252:255]
    v_cmp_le_i32 s[52:53], 1, v13
    s_cmp_lg_u32 s40, 0
    s_cbranch_scc1 L_w_2
    s_mov_b32 s17, 20987904
    buffer_load_dwordx2 v[8:9], v6, s[20:23], s17 offen sc1
L_w_2:
    s_waitcnt lgkmcnt(3)
    v_mfma_f32_16x16x32_bf16 v[224:227], v[152:155], v[48:51], v[224:227]
    ds_read_b128 v[32:35], v22 offset:16384
    s_nop 0
    v_mfma_f32_16x16x32_bf16 v[240:243], v[156:159], v[48:51], v[240:243]
    ds_read_b128 v[36:39], v22 offset:18432
    v_cndmask_b32 v96, 0, v14, vcc
    s_waitcnt lgkmcnt(4)
    v_mfma_f32_16x16x32_bf16 v[228:231], v[152:155], v[52:55], v[228:231]
    ds_read_b128 v[40:43], v22 offset:20480
    v_cndmask_b32 v97, 0, v14, s[52:53]
    v_mfma_f32_16x16x32_bf16 v[244:247], v[156:159], v[52:55], v[244:247]
    ds_read_b128 v[44:47], v22 offset:22528
    v_sub_f32 v112, v14, v96
    s_waitcnt lgkmcnt(5)
    v_mfma_f32_16x16x32_bf16 v[232:235], v[152:155], v[56:59], v[232:235]
    v_cmp_le_i32 vcc, 2, v13
    v_mfma_f32_16x16x32_bf16 v[248:251], v[156:159], v[56:59], v[248:251]
    v_cmp_le_i32 s[52:53], 3, v13
    s_waitcnt lgkmcnt(4)
    v_mfma_f32_16x16x32_bf16 v[236:239], v[152:155], v[60:63], v[236:239]
    v_sub_f32 v113, v14, v97
    v_mfma_f32_16x16x32_bf16 v[252:255], v[156:159], v[60:63], v[252:255]
    v_cndmask_b32 v98, 0, v14, vcc
    s_waitcnt lgkmcnt(3)
    v_mfma_f32_16x16x32_bf16 v[224:227], v[160:163], v[32:35], v[224:227]
    ds_read_b128 v[48:51], v23 offset:16384
    v_cndmask_b32 v99, 0, v14, s[52:53]
    v_mfma_f32_16x16x32_bf16 v[240:243], v[164:167], v[32:35], v[240:243]
    ds_read_b128 v[52:55], v23 offset:18432
    v_sub_f32 v114, v14, v98
    s_waitcnt lgkmcnt(4)
    v_mfma_f32_16x16x32_bf16 v[228:231], v[160:163], v[36:39], v[228:231]
    ds_read_b128 v[56:59], v23 offset:20480
    v_cmp_le_i32 vcc, 4, v13
    v_mfma_f32_16x16x32_bf16 v[244:247], v[164:167], v[36:39], v[244:247]
    ds_read_b128 v[60:63], v23 offset:22528
    v_cmp_le_i32 s[52:53], 5, v13
    s_waitcnt lgkmcnt(5)
    v_mfma_f32_16x16x32_bf16 v[232:235], v[160:163], v[40:43], v[232:235]
    v_sub_f32 v115, v14, v99
    v_mfma_f32_16x16x32_bf16 v[248:251], v[164:167], v[40:43], v[248:251]
    v_cndmask_b32 v100, 0, v14, vcc
    s_waitcnt lgkmcnt(4)
    v_mfma_f32_16x16x32_bf16 v[236:239], v[160:163], v[44:47], v[236:239]
    v_cndmask_b32 v101, 0, v14, s[52:53]
    v_mfma_f32_16x16x32_bf16 v[252:255], v[164:167], v[44:47], v[252:255]
    v_sub_f32 v116, v14, v100
    s_cmp_lg_u32 s40, 0
    s_cbranch_scc1 L_w_3
    s_mov_b32 s70, 0x20000
    s_waitcnt vmcnt(0)
L_spin_4:
    v_cmp_eq_u32 s[32:33], s3, v8
    v_cmp_eq_u32 s[18:19], s3, v9
    s_orn2_b64 s[18:19], s[18:19], s[26:27]
    s_and_b64 s[32:33], s[32:33], s[18:19]
    s_orn2_b64 s[32:33], s[32:33], s[12:13]
    s_cmp_eq_u64 s[32:33], -1
    s_cbranch_scc1 L_w_3
    s_sleep 4
    s_mov_b32 s17, 20987904
    buffer_load_dwordx2 v[8:9], v6, s[20:23], s17 offen sc1
    s_sub_u32 s70, s70, 1
    s_cmp_lg_u32 s70, 0
    s_waitcnt vmcnt(0)
    s_cbranch_scc1 L_spin_4
L_w_3:
    s_waitcnt vmcnt(8)
    s_barrier
    s_waitcnt lgkmcnt(3)
    v_mfma_f32_16x16x32_bf16 v[224:227], v[168:171], v[48:51], v[224:227]
    ds_read_b128 v[32:35], v22 offset:32768
    v_cmp_le_i32 vcc, 6, v13
    v_mfma_f32_16x16x32_bf16 v[240:243], v[172:175], v[48:51], v[240:243]
    ds_read_b128 v[36:39], v22 offset:34816
    v_cmp_le_i32 s[52:53], 7, v13
    s_mul_i32 s50, s56, 64
    s_and_b32 s17, s58, 31
    s_add_u32 s50, s50, s17
    s_mul_i32 s50, s50, 1280
    s_add_u32 s50, s50, 2621440
    buffer_load_dwordx2 v[144:145], v68, s[20:23], s50 offen sc1
    buffer_load_dwordx2 v[146:147], v68, s[20:23], s50 offen offset:512 sc1
    s_mov_b64 exec, s[62:63]
    buffer_load_dwordx2 v[148:149], v68, s[20:23], s50 offen offset:1024 sc1
    s_mov_b64 exec, -1
    s_waitcnt lgkmcnt(4)
    v_mfma_f32_16x16x32_bf16 v[228:231], v[168:171], v[52:55], v[228:231]
    ds_read_b128 v[40:43], v22 offset:36864
    v_sub_f32 v117, v14, v101
    v_mfma_f32_16x16x32_bf16 v[244:247], v[172:175], v[52:55], v[244:247]
    ds_read_b128 v[44:47], v22 offset:38912
    v_cndmask_b32 v102, 0, v14, vcc
    s_add_u32 m0, s59, 0
    s_add_u32 s50, s71, 5242880
    buffer_load_dwordx4 v67, s[20:23], s50 offen sc1 lds
    s_waitcnt lgkmcnt(5)
    v_mfma_f32_16x16x32_bf16 v[232:235], v[168:171], v[56:59], v[232:235]
    v_cndmask_b32 v103, 0, v14, s[52:53]
    v_mfma_f32_16x16x32_bf16 v[248:251], v[172:175], v[56:59], v[248:251]
    v_sub_f32 v118, v14, v102
    s_add_u32 m0, s59, 8192
    s_add_u32 s50, s71, 5251072
    buffer_load_dwordx4 v67, s[20:23], s50 offen sc1 lds
    s_waitcnt lgkmcnt(4)
    v_mfma_f32_16x16x32_bf16 v[236:239], v[168:171], v[60:63], v[236:239]
    v_cmp_le_i32 vcc, 8, v13
    v_mfma_f32_16x16x32_bf16 v[252:255], v[172:175], v[60:63], v[252:255]
    v_cmp_le_i32 s[52:53], 9, v13
    s_add_u32 m0, s59, 16384
    s_add_u32 s50, s71, 5259264
    buffer_load_dwordx4 v67, s[20:23], s50 offen sc1 lds
    s_waitcnt lgkmcnt(3)
    v_mfma_f32_16x16x32_bf16 v[224:227], v[176:179], v[32:35], v[224:227]
    ds_read_b128 v[48:51], v23 offset:32768
    v_sub_f32 v119, v14, v103
    v_mfma_f32_16x16x32_bf16 v[240:243], v[180:183], v[32:35], v[240:243]
    ds_read_b128 v[52:55], v23 offset:34816
    v_cndmask_b32 v104, 0, v14, vcc
    s_add_u32 m0, s59, 24576
    s_add_u32 s50, s71, 5267456
    buffer_load_dwordx4 v67, s[20:23], s50 offen sc1 lds
    s_waitcnt lgkmcnt(4)
    v_mfma_f32_16x16x32_bf16 v[228:231], v[176:179], v[36:39], v[228:231]
    ds_read_b128 v[56:59], v23 offset:36864
    v_cndmask_b32 v105, 0, v14, s[52:53]
    v_mfma_f32_16x16x32_bf16 v[244:247], v[180:183], v[36:39], v[244:247]
    ds_read_b128 v[60:63], v23 offset:38912
    v_sub_f32 v120, v14, v104
    s_add_u32 m0, s59, 32768
    s_add_u32 s50, s71, 5275648
    buffer_load_dwordx4 v67, s[20:23], s50 offen sc1 lds
    s_waitcnt lgkmcnt(5)
    v_mfma_f32_16x16x32_bf16 v[232:235], v[176:179], v[40:43], v[232:235]
    v_cmp_le_i32 vcc, 10, v13
    v_mfma_f32_16x16x32_bf16 v[248:251], v[180:183], v[40:43], v[248:251]
    v_cmp_le_i32 s[52:53], 11, v13
    s_add_u32 m0, s59, 40960
    s_add_u32 s50, s71, 5283840
    buffer_load_dwordx4 v67, s[20:23], s50 offen sc1 lds
    s_waitcnt lgkmcnt(4)
    v_mfma_f32_16x16x32_bf16 v[236:239], v[176:179], v[44:47], v[236:239]
    v_sub_f32 v121, v14, v105
    v_mfma_f32_16x16x32_bf16 v[252:255], v[180:183], v[44:47], v[252:255]
    v_cndmask_b32 v106, 0, v14, vcc
    s_add_u32 m0, s59, 49152
    s_add_u32 s50, s71, 5292032
    buffer_load_dwordx4 v67, s[20:23], s50 offen sc1 lds
    s_waitcnt lgkmcnt(3)
    v_mfma_f32_16x16x32_bf16 v[224:227], v[184:187], v[48:51], v[224:227]
    ds_read_b128 v[32:35], v22 offset:49152
    v_cndmask_b32 v107, 0, v14, s[52:53]
    v_mfma_f32_16x16x32_bf16 v[240:243], v[188:191], v[48:51], v[240:243]
    ds_read_b128 v[36:39], v22 offset:51200
    v_sub_f32 v122, v14, v106
    s_waitcnt lgkmcnt(4)
    v_mfma_f32_16x16x32_bf16 v[228:231], v[184:187], v[52:55], v[228:231]
    ds_read_b128 v[40:43], v22 offset:53248
    v_cmp_le_i32 vcc, 12, v13
    v_mfma_f32_16x16x32_bf16 v[244:247], v[188:191], v[52:55], v[244:247]
    ds_read_b128 v[44:47], v22 offset:55296
    v_cmp_le_i32 s[52:53], 13, v13
    s_add_u32 m0, s59, 57344
    s_add_u32 s50, s71, 5300224
    buffer_load_dwordx4 v67, s[20:23], s50 offen sc1 lds
    s_waitcnt lgkmcnt(5)
    v_mfma_f32_16x16x32_bf16 v[232:235], v[184:187], v[56:59], v[232:235]
    v_sub_f32 v123, v14, v107
    v_mfma_f32_16x16x32_bf16 v[248:251], v[188:191], v[56:59], v[248:251]
    v_cndmask_b32 v108, 0, v14, vcc
    s_waitcnt lgkmcnt(4)
    v_mfma_f32_16x16x32_bf16 v[236:239], v[184:187], v[60:63], v[236:239]
    v_cndmask_b32 v109, 0, v14, s[52:53]
    v_mfma_f32_16x16x32_bf16 v[252:255], v[188:191], v[60:63], v[252:255]
    v_sub_f32 v124, v14, v108
    s_add_u32 m0, s59, 65536
    s_add_u32 s50, s71, 5308416
    buffer_load_dwordx4 v67, s[20:23], s50 offen sc1 lds
    s_waitcnt lgkmcnt(3)
    v_mfma_f32_16x16x32_bf16 v[224:227], v[192:195], v[32:35], v[224:227]
    ds_read_b128 v[48:51], v23 offset:49152
    v_cmp_le_i32 vcc, 14, v13
    v_mfma_f32_16x16x32_bf16 v[240:243], v[196:199], v[32:35], v[240:243]
    ds_read_b128 v[52:55], v23 offset:51200
    v_cmp_le_i32 s[52:53], 15, v13
    s_waitcnt lgkmcnt(4)
    v_mfma_f32_16x16x32_bf16 v[228:231], v[192:195], v[36:39], v[228:231]
    ds_read_b128 v[56:59], v23 offset:53248
    v_sub_f32 v125, v14, v109
    v_mfma_f32_16x16x32_bf16 v[244:247], v[196:199], v[36:39], v[244:247]
    ds_read_b128 v[60:63], v23 offset:55296
    v_cndmask_b32 v110, 0, v14, vcc
    s_add_u32 m0, s59, 73728
    s_add_u32 s50, s71, 5316608
    buffer_load_dwordx4 v67, s[20:23], s50 offen sc1 lds
    s_waitcnt lgkmcnt(5)
    v_mfma_f32_16x16x32_bf16 v[232:235], v[192:195], v[40:43], v[232:235]
    v_cndmask_b32 v111, 0, v14, s[52:53]
    v_mfma_f32_16x16x32_bf16 v[248:251], v[196:199], v[40:43], v[248:251]
    v_sub_f32 v126, v14, v110
    s_waitcnt lgkmcnt(4)
    v_mfma_f32_16x16x32_bf16 v[236:239], v[192:195], v[44:47], v[236:239]
    v_sub_f32 v127, v14, v111
    v_mfma_f32_16x16x32_bf16 v[252:255], v[196:199], v[44:47], v[252:255]
    s_waitcnt vmcnt(13)
    s_barrier
    s_waitcnt lgkmcnt(3)
    v_mfma_f32_16x16x32_bf16 v[224:227], v[200:203], v[48:51], v[224:227]
    ds_read_b128 v[32:35], v24 offset:0
    v_mfma_f32_16x16x32_bf16 v[240:243], v[204:207], v[48:51], v[240:243]
    ds_read_b128 v[36:39], v24 offset:2048
    s_waitcnt lgkmcnt(4)
    v_mfma_f32_16x16x32_bf16 v[228:231], v[200:203], v[52:55], v[228:231]
    ds_read_b128 v[40:43], v24 offset:4096
    v_mfma_f32_16x16x32_bf16 v[244:247], v[204:207], v[52:55], v[244:247]
    ds_read_b128 v[44:47], v24 offset:6144
    s_waitcnt lgkmcnt(5)
    v_mfma_f32_16x16x32_bf16 v[232:235], v[200:203], v[56:59], v[232:235]
    v_mfma_f32_16x16x32_bf16 v[248:251], v[204:207], v[56:59], v[248:251]
    s_waitcnt lgkmcnt(4)
    v_mfma_f32_16x16x32_bf16 v[236:239], v[200:203], v[60:63], v[236:239]
    v_mfma_f32_16x16x32_bf16 v[252:255], v[204:207], v[60:63], v[252:255]
    s_waitcnt lgkmcnt(3)
    v_mfma_f32_16x16x32_bf16 v[224:227], v[128:131], v[32:35], v[224:227]
    ds_read_b128 v[48:51], v25 offset:0
    v_mfma_f32_16x16x32_bf16 v[240:243], v[132:135], v[32:35], v[240:243]
    ds_read_b128 v[52:55], v25 offset:2048
    s_waitcnt lgkmcnt(4)
    v_mfma_f32_16x16x32_bf16 v[228:231], v[128:131], v[36:39], v[228:231]
    ds_read_b128 v[56:59], v25 offset:4096
    v_mfma_f32_16x16x32_bf16 v[244:247], v[132:135], v[36:39], v[244:247]
    ds_read_b128 v[60:63], v25 offset:6144
    s_waitcnt lgkmcnt(5)
    v_mfma_f32_16x16x32_bf16 v[232:235], v[128:131], v[40:43], v[232:235]
    v_mfma_f32_16x16x32_bf16 v[248:251], v[132:135], v[40:43], v[248:251]
    s_waitcnt lgkmcnt(4)
    v_mfma_f32_16x16x32_bf16 v[236:239], v[128:131], v[44:47], v[236:239]
    v_mfma_f32_16x16x32_bf16 v[252:255], v[132:135], v[44:47], v[252:255]
    s_waitcnt lgkmcnt(3)
    v_mfma_f32_16x16x32_bf16 v[224:227], v[136:139], v[48:51], v[224:227]
    ds_read_b128 v[32:35], v24 offset:16384
    v_mfma_f32_16x16x32_bf16 v[240:243], v[140:143], v[48:51], v[240:243]
    ds_read_b128 v[36:39], v24 offset:18432
    s_waitcnt lgkmcnt(4)
    v_mfma_f32_16x16x32_bf16 v[228:231], v[136:139], v[52:55], v[228:231]
    ds_read_b128 v[40:43], v24 offset:20480
    v_mfma_f32_16x16x32_bf16 v[244:247], v[140:143], v[52:55], v[244:247]
    ds_read_b128 v[44:47], v24 offset:22528
    s_waitcnt lgkmcnt(5)
    v_mfma_f32_16x16x32_bf16 v[232:235], v[136:139], v[56:59], v[232:235]
    v_mfma_f32_16x16x32_bf16 v[248:251], v[140:143], v[56:59], v[248:251]
    s_waitcnt lgkmcnt(4)
    v_mfma_f32_16x16x32_bf16 v[236:239], v[136:139], v[60:63], v[236:239]
    v_mfma_f32_16x16x32_bf16 v[252:255], v[140:143], v[60:63], v[252:255]
    s_waitcnt lgkmcnt(3)
    v_mfma_f32_16x16x32_bf16 v[224:227], v[208:211], v[32:35], v[224:227]
    ds_read_b128 v[48:51], v25 offset:16384
    v_mfma_f32_16x16x32_bf16 v[240:243], v[212:215], v[32:35], v[240:243]
    ds_read_b128 v[52:55], v25 offset:18432
    s_waitcnt lgkmcnt(4)
    v_mfma_f32_16x16x32_bf16 v[228:231], v[208:211], v[36:39], v[228:231]
    ds_read_b128 v[56:59], v25 offset:20480
    v_mfma_f32_16x16x32_bf16 v[244:247], v[212:215], v[36:39], v[244:247]
    ds_read_b128 v[60:63], v25 offset:22528
    s_waitcnt lgkmcnt(5)
    v_mfma_f32_16x16x32_bf16 v[232:235], v[208:211], v[40:43], v[232:235]
    v_mfma_f32_16x16x32_bf16 v[248:251], v[212:215], v[40:43], v[248:251]
    s_waitcnt lgkmcnt(4)
    v_mfma_f32_16x16x32_bf16 v[236:239], v[208:211], v[44:47], v[236:239]
    v_mfma_f32_16x16x32_bf16 v[252:255], v[212:215], v[44:47], v[252:255]
    s_waitcnt lgkmcnt(3)
    v_mfma_f32_16x16x32_bf16 v[224:227], v[216:219], v[48:51], v[224:227]
    v_mfma_f32_16x16x32_bf16 v[240:243], v[220:223], v[48:51], v[240:243]
    s_waitcnt lgkmcnt(2)
    v_mfma_f32_16x16x32_bf16 v[228:231], v[216:219], v[52:55], v[228:231]
    v_mfma_f32_16x16x32_bf16 v[244:247], v[220:223], v[52:55], v[244:247]
    s_waitcnt lgkmcnt(1)
    v_mfma_f32_16x16x32_bf16 v[232:235], v[216:219], v[56:59], v[232:235]
    v_mfma_f32_16x16x32_bf16 v[248:251], v[220:223], v[56:59], v[248:251]
    s_waitcnt lgkmcnt(0)
    v_mfma_f32_16x16x32_bf16 v[236:239], v[216:219], v[60:63], v[236:239]
    v_mfma_f32_16x16x32_bf16 v[252:255], v[220:223], v[60:63], v[252:255]
    s_branch L_g1epi
L_comp1:
    s_waitcnt lgkmcnt(3)
    v_mfma_f32_16x16x32_bf16 v[224:227], v[32:35], v[64:67], 0
    ds_read_b64_tr_b16 v[72:73], v30 offset:24576
    ds_read_b64_tr_b16 v[74:75], v30 offset:25600
    s_lshl_b32 s48, s42, 2
    v_mfma_f32_16x16x32_bf16 v[240:243], v[32:35], v[68:71], 0
    ds_read_b64_tr_b16 v[76:77], v31 offset:24576
    ds_read_b64_tr_b16 v[78:79], v31 offset:25600
    s_lshr_b32 s49, s40, 2
    s_waitcnt lgkmcnt(6)
    v_mfma_f32_16x16x32_bf16 v[228:231], v[36:39], v[64:67], 0
    ds_read_b128 v[48:51], v25 offset:0
    s_lshl_b32 s49, s49, 1
    v_mfma_f32_16x16x32_bf16 v[244:247], v[36:39], v[68:71], 0
    ds_read_b128 v[52:55], v25 offset:2048
    s_add_u32 s48, s48, s49
    s_add_u32 s15, s44, 2
    s_cmp_ge_u32 s15, 10
    s_cselect_b32 s14, 10, 0
    s_sub_u32 s15, s15, s14
    s_lshl_b32 s14, s15, 7
    s_add_u32 s14, s14, s45
    s_mul_i32 s15, s15, 245760
    s_add_u32 s15, s15, s46
    s_add_u32 m0, s47, 98304
    s_add_u32 s50, s14, 0
    buffer_load_dwordx4 v2, s[4:7], s50 offen lds
    s_waitcnt lgkmcnt(7)
    v_mfma_f32_16x16x32_bf16 v[232:235], v[40:43], v[64:67], 0
    ds_read_b128 v[56:59], v25 offset:4096
    s_lshl_b32 s49, s16, 11
    v_mfma_f32_16x16x32_bf16 v[248:251], v[40:43], v[68:71], 0
    ds_read_b128 v[60:63], v25 offset:6144
    s_add_u32 s48, s48, s49
    s_waitcnt lgkmcnt(8)
    v_mfma_f32_16x16x32_bf16 v[236:239], v[44:47], v[64:67], 0
    s_mul_i32 s52, s43, 52
    v_mfma_f32_16x16x32_bf16 v[252:255], v[44:47], v[68:71], 0
    s_add_u32 m0, s47, 114688
    s_add_u32 s50, s15, 0
    buffer_load_dwordx4 v4, s[8:11], s50 offen lds
    s_add_u32 m0, s47, 99328
    s_add_u32 s50, s14, 10240
    buffer_load_dwordx4 v3, s[4:7], s50 offen lds
    s_add_u32 m0, s47, 115712
    s_add_u32 s50, s15, 15360
    buffer_load_dwordx4 v4, s[8:11], s50 offen lds
    s_waitcnt lgkmcnt(0)
    s_waitcnt vmcnt(4)
    s_barrier
    v_mfma_f32_16x16x32_bf16 v[224:227], v[48:51], v[72:75], v[224:227]
    ds_read_b64_tr_b16 v[80:81], v28 offset:16384
    ds_read_b64_tr_b16 v[82:83], v28 offset:17408
    s_lshr_b32 s52, s52, 8
    v_mfma_f32_16x16x32_bf16 v[240:243], v[48:51], v[76:79], v[240:243]
    ds_read_b64_tr_b16 v[84:85], v29 offset:16384
    ds_read_b64_tr_b16 v[86:87], v29 offset:17408
    s_min_u32 s49, s52, 1
    v_mfma_f32_16x16x32_bf16 v[228:231], v[52:55], v[72:75], v[228:231]
    ds_read_b128 v[32:35], v22 offset:0
    s_lshl_b32 s51, 1280, s49
    v_mfma_f32_16x16x32_bf16 v[244:247], v[52:55], v[76:79], v[244:247]
    ds_read_b128 v[36:39], v22 offset:2048
    s_mul_i32 s54, s48, s51
    s_add_u32 s15, s44, 3
    s_cmp_ge_u32 s15, 10
    s_cselect_b32 s14, 10, 0
    s_sub_u32 s15, s15, s14
    s_lshl_b32 s14, s15, 7
    s_add_u32 s14, s14, s45
    s_mul_i32 s15, s15, 245760
    s_add_u32 s15, s15, s46
    s_add_u32 m0, s47, 131072
    s_add_u32 s50, s14, 0
    buffer_load_dwordx4 v2, s[4:7], s50 offen lds
    v_mfma_f32_16x16x32_bf16 v[232:235], v[56:59], v[72:75], v[232:235]
    ds_read_b128 v[40:43], v22 offset:4096
    s_mul_i32 s48, s49, 5242880
    v_mfma_f32_16x16x32_bf16 v[248:251], v[56:59], v[76:79], v[248:251]
    ds_read_b128 v[44:47], v22 offset:6144
    s_add_u32 s54, s54, s48
    v_mfma_f32_16x16x32_bf16 v[236:239], v[60:63], v[72:75], v[236:239]
    s_mov_b32 s55, s51
    v_mfma_f32_16x16x32_bf16 v[252:255], v[60:63], v[76:79], v[252:255]
    s_add_u32 m0, s47, 147456
    s_add_u32 s50, s15, 0
    buffer_load_dwordx4 v4, s[8:11], s50 offen lds
    s_waitcnt lgkmcnt(3)
    v_mfma_f32_16x16x32_bf16 v[224:227], v[32:35], v[80:83], v[224:227]
    ds_read_b64_tr_b16 v[88:89], v28 offset:24576
    ds_read_b64_tr_b16 v[90:91], v28 offset:25600
    s_lshl_b32 s51, s51, 6
    v_mfma_f32_16x16x32_bf16 v[240:243], v[32:35], v[84:87], v[240:243]
    ds_read_b64_tr_b16 v[92:93], v29 offset:24576
    ds_read_b64_tr_b16 v[94:95], v29 offset:25600
    s_mul_i32 s48, s52, 5
    s_waitcnt lgkmcnt(6)
    v_mfma_f32_16x16x32_bf16 v[228:231], v[36:39], v[80:83], v[228:231]
    ds_read_b128 v[48:51], v23 offset:0
    s_sub_u32 s53, s43, s48
    v_mfma_f32_16x16x32_bf16 v[244:247], v[36:39], v[84:87], v[244:247]
    ds_read_b128 v[52:55], v23 offset:2048
    s_lshl_b32 s48, s53, 5
    s_add_u32 m0, s47, 132096
    s_add_u32 s50, s14, 10240
    buffer_load_dwordx4 v3, s[4:7], s50 offen lds
    s_waitcnt lgkmcnt(7)
    v_mfma_f32_16x16x32_bf16 v[232:235], v[40:43], v[80:83], v[232:235]
    ds_read_b128 v[56:59], v23 offset:4096
    s_lshl_b32 s49, s41, 3
    v_mfma_f32_16x16x32_bf16 v[248:251], v[40:43], v[84:87], v[248:251]
    ds_read_b128 v[60:63], v23 offset:6144
    s_add_u32 s48, s48, s49
    s_waitcnt lgkmcnt(8)
    v_mfma_f32_16x16x32_bf16 v[236:239], v[44:47], v[80:83], v[236:239]
    v_add_u32 v10, s48, v17
    v_mfma_f32_16x16x32_bf16 v[252:255], v[44:47], v[84:87], v[252:255]
    s_add_u32 m0, s47, 148480
    s_add_u32 s50, s15, 15360
    buffer_load_dwordx4 v4, s[8:11], s50 offen lds
    s_waitcnt lgkmcnt(0)
    s_waitcnt vmcnt(4)
    s_barrier
    v_mfma_f32_16x16x32_bf16 v[224:227], v[48:51], v[88:91], v[224:227]
    ds_read_b64_tr_b16 v[96:97], v28 offset:49152
    ds_read_b64_tr_b16 v[98:99], v28 offset:50176
    s_lshl_b32 s48, s48, 2
    v_mfma_f32_16x16x32_bf16 v[240:243], v[48:51], v[92:95], v[240:243]
    ds_read_b64_tr_b16 v[100:101], v29 offset:49152
    ds_read_b64_tr_b16 v[102:103], v29 offset:50176
    v_add_u32 v11, s48, v16
    v_mfma_f32_16x16x32_bf16 v[228:231], v[52:55], v[88:91], v[228:231]
    ds_read_b128 v[32:35], v22 offset:32768
    v_lshlrev_b32 v12, 4, v16
    v_mfma_f32_16x16x32_bf16 v[244:247], v[52:55], v[92:95], v[244:247]
    ds_read_b128 v[36:39], v22 offset:34816
    v_mul_u32_u24 v13, 320, v17
    s_add_u32 s15, s44, 4
    s_cmp_ge_u32 s15, 10
    s_cselect_b32 s14, 10, 0
    s_sub_u32 s15, s15, s14
    s_lshl_b32 s14, s15, 7
    s_add_u32 s14, s14, s45
    s_mul_i32 s15, s15, 245760
    s_add_u32 s15, s15, s46
    s_add_u32 m0, s47, 65536
    s_add_u32 s50, s14, 0
    buffer_load_dwordx4 v2, s[4:7], s50 offen lds
    v_mfma_f32_16x16x32_bf16 v[232:235], v[56:59], v[88:91], v[232:235]
    ds_read_b128 v[40:43], v22 offset:36864
    v_add_u32 v13, 1280, v13
    v_mfma_f32_16x16x32_bf16 v[248:251], v[56:59], v[92:95], v[248:251]
    ds_read_b128 v[44:47], v22 offset:38912
    v_mul_u32_u24 v14, 205, v10
    v_mfma_f32_16x16x32_bf16 v[236:239], v[60:63], v[88:91], v[236:239]
    v_lshrrev_b32 v14, 10, v14
    v_mfma_f32_16x16x32_bf16 v[252:255], v[60:63], v[92:95], v[252:255]
    s_add_u32 m0, s47, 81920
    s_add_u32 s50, s15, 0
    buffer_load_dwordx4 v4, s[8:11], s50 offen lds
    s_waitcnt lgkmcnt(3)
    v_mfma_f32_16x16x32_bf16 v[224:227], v[32:35], v[96:99], v[224:227]
    ds_read_b64_tr_b16 v[104:105], v28 offset:57344
    ds_read_b64_tr_b16 v[106:107], v28 offset:58368
    v_mul_u32_u24 v15, 5, v14
    v_mfma_f32_16x16x32_bf16 v[240:243], v[32:35], v[100:103], v[240:243]
    ds_read_b64_tr_b16 v[108:109], v29 offset:57344
    ds_read_b64_tr_b16 v[110:111], v29 offset:58368
    v_sub_u32 v15, v10, v15
    s_waitcnt lgkmcnt(6)
    v_mfma_f32_16x16x32_bf16 v[228:231], v[36:39], v[96:99], v[228:231]
    ds_read_b128 v[48:51], v23 offset:32768
    v_mul_lo_u32 v14, v14, s51
    v_mfma_f32_16x16x32_bf16 v[244:247], v[36:39], v[100:103], v[244:247]
    ds_read_b128 v[52:55], v23 offset:34816
    v_lshl_add_u32 v15, v15, 8, v12
    s_add_u32 m0, s47, 66560
    s_add_u32 s50, s14, 10240
    buffer_load_dwordx4 v3, s[4:7], s50 offen lds
    s_waitcnt lgkmcnt(7)
    v_mfma_f32_16x16x32_bf16 v[232:235], v[40:43], v[96:99], v[232:235]
    ds_read_b128 v[56:59], v23 offset:36864
    v_add_u32 v18, v14, v15
    v_mfma_f32_16x16x32_bf16 v[248:251], v[40:43], v[100:103], v[248:251]
    ds_read_b128 v[60:63], v23 offset:38912
    v_mul_u32_u24 v14, 3277, v11
    s_waitcnt lgkmcnt(8)
    v_mfma_f32_16x16x32_bf16 v[236:239], v[44:47], v[96:99], v[236:239]
    v_lshrrev_b32 v14, 16, v14
    v_mfma_f32_16x16x32_bf16 v[252:255], v[44:47], v[100:103], v[252:255]
    s_add_u32 m0, s47, 82944
    s_add_u32 s50, s15, 15360
    buffer_load_dwordx4 v4, s[8:11], s50 offen lds
    s_waitcnt lgkmcnt(0)
    s_waitcnt vmcnt(4)
    s_barrier
    v_mfma_f32_16x16x32_bf16 v[224:227], v[48:51], v[104:107], v[224:227]
    ds_read_b64_tr_b16 v[112:113], v30 offset:16384
    ds_read_b64_tr_b16 v[114:115], v30 offset:17408
    v_mul_u32_u24 v15, 20, v14
    s_add_u32 s15, s44, 5
    s_cmp_ge_u32 s15, 10
    s_cselect_b32 s14, 10, 0
    s_sub_u32 s15, s15, s14
    s_lshl_b32 s14, s15, 7
    s_add_u32 s14, s14, s45
    s_mul_i32 s15, s15, 245760
    s_add_u32 s15, s15, s46
    s_add_u32 m0, s47, 98304
    s_add_u32 s50, s14, 0
    buffer_load_dwordx4 v2, s[4:7], s50 offen lds
    v_mfma_f32_16x16x32_bf16 v[240:243], v[48:51], v[108:111], v[240:243]
    ds_read_b64_tr_b16 v[116:117], v31 offset:16384
    ds_read_b64_tr_b16 v[118:119], v31 offset:17408
    v_sub_u32 v15, v11, v15
    s_add_u32 m0, s47, 114688
    s_add_u32 s50, s15, 0
    buffer_load_dwordx4 v4, s[8:11], s50 offen lds
    v_mfma_f32_16x16x32_bf16 v[228:231], v[52:55], v[104:107], v[228:231]
    ds_read_b128 v[32:35], v24 offset:0
    v_mul_lo_u32 v14, v14, s51
    v_mfma_f32_16x16x32_bf16 v[244:247], v[52:55], v[108:111], v[244:247]
    ds_read_b128 v[36:39], v24 offset:2048
    v_lshl_add_u32 v15, v15, 4, v13
    s_add_u32 m0, s47, 99328
    s_add_u32 s50, s14, 10240
    buffer_load_dwordx4 v3, s[4:7], s50 offen lds
    v_mfma_f32_16x16x32_bf16 v[232:235], v[56:59], v[104:107], v[232:235]
    ds_read_b128 v[40:43], v24 offset:4096
    v_add_u32 v1, v14, v15
    v_mfma_f32_16x16x32_bf16 v[248:251], v[56:59], v[108:111], v[248:251]
    ds_read_b128 v[44:47], v24 offset:6144
    v_cmp_le_u32 vcc, 2, s52
    v_mfma_f32_16x16x32_bf16 v[236:239], v[60:63], v[104:107], v[236:239]
    v_add_u32 v10, 4, v10
    v_mfma_f32_16x16x32_bf16 v[252:255], v[60:63], v[108:111], v[252:255]
    s_add_u32 m0, s47, 115712
    s_add_u32 s50, s15, 15360
    buffer_load_dwordx4 v4, s[8:11], s50 offen lds
    s_waitcnt lgkmcnt(3)
    v_mfma_f32_16x16x32_bf16 v[224:227], v[32:35], v[112:115], v[224:227]
    ds_read_b64_tr_b16 v[120:121], v30 offset:24576
    ds_read_b64_tr_b16 v[122:123], v30 offset:25600
    v_add_u32 v11, 16, v11
    v_mfma_f32_16x16x32_bf16 v[240:243], v[32:35], v[116:119], v[240:243]
    ds_read_b64_tr_b16 v[124:125], v31 offset:24576
    ds_read_b64_tr_b16 v[126:127], v31 offset:25600
    v_cndmask_b32 v18, v18, v1, vcc
    s_waitcnt lgkmcnt(6)
    v_mfma_f32_16x16x32_bf16 v[228:231], v[36:39], v[112:115], v[228:231]
    ds_read_b128 v[48:51], v25 offset:0
    v_mul_u32_u24 v14, 205, v10
    v_mfma_f32_16x16x32_bf16 v[244:247], v[36:39], v[116:119], v[244:247]
    ds_read_b128 v[52:55], v25 offset:2048
    v_lshrrev_b32 v14, 10, v14
    s_add_u32 s15, s44, 0
    s_cmp_ge_u32 s15, 10
    s_cselect_b32 s14, 10, 0
    s_sub_u32 s15, s15, s14
    s_lshl_b32 s14, s15, 7
    s_add_u32 s14, s14, s45
    s_add_u32 m0, s47, 0
    s_add_u32 s50, s14, 1310720
    buffer_load_dwordx4 v2, s[4:7], s50 offen lds
    s_waitcnt lgkmcnt(7)
    v_mfma_f32_16x16x32_bf16 v[232:235], v[40:43], v[112:115], v[232:235]
    ds_read_b128 v[56:59], v25 offset:4096
    v_mul_u32_u24 v15, 5, v14
    v_mfma_f32_16x16x32_bf16 v[248:251], v[40:43], v[116:119], v[248:251]
    ds_read_b128 v[60:63], v25 offset:6144
    v_sub_u32 v15, v10, v15
    s_waitcnt lgkmcnt(8)
    v_mfma_f32_16x16x32_bf16 v[236:239], v[44:47], v[112:115], v[236:239]
    v_mul_lo_u32 v14, v14, s51
    v_mfma_f32_16x16x32_bf16 v[252:255], v[44:47], v[116:119], v[252:255]
    s_add_u32 m0, s47, 1024
    s_add_u32 s50, s14, 1320960
    buffer_load_dwordx4 v3, s[4:7], s50 offen lds
    s_waitcnt lgkmcnt(0)
    s_waitcnt vmcnt(6)
    s_barrier
    v_mfma_f32_16x16x32_bf16 v[224:227], v[48:51], v[120:123], v[224:227]
    ds_read_b64_tr_b16 v[128:129], v28 offset:16384
    ds_read_b64_tr_b16 v[130:131], v28 offset:17408
    v_lshl_add_u32 v15, v15, 8, v12
    s_add_u32 s15, s44, 6
    s_cmp_ge_u32 s15, 10
    s_cselect_b32 s14, 10, 0
    s_sub_u32 s15, s15, s14
    s_lshl_b32 s14, s15, 7
    s_add_u32 s14, s14, s45
    s_mul_i32 s15, s15, 245760
    s_add_u32 s15, s15, s46
    s_add_u32 m0, s47, 131072
    s_add_u32 s50, s14, 0
    buffer_load_dwordx4 v2, s[4:7], s50 offen lds
    v_mfma_f32_16x16x32_bf16 v[240:243], v[48:51], v[124:127], v[240:243]
    ds_read_b64_tr_b16 v[132:133], v29 offset:16384
    ds_read_b64_tr_b16 v[134:135], v29 offset:17408
    v_add_u32 v19, v14, v15
    s_add_u32 m0, s47, 147456
    s_add_u32 s50, s15, 0
    buffer_load_dwordx4 v4, s[8:11], s50 offen lds
    v_mfma_f32_16x16x32_bf16 v[228:231], v[52:55], v[120:123], v[228:231]
    ds_read_b128 v[32:35], v22 offset:0
    v_mul_u32_u24 v14, 3277, v11
    v_mfma_f32_16x16x32_bf16 v[244:247], v[52:55], v[124:127], v[244:247]
    ds_read_b128 v[36:39], v22 offset:2048
    v_lshrrev_b32 v14, 16, v14
    s_add_u32 m0, s47, 132096
    s_add_u32 s50, s14, 10240
    buffer_load_dwordx4 v3, s[4:7], s50 offen lds
    v_mfma_f32_16x16x32_bf16 v[232:235], v[56:59], v[120:123], v[232:235]
    ds_read_b128 v[40:43], v22 offset:4096
    v_mul_u32_u24 v15, 20, v14
    v_mfma_f32_16x16x32_bf16 v[248:251], v[56:59], v[124:127], v[248:251]
    ds_read_b128 v[44:47], v22 offset:6144
    v_sub_u32 v15, v11, v15
    v_mfma_f32_16x16x32_bf16 v[236:239], v[60:63], v[120:123], v[236:239]
    v_mul_lo_u32 v14, v14, s51
    v_mfma_f32_16x16x32_bf16 v[252:255], v[60:63], v[124:127], v[252:255]
    s_add_u32 m0, s47, 148480
    s_add_u32 s50, s15, 15360
    buffer_load_dwordx4 v4, s[8:11], s50 offen lds
    s_waitcnt lgkmcnt(3)
    v_mfma_f32_16x16x32_bf16 v[224:227], v[32:35], v[128:131], v[224:227]
    ds_read_b64_tr_b16 v[136:137], v28 offset:24576
    ds_read_b64_tr_b16 v[138:139], v28 offset:25600
    v_lshl_add_u32 v15, v15, 4, v13
    v_mfma_f32_16x16x32_bf16 v[240:243], v[32:35], v[132:135], v[240:243]
    ds_read_b64_tr_b16 v[140:141], v29 offset:24576
    ds_read_b64_tr_b16 v[142:143], v29 offset:25600
    v_add_u32 v1, v14, v15
    s_waitcnt lgkmcnt(6)
    v_mfma_f32_16x16x32_bf16 v[228:231], v[36:39], v[128:131], v[228:231]
    ds_read_b128 v[48:51], v23 offset:0
    v_cmp_le_u32 vcc, 2, s52
    v_mfma_f32_16x16x32_bf16 v[244:247], v[36:39], v[132:135], v[244:247]
    ds_read_b128 v[52:55], v23 offset:2048
    v_add_u32 v10, 4, v10
    s_add_u32 s15, s44, 1
    s_cmp_ge_u32 s15, 10
    s_cselect_b32 s14, 10, 0
    s_sub_u32 s15, s15, s14
    s_lshl_b32 s14, s15, 7
    s_add_u32 s14, s14, s45
    s_add_u32 m0, s47, 16384
    s_add_u32 s50, s14, 1310720
    buffer_load_dwordx4 v2, s[4:7], s50 offen lds
    s_waitcnt lgkmcnt(7)
    v_mfma_f32_16x16x32_bf16 v[232:235], v[40:43], v[128:131], v[232:235]
    ds_read_b128 v[56:59], v23 offset:4096
    v_add_u32 v11, 16, v11
    v_mfma_f32_16x16x32_bf16 v[248:251], v[40:43], v[132:135], v[248:251]
    ds_read_b128 v[60:63], v23 offset:6144
    v_cndmask_b32 v19, v19, v1, vcc
    s_waitcnt lgkmcnt(8)
    v_mfma_f32_16x16x32_bf16 v[236:239], v[44:47], v[128:131], v[236:239]
    s_mul_i32 s48, s53, 205
    v_mfma_f32_16x16x32_bf16 v[252:255], v[44:47], v[132:135], v[252:255]
    s_add_u32 m0, s47, 17408
    s_add_u32 s50, s14, 1320960
    buffer_load_dwordx4 v3, s[4:7], s50 offen lds
    s_waitcnt lgkmcnt(0)
    s_waitcnt vmcnt(8)
    s_barrier
    v_mfma_f32_16x16x32_bf16 v[224:227], v[48:51], v[136:139], v[224:227]
    ds_read_b64_tr_b16 v[144:145], v28 offset:49152
    ds_read_b64_tr_b16 v[146:147], v28 offset:50176
    s_lshr_b32 s48, s48, 5
    s_add_u32 s15, s44, 7
    s_cmp_ge_u32 s15, 10
    s_cselect_b32 s14, 10, 0
    s_sub_u32 s15, s15, s14
    s_lshl_b32 s14, s15, 7
    s_add_u32 s14, s14, s45
    s_mul_i32 s15, s15, 245760
    s_add_u32 s15, s15, s46
    s_add_u32 m0, s47, 65536
    s_add_u32 s50, s14, 0
    buffer_load_dwordx4 v2, s[4:7], s50 offen lds
    v_mfma_f32_16x16x32_bf16 v[240:243], v[48:51], v[140:143], v[240:243]
    ds_read_b64_tr_b16 v[148:149], v29 offset:49152
    ds_read_b64_tr_b16 v[150:151], v29 offset:50176
    s_lshl_b32 s48, s48, 9
    s_add_u32 m0, s47, 81920
    s_add_u32 s50, s15, 0
    buffer_load_dwordx4 v4, s[8:11], s50 offen lds
    v_mfma_f32_16x16x32_bf16 v[228:231], v[52:55], v[136:139], v[228:231]
    ds_read_b128 v[32:35], v22 offset:32768
    s_lshl_b32 s49, s52, 7
    v_mfma_f32_16x16x32_bf16 v[244:247], v[52:55], v[140:143], v[244:247]
    ds_read_b128 v[36:39], v22 offset:34816
    s_add_u32 s48, s48, s49
    s_add_u32 m0, s47, 66560
    s_add_u32 s50, s14, 10240
    buffer_load_dwordx4 v3, s[4:7], s50 offen lds
    v_mfma_f32_16x16x32_bf16 v[232:235], v[56:59], v[136:139], v[232:235]
    ds_read_b128 v[40:43], v22 offset:36864
    s_lshl_b32 s49, s42, 3
    v_mfma_f32_16x16x32_bf16 v[248:251], v[56:59], v[140:143], v[248:251]
    ds_read_b128 v[44:47], v22 offset:38912
    s_add_u32 s48, s48, s49
    v_mfma_f32_16x16x32_bf16 v[236:239], v[60:63], v[136:139], v[236:239]
    s_lshl_b32 s49, s16, 14
    v_mfma_f32_16x16x32_bf16 v[252:255], v[60:63], v[140:143], v[252:255]
    s_add_u32 m0, s47, 82944
    s_add_u32 s50, s15, 15360
    buffer_load_dwordx4 v4, s[8:11], s50 offen lds
    s_waitcnt lgkmcnt(3)
    v_mfma_f32_16x16x32_bf16 v[224:227], v[32:35], v[144:147], v[224:227]
    ds_read_b64_tr_b16 v[152:153], v28 offset:57344
    ds_read_b64_tr_b16 v[154:155], v28 offset:58368
    s_add_u32 s48, s48, s49
    v_mfma_f32_16x16x32_bf16 v[240:243], v[32:35], v[148:151], v[240:243]
    ds_read_b64_tr_b16 v[156:157], v29 offset:57344
    ds_read_b64_tr_b16 v[158:159], v29 offset:58368
    v_lshl_add_u32 v5, v0, 9, s48
    s_waitcnt lgkmcnt(6)
    v_mfma_f32_16x16x32_bf16 v[228:231], v[36:39], v[144:147], v[228:231]
    ds_read_b128 v[48:51], v23 offset:32768
    s_min_u32 s49, s53, 1
    v_mfma_f32_16x16x32_bf16 v[244:247], v[36:39], v[148:151], v[244:247]
    ds_read_b128 v[52:55], v23 offset:34816
    s_lshl_b32 s49, s49, 2
    s_add_u32 s15, s44, 2
    s_cmp_ge_u32 s15, 10
    s_cselect_b32 s14, 10, 0
    s_sub_u32 s15, s15, s14
    s_lshl_b32 s14, s15, 7
    s_add_u32 s14, s14, s45
    s_add_u32 m0, s47, 32768
    s_add_u32 s50, s14, 1310720
    buffer_load_dwordx4 v2, s[4:7], s50 offen lds
    s_waitcnt lgkmcnt(7)
    v_mfma_f32_16x16x32_bf16 v[232:235], v[40:43], v[144:147], v[232:235]
    ds_read_b128 v[56:59], v23 offset:36864
    v_mov_b32 v10, s49
    v_mfma_f32_16x16x32_bf16 v[248:251], v[40:43], v[148:151], v[248:251]
    ds_read_b128 v[60:63], v23 offset:38912
    v_cmp_eq_u32 vcc, 0, v0
    s_waitcnt lgkmcnt(8)
    v_mfma_f32_16x16x32_bf16 v[236:239], v[44:47], v[144:147], v[236:239]
    s_xor_b32 s48, s53, 2
    v_mfma_f32_16x16x32_bf16 v[252:255], v[44:47], v[148:151], v[252:255]
    s_add_u32 m0, s47, 33792
    s_add_u32 s50, s14, 1320960
    buffer_load_dwordx4 v3, s[4:7], s50 offen lds
    s_waitcnt lgkmcnt(0)
    s_waitcnt vmcnt(8)
    s_barrier
    v_mfma_f32_16x16x32_bf16 v[224:227], v[48:51], v[152:155], v[224:227]
    ds_read_b64_tr_b16 v[160:161], v30 offset:16384
    ds_read_b64_tr_b16 v[162:163], v30 offset:17408
    s_min_u32 s48, s48, 1
    s_add_u32 s15, s44, 8
    s_cmp_ge_u32 s15, 10
    s_cselect_b32 s14, 10, 0
    s_sub_u32 s15, s15, s14
    s_lshl_b32 s14, s15, 7
    s_add_u32 s14, s14, s45
    s_mul_i32 s15, s15, 245760
    s_add_u32 s15, s15, s46
    s_add_u32 m0, s47, 98304
    s_add_u32 s50, s14, 0
    buffer_load_dwordx4 v2, s[4:7], s50 offen lds
    v_mfma_f32_16x16x32_bf16 v[240:243], v[48:51], v[156:159], v[240:243]
    ds_read_b64_tr_b16 v[164:165], v31 offset:16384
    ds_read_b64_tr_b16 v[166:167], v31 offset:17408
    v_cndmask_b32 v10, 0, v10, vcc
    s_add_u32 m0, s47, 114688
    s_add_u32 s50, s15, 0
    buffer_load_dwordx4 v4, s[8:11], s50 offen lds
    v_mfma_f32_16x16x32_bf16 v[228:231], v[52:55], v[152:155], v[228:231]
    ds_read_b128 v[32:35], v24 offset:0
    v_add_u32 v5, v10, v5
    v_mfma_f32_16x16x32_bf16 v[244:247], v[52:55], v[156:159], v[244:247]
    ds_read_b128 v[36:39], v24 offset:2048
    s_lshr_b32 s24, 0xff, s48
    s_add_u32 m0, s47, 99328
    s_add_u32 s50, s14, 10240
    buffer_load_dwordx4 v3, s[4:7], s50 offen lds
    v_mfma_f32_16x16x32_bf16 v[232:235], v[56:59], v[152:155], v[232:235]
    ds_read_b128 v[40:43], v24 offset:4096
    s_mov_b32 s25, 0
    v_mfma_f32_16x16x32_bf16 v[248:251], v[56:59], v[156:159], v[248:251]
    ds_read_b128 v[44:47], v24 offset:6144
    s_mul_i32 s48, s56, 20
    v_mfma_f32_16x16x32_bf16 v[236:239], v[60:63], v[152:155], v[236:239]
    s_add_u32 s49, s48, 19
    v_mfma_f32_16x16x32_bf16 v[252:255], v[60:63], v[156:159], v[252:255]
    s_add_u32 m0, s47, 115712
    s_add_u32 s50, s15, 15360
    buffer_load_dwordx4 v4, s[8:11], s50 offen lds
    s_waitcnt lgkmcnt(3)
    v_mfma_f32_16x16x32_bf16 v[224:227], v[32:35], v[160:163], v[224:227]
    ds_read_b64_tr_b16 v[168:169], v30 offset:24576
    ds_read_b64_tr_b16 v[170:171], v30 offset:25600
    s_xor_b32 s48, s48, s49
    v_mfma_f32_16x16x32_bf16 v[240:243], v[32:35], v[164:167], v[240:243]
    ds_read_b64_tr_b16 v[172:173], v31 offset:24576
    ds_read_b64_tr_b16 v[174:175], v31 offset:25600
    s_lshr_b32 s48, s48, 7
    s_waitcnt lgkmcnt(6)
    v_mfma_f32_16x16x32_bf16 v[228:231], v[36:39], v[160:163], v[228:231]
    ds_read_b128 v[48:51], v25 offset:0
    s_min_u32 s48, s48, 1
    v_mfma_f32_16x16x32_bf16 v[244:247], v[36:39], v[164:167], v[244:247]
    ds_read_b128 v[52:55], v25 offset:2048
    s_sub_u32 s26, 0, s48
    s_add_u32 s15, s44, 3
    s_cmp_ge_u32 s15, 10
    s_cselect_b32 s14, 10, 0
    s_sub_u32 s15, s15, s14
    s_lshl_b32 s14, s15, 7
    s_add_u32 s14, s14, s45
    s_add_u32 m0, s47, 49152
    s_add_u32 s50, s14, 1310720
    buffer_load_dwordx4 v2, s[4:7], s50 offen lds
    s_waitcnt lgkmcnt(7)
    v_mfma_f32_16x16x32_bf16 v[232:235], v[40:43], v[160:163], v[232:235]
    ds_read_b128 v[56:59], v25 offset:4096
    s_mov_b32 s27, s26
    v_mfma_f32_16x16x32_bf16 v[248:251], v[40:43], v[164:167], v[248:251]
    ds_read_b128 v[60:63], v25 offset:6144
    s_lshl_b32 s48, s56, 9
    s_waitcnt lgkmcnt(8)
    v_mfma_f32_16x16x32_bf16 v[236:239], v[44:47], v[160:163], v[236:239]
    v_lshl_add_u32 v6, v0, 3, s48
    v_mfma_f32_16x16x32_bf16 v[252:255], v[44:47], v[164:167], v[252:255]
    s_add_u32 m0, s47, 50176
    s_add_u32 s50, s14, 1320960
    buffer_load_dwordx4 v3, s[4:7], s50 offen lds
    s_waitcnt lgkmcnt(0)
    s_waitcnt vmcnt(8)
    s_barrier
    v_mfma_f32_16x16x32_bf16 v[224:227], v[48:51], v[168:171], v[224:227]
    ds_read_b64_tr_b16 v[176:177], v28 offset:16384
    ds_read_b64_tr_b16 v[178:179], v28 offset:17408
    s_lshl_b32 s58, s57, 2
    v_mfma_f32_16x16x32_bf16 v[240:243], v[48:51], v[172:175], v[240:243]
    ds_read_b64_tr_b16 v[180:181], v29 offset:16384
    ds_read_b64_tr_b16 v[182:183], v29 offset:17408
    s_add_u32 s58, s58, s41
    v_mfma_f32_16x16x32_bf16 v[228:231], v[52:55], v[168:171], v[228:231]
    ds_read_b128 v[32:35], v22 offset:0
    s_and_b32 s48, s40, 4
    v_mfma_f32_16x16x32_bf16 v[244:247], v[52:55], v[172:175], v[244:247]
    ds_read_b128 v[36:39], v22 offset:2048
    s_lshl_b32 s48, s48, 3
    s_add_u32 s15, s44, 9
    s_cmp_ge_u32 s15, 10
    s_cselect_b32 s14, 10, 0
    s_sub_u32 s15, s15, s14
    s_lshl_b32 s14, s15, 7
    s_add_u32 s14, s14, s45
    s_mul_i32 s15, s15, 245760
    s_add_u32 s15, s15, s46
    s_add_u32 m0, s47, 131072
    s_add_u32 s50, s14, 0
    buffer_load_dwordx4 v2, s[4:7], s50 offen lds
    v_mfma_f32_16x16x32_bf16 v[232:235], v[56:59], v[168:171], v[232:235]
    ds_read_b128 v[40:43], v22 offset:4096
    s_add_u32 s58, s58, s48
    v_mfma_f32_16x16x32_bf16 v[248:251], v[56:59], v[172:175], v[248:251]
    ds_read_b128 v[44:47], v22 offset:6144
    s_lshl_b32 s59, s40, 10
    v_mfma_f32_16x16x32_bf16 v[236:239], v[60:63], v[168:171], v[236:239]
    s_mov_b32 s60, 0x000fffff
    v_mfma_f32_16x16x32_bf16 v[252:255], v[60:63], v[172:175], v[252:255]
    s_add_u32 m0, s47, 147456
    s_add_u32 s50, s15, 0
    buffer_load_dwordx4 v4, s[8:11], s50 offen lds
    s_waitcnt lgkmcnt(3)
    v_mfma_f32_16x16x32_bf16 v[224:227], v[32:35], v[176:179], v[224:227]
    ds_read_b64_tr_b16 v[184:185], v28 offset:24576
    ds_read_b64_tr_b16 v[186:187], v28 offset:25600
    s_mov_b32 s61, 0x000fffff
    v_mfma_f32_16x16x32_bf16 v[240:243], v[32:35], v[180:183], v[240:243]
    ds_read_b64_tr_b16 v[188:189], v29 offset:24576
    ds_read_b64_tr_b16 v[190:191], v29 offset:25600
    s_mov_b32 s62, -1
    s_waitcnt lgkmcnt(6)
    v_mfma_f32_16x16x32_bf16 v[228:231], v[36:39], v[176:179], v[228:231]
    ds_read_b128 v[48:51], v23 offset:0
    s_mov_b32 s63, 0
    v_mfma_f32_16x16x32_bf16 v[244:247], v[36:39], v[180:183], v[244:247]
    ds_read_b128 v[52:55], v23 offset:2048
    s_mov_b32 s12, 0x00ff00ff
    s_add_u32 m0, s47, 132096
    s_add_u32 s50, s14, 10240
    buffer_load_dwordx4 v3, s[4:7], s50 offen lds
    s_waitcnt lgkmcnt(7)
    v_mfma_f32_16x16x32_bf16 v[232:235], v[40:43], v[176:179], v[232:235]
    ds_read_b128 v[56:59], v23 offset:4096
    s_mov_b32 s13, 0x000000ff
    v_mfma_f32_16x16x32_bf16 v[248:251], v[40:43], v[180:183], v[248:251]
    ds_read_b128 v[60:63], v23 offset:6144
    s_mov_b32 s64, 1051011932
    s_waitcnt lgkmcnt(8)
    v_mfma_f32_16x16x32_bf16 v[236:239], v[44:47], v[176:179], v[236:239]
    s_mov_b32 s65, 0x3f80
    v_mfma_f32_16x16x32_bf16 v[252:255], v[44:47], v[180:183], v[252:255]
    s_add_u32 m0, s47, 148480
    s_add_u32 s50, s15, 15360
    buffer_load_dwordx4 v4, s[8:11], s50 offen lds
    s_waitcnt lgkmcnt(0)
    s_waitcnt vmcnt(6)
    s_barrier
    v_mfma_f32_16x16x32_bf16 v[224:227], v[48:51], v[184:187], v[224:227]
    ds_read_b64_tr_b16 v[192:193], v28 offset:49152
    ds_read_b64_tr_b16 v[194:195], v28 offset:50176
    s_mul_i32 s66, s56, 163840
    v_mfma_f32_16x16x32_bf16 v[240:243], v[48:51], v[188:191], v[240:243]
    ds_read_b64_tr_b16 v[196:197], v29 offset:49152
    ds_read_b64_tr_b16 v[198:199], v29 offset:50176
    s_add_u32 s66, s66, 5242880
    v_mfma_f32_16x16x32_bf16 v[228:231], v[52:55], v[184:187], v[228:231]
    ds_read_b128 v[32:35], v22 offset:32768
    s_add_u32 s71, s66, s59
    v_mfma_f32_16x16x32_bf16 v[244:247], v[52:55], v[188:191], v[244:247]
    ds_read_b128 v[36:39], v22 offset:34816
    s_add_u32 s3, s3, 0x9e3779b1
    s_add_u32 s15, s44, 5
    s_cmp_ge_u32 s15, 10
    s_cselect_b32 s14, 10, 0
    s_sub_u32 s15, s15, s14
    s_lshl_b32 s14, s15, 7
    s_add_u32 s14, s14, s45
    s_add_u32 m0, s47, 65536
    s_add_u32 s50, s14, 1310720
    buffer_load_dwordx4 v2, s[4:7], s50 offen lds
    v_mfma_f32_16x16x32_bf16 v[232:235], v[56:59], v[184:187], v[232:235]
    ds_read_b128 v[40:43], v22 offset:36864
    v_mfma_f32_16x16x32_bf16 v[248:251], v[56:59], v[188:191], v[248:251]
    ds_read_b128 v[44:47], v22 offset:38912
    v_mfma_f32_16x16x32_bf16 v[236:239], v[60:63], v[184:187], v[236:239]
    v_mfma_f32_16x16x32_bf16 v[252:255], v[60:63], v[188:191], v[252:255]
    s_add_u32 m0, s47, 66560
    s_add_u32 s50, s14, 1320960
    buffer_load_dwordx4 v3, s[4:7], s50 offen lds
    s_waitcnt lgkmcnt(3)
    v_mfma_f32_16x16x32_bf16 v[224:227], v[32:35], v[192:195], v[224:227]
    ds_read_b64_tr_b16 v[200:201], v28 offset:57344
    ds_read_b64_tr_b16 v[202:203], v28 offset:58368
    s_mul_i32 s48, s58, 40960
    v_mfma_f32_16x16x32_bf16 v[240:243], v[32:35], v[196:199], v[240:243]
    ds_read_b64_tr_b16 v[204:205], v29 offset:57344
    ds_read_b64_tr_b16 v[206:207], v29 offset:58368
    s_add_u32 s48, s48, 15728640
    s_waitcnt lgkmcnt(6)
    v_mfma_f32_16x16x32_bf16 v[228:231], v[36:39], v[192:195], v[228:231]
    ds_read_b128 v[48:51], v23 offset:32768
    s_lshl_b32 s28, s56, 10
    v_mfma_f32_16x16x32_bf16 v[244:247], v[36:39], v[196:199], v[244:247]
    ds_read_b128 v[52:55], v23 offset:34816
    s_add_u32 s28, s28, s48
    s_add_u32 s15, s44, 6
    s_cmp_ge_u32 s15, 10
    s_cselect_b32 s14, 10, 0
    s_sub_u32 s15, s15, s14
    s_lshl_b32 s14, s15, 7
    s_add_u32 s14, s14, s45
    s_add_u32 m0, s47, 81920
    s_add_u32 s50, s14, 1310720
    buffer_load_dwordx4 v2, s[4:7], s50 offen lds
    s_waitcnt lgkmcnt(7)
    v_mfma_f32_16x16x32_bf16 v[232:235], v[40:43], v[192:195], v[232:235]
    ds_read_b128 v[56:59], v23 offset:36864
    s_lshr_b32 s29, s56, 2
    v_mfma_f32_16x16x32_bf16 v[248:251], v[40:43], v[196:199], v[248:251]
    ds_read_b128 v[60:63], v23 offset:38912
    s_add_u32 s29, s29, 32
    s_waitcnt lgkmcnt(8)
    v_mfma_f32_16x16x32_bf16 v[236:239], v[44:47], v[192:195], v[236:239]
    s_lshl_b32 s29, s29, 10
    v_mfma_f32_16x16x32_bf16 v[252:255], v[44:47], v[196:199], v[252:255]
    s_add_u32 s29, s29, s48
    s_add_u32 m0, s47, 82944
    s_add_u32 s50, s14, 1320960
    buffer_load_dwordx4 v3, s[4:7], s50 offen lds
    s_waitcnt lgkmcnt(0)
    s_waitcnt vmcnt(4)
    s_barrier
    v_mfma_f32_16x16x32_bf16 v[224:227], v[48:51], v[200:203], v[224:227]
    ds_read_b64_tr_b16 v[208:209], v30 offset:16384
    ds_read_b64_tr_b16 v[210:211], v30 offset:17408
    s_and_b32 s48, s56, 1
    v_mfma_f32_16x16x32_bf16 v[240:243], v[48:51], v[204:207], v[240:243]
    ds_read_b64_tr_b16 v[212:213], v31 offset:16384
    ds_read_b64_tr_b16 v[214:215], v31 offset:17408
    s_lshl_b32 s48, s48, 9
    v_mfma_f32_16x16x32_bf16 v[228:231], v[52:55], v[200:203], v[228:231]
    ds_read_b128 v[32:35], v24 offset:0
    s_add_u32 s29, s29, s48
    v_mfma_f32_16x16x32_bf16 v[244:247], v[52:55], v[204:207], v[244:247]
    ds_read_b128 v[36:39], v24 offset:2048
    s_and_b32 s48, s56, 2
    s_add_u32 s15, s44, 7
    s_cmp_ge_u32 s15, 10
    s_cselect_b32 s14, 10, 0
    s_sub_u32 s15, s15, s14
    s_lshl_b32 s14, s15, 7
    s_add_u32 s14, s14, s45
    s_add_u32 m0, s47, 98304
    s_add_u32 s50, s14, 1310720
    buffer_load_dwordx4 v2, s[4:7], s50 offen lds
    v_mfma_f32_16x16x32_bf16 v[232:235], v[56:59], v[200:203], v[232:235]
    ds_read_b128 v[40:43], v24 offset:4096
    s_lshl_b32 s48, s48, 2
    v_mfma_f32_16x16x32_bf16 v[248:251], v[56:59], v[204:207], v[248:251]
    ds_read_b128 v[44:47], v24 offset:6144
    s_add_u32 s29, s29, s48
    v_mfma_f32_16x16x32_bf16 v[236:239], v[60:63], v[200:203], v[236:239]
    s_lshl_b32 s48, s56, 1
    v_mfma_f32_16x16x32_bf16 v[252:255], v[60:63], v[204:207], v[252:255]
    s_lshr_b32 s49, s41, 1
    s_add_u32 m0, s47, 99328
    s_add_u32 s50, s14, 1320960
    buffer_load_dwordx4 v3, s[4:7], s50 offen lds
    s_waitcnt lgkmcnt(3)
    v_mfma_f32_16x16x32_bf16 v[224:227], v[32:35], v[208:211], v[224:227]
    ds_read_b64_tr_b16 v[216:217], v30 offset:24576
    ds_read_b64_tr_b16 v[218:219], v30 offset:25600
    s_add_u32 s48, s48, s49
    v_mfma_f32_16x16x32_bf16 v[240:243], v[32:35], v[212:215], v[240:243]
    ds_read_b64_tr_b16 v[220:221], v31 offset:24576
    ds_read_b64_tr_b16 v[222:223], v31 offset:25600
    s_mul_i32 s48, s48, 40960
    s_waitcnt lgkmcnt(6)
    v_mfma_f32_16x16x32_bf16 v[228:231], v[36:39], v[208:211], v[228:231]
    ds_read_b128 v[48:51], v25 offset:0
    s_and_b32 s49, s41, 1
    v_mfma_f32_16x16x32_bf16 v[244:247], v[36:39], v[212:215], v[244:247]
    ds_read_b128 v[52:55], v25 offset:2048
    s_lshl_b32 s49, s49, 8
    s_add_u32 s15, s44, 8
    s_cmp_ge_u32 s15, 10
    s_cselect_b32 s14, 10, 0
    s_sub_u32 s15, s15, s14
    s_lshl_b32 s14, s15, 7
    s_add_u32 s14, s14, s45
    s_add_u32 m0, s47, 114688
    s_add_u32 s50, s14, 1310720
    buffer_load_dwordx4 v2, s[4:7], s50 offen lds
    s_waitcnt lgkmcnt(7)
    v_mfma_f32_16x16x32_bf16 v[232:235], v[40:43], v[208:211], v[232:235]
    ds_read_b128 v[56:59], v25 offset:4096
    s_add_u32 s48, s48, s49
    v_mfma_f32_16x16x32_bf16 v[248:251], v[40:43], v[212:215], v[248:251]
    ds_read_b128 v[60:63], v25 offset:6144
    s_add_u32 s48, s48, 15728640
    s_waitcnt lgkmcnt(8)
    v_mfma_f32_16x16x32_bf16 v[236:239], v[44:47], v[208:211], v[236:239]
    s_lshr_b32 s49, s40, 2
    v_mfma_f32_16x16x32_bf16 v[252:255], v[44:47], v[212:215], v[252:255]
    s_lshl_b32 s31, s49, 12
    s_add_u32 m0, s47, 115712
    s_add_u32 s50, s14, 1320960
    buffer_load_dwordx4 v3, s[4:7], s50 offen lds
    s_waitcnt lgkmcnt(0)
    s_waitcnt vmcnt(30)
    s_barrier
    v_mfma_f32_16x16x32_bf16 v[224:227], v[48:51], v[216:219], v[224:227]
    ds_read_b128 v[32:35], v20 offset:0
    s_add_u32 s31, s31, s48
    v_mfma_f32_16x16x32_bf16 v[240:243], v[48:51], v[220:223], v[240:243]
    ds_read_b128 v[36:39], v20 offset:2048
    s_add_u32 s31, s31, 32768
    v_mfma_f32_16x16x32_bf16 v[228:231], v[52:55], v[216:219], v[228:231]
    ds_read_b128 v[40:43], v20 offset:4096
    s_mul_i32 s67, s49, 2560
    v_mfma_f32_16x16x32_bf16 v[244:247], v[52:55], v[220:223], v[244:247]
    ds_read_b128 v[44:47], v20 offset:6144
    s_mul_i32 s69, s49, 28160
    v_mfma_f32_16x16x32_bf16 v[232:235], v[56:59], v[216:219], v[232:235]
    s_lshl_b32 s49, s49, 14
    v_mfma_f32_16x16x32_bf16 v[248:251], v[56:59], v[220:223], v[248:251]
    s_add_u32 s30, s48, s49
    v_mfma_f32_16x16x32_bf16 v[236:239], v[60:63], v[216:219], v[236:239]
    s_mul_i32 s48, s41, 2560
    v_mfma_f32_16x16x32_bf16 v[252:255], v[60:63], v[220:223], v[252:255]
    s_add_u32 s69, s69, s48
    s_nop 5
    s_add_u32 s50, s54, s55
    v_cvt_pk_bf16_f32 v48, v224, v225
    v_cvt_pk_bf16_f32 v49, v226, v227
    v_cvt_pk_bf16_f32 v50, v228, v229
    v_cvt_pk_bf16_f32 v51, v230, v231
    buffer_store_dwordx4 v[48:51], v18, s[20:23], s54 offen sc1
    v_cvt_pk_bf16_f32 v52, v232, v233
    v_cvt_pk_bf16_f32 v53, v234, v235
    v_cvt_pk_bf16_f32 v54, v236, v237
    v_cvt_pk_bf16_f32 v55, v238, v239
    buffer_store_dwordx4 v[52:55], v18, s[20:23], s50 offen sc1
    v_cvt_pk_bf16_f32 v56, v240, v241
    v_cvt_pk_bf16_f32 v57, v242, v243
    v_cvt_pk_bf16_f32 v58, v244, v245
    v_cvt_pk_bf16_f32 v59, v246, v247
    buffer_store_dwordx4 v[56:59], v19, s[20:23], s54 offen sc1
    v_cvt_pk_bf16_f32 v60, v248, v249
    v_cvt_pk_bf16_f32 v61, v250, v251
    v_cvt_pk_bf16_f32 v62, v252, v253
    v_cvt_pk_bf16_f32 v63, v254, v255
    buffer_store_dwordx4 v[60:63], v19, s[20:23], s50 offen sc1
    s_lshl_b32 s50, s55, 5
    s_add_u32 s54, s54, s50
    s_waitcnt lgkmcnt(3)
    v_mfma_f32_16x16x32_bf16 v[224:227], v[32:35], v[64:67], 0
    ds_read_b128 v[48:51], v21 offset:0
    s_mul_i32 s34, s57, 102400
    v_mfma_f32_16x16x32_bf16 v[240:243], v[32:35], v[68:71], 0
    ds_read_b128 v[52:55], v21 offset:2048
    s_add_u32 s34, s34, s59
    s_waitcnt lgkmcnt(4)
    v_mfma_f32_16x16x32_bf16 v[228:231], v[36:39], v[64:67], 0
    ds_read_b128 v[56:59], v21 offset:4096
    s_mul_i32 s35, s57, 10240
    v_mfma_f32_16x16x32_bf16 v[244:247], v[36:39], v[68:71], 0
    ds_read_b128 v[60:63], v21 offset:6144
    s_sub_u32 s35, s35, 20480
    s_waitcnt lgkmcnt(5)
    v_mfma_f32_16x16x32_bf16 v[232:235], v[40:43], v[64:67], 0
    s_add_u32 s35, s35, s59
    v_mfma_f32_16x16x32_bf16 v[248:251], v[40:43], v[68:71], 0
    v_lshrrev_b32 v11, 5, v0
    s_waitcnt lgkmcnt(4)
    v_mfma_f32_16x16x32_bf16 v[236:239], v[44:47], v[64:67], 0
    v_and_b32 v12, 31, v0
    v_mfma_f32_16x16x32_bf16 v[252:255], v[44:47], v[68:71], 0
    v_and_b32 v17, 0x1b, v12
    s_waitcnt vmcnt(28)
    s_barrier
    s_waitcnt lgkmcnt(3)
    v_mfma_f32_16x16x32_bf16 v[224:227], v[48:51], v[72:75], v[224:227]
    ds_read_b128 v[32:35], v20 offset:16384
    v_cmp_eq_u32 vcc, 24, v17
    v_mfma_f32_16x16x32_bf16 v[240:243], v[48:51], v[76:79], v[240:243]
    ds_read_b128 v[36:39], v20 offset:18432
    v_mov_b32 v16, 0x3f803f80
    s_waitcnt lgkmcnt(4)
    v_mfma_f32_16x16x32_bf16 v[228:231], v[52:55], v[72:75], v[228:231]
    ds_read_b128 v[40:43], v20 offset:20480
    v_lshlrev_b32 v13, 4, v11
    v_mfma_f32_16x16x32_bf16 v[244:247], v[52:55], v[76:79], v[244:247]
    ds_read_b128 v[44:47], v20 offset:22528
    v_cndmask_b32 v17, 0, v16, vcc
    s_waitcnt lgkmcnt(5)
    v_mfma_f32_16x16x32_bf16 v[232:235], v[56:59], v[72:75], v[232:235]
    v_sub_u32 v13, v12, v13
    v_mfma_f32_16x16x32_bf16 v[248:251], v[56:59], v[76:79], v[248:251]
    v_mov_b32 v14, 4048155338
    s_waitcnt lgkmcnt(4)
    v_mfma_f32_16x16x32_bf16 v[236:239], v[60:63], v[72:75], v[236:239]
    v_mfma_f32_16x16x32_bf16 v[252:255], v[60:63], v[76:79], v[252:255]
    s_waitcnt lgkmcnt(3)
    v_mfma_f32_16x16x32_bf16 v[224:227], v[32:35], v[80:83], v[224:227]
    ds_read_b128 v[48:51], v21 offset:16384
    v_lshlrev_b32 v67, 4, v0
    v_mfma_f32_16x16x32_bf16 v[240:243], v[32:35], v[84:87], v[240:243]
    ds_read_b128 v[52:55], v21 offset:18432
    v_and_b32 v15, 15, v12
    s_waitcnt lgkmcnt(4)
    v_mfma_f32_16x16x32_bf16 v[228:231], v[36:39], v[80:83], v[228:231]
    ds_read_b128 v[56:59], v21 offset:20480
    v_lshlrev_b32 v15, 4, v15
    v_mfma_f32_16x16x32_bf16 v[244:247], v[36:39], v[84:87], v[244:247]
    ds_read_b128 v[60:63], v21 offset:22528
    v_lshrrev_b32 v16, 4, v12
    s_waitcnt lgkmcnt(5)
    v_mfma_f32_16x16x32_bf16 v[232:235], v[40:43], v[80:83], v[232:235]
    v_lshl_add_u32 v15, v16, 3, v15
    v_mfma_f32_16x16x32_bf16 v[248:251], v[40:43], v[84:87], v[248:251]
    v_lshl_add_u32 v68, v11, 8, v15
    s_waitcnt lgkmcnt(4)
    v_mfma_f32_16x16x32_bf16 v[236:239], v[44:47], v[80:83], v[236:239]
    v_and_b32 v10, 3, v12
    v_mfma_f32_16x16x32_bf16 v[252:255], v[44:47], v[84:87], v[252:255]
    v_lshrrev_b32 v15, 3, v12
    s_waitcnt vmcnt(0)
    s_barrier
    s_cmp_lg_u32 s40, 1
    s_cbranch_scc1 L_w_5
    s_cmp_eq_u32 s43, 15
    s_cbranch_scc1 L_w_5
    v_mov_b32 v1, s3
    s_mov_b32 s50, 20971520
    s_mov_b64 exec, s[24:25]
    buffer_store_dword v1, v5, s[20:23], s50 offen sc1
    s_mov_b64 exec, -1
L_w_5:
    s_waitcnt lgkmcnt(3)
    v_mfma_f32_16x16x32_bf16 v[224:227], v[48:51], v[88:91], v[224:227]
    ds_read_b128 v[32:35], v20 offset:32768
    v_lshl_add_u32 v10, v15, 2, v10
    v_mfma_f32_16x16x32_bf16 v[240:243], v[48:51], v[92:95], v[240:243]
    ds_read_b128 v[36:39], v20 offset:34816
    v_bfe_u32 v15, v12, 2, 1
    s_waitcnt lgkmcnt(4)
    v_mfma_f32_16x16x32_bf16 v[228:231], v[52:55], v[88:91], v[228:231]
    ds_read_b128 v[40:43], v20 offset:36864
    v_lshlrev_b32 v10, 4, v10
    v_mfma_f32_16x16x32_bf16 v[244:247], v[52:55], v[92:95], v[244:247]
    ds_read_b128 v[44:47], v20 offset:38912
    v_lshl_add_u32 v16, v15, 3, v10
    s_add_u32 s15, s44, 4
    s_cmp_ge_u32 s15, 10
    s_cselect_b32 s14, 10, 0
    s_sub_u32 s15, s15, s14
    s_lshl_b32 s14, s15, 7
    s_add_u32 s14, s14, s45
    s_add_u32 m0, s47, 131072
    s_add_u32 s50, s14, 1310720
    buffer_load_dwordx4 v2, s[4:7], s50 offen lds
    s_waitcnt lgkmcnt(5)
    v_mfma_f32_16x16x32_bf16 v[232:235], v[56:59], v[88:91], v[232:235]
    v_lshl_add_u32 v16, v11, 8, v16
    v_mfma_f32_16x16x32_bf16 v[248:251], v[56:59], v[92:95], v[248:251]
    v_add_u32 v64, s67, v16
    s_waitcnt lgkmcnt(4)
    v_mfma_f32_16x16x32_bf16 v[236:239], v[60:63], v[88:91], v[236:239]
    v_mul_u32_u24 v16, 20, v11
    v_mfma_f32_16x16x32_bf16 v[252:255], v[60:63], v[92:95], v[252:255]
    v_add_u32 v16, v16, v12
    s_add_u32 m0, s47, 132096
    s_add_u32 s50, s14, 1320960
    buffer_load_dwordx4 v3, s[4:7], s50 offen lds
    s_waitcnt lgkmcnt(3)
    v_mfma_f32_16x16x32_bf16 v[224:227], v[32:35], v[96:99], v[224:227]
    ds_read_b128 v[48:51], v21 offset:32768
    v_lshlrev_b32 v16, 4, v16
    v_mfma_f32_16x16x32_bf16 v[240:243], v[32:35], v[100:103], v[240:243]
    ds_read_b128 v[52:55], v21 offset:34816
    s_add_u32 s48, s67, 1280
    s_waitcnt lgkmcnt(4)
    v_mfma_f32_16x16x32_bf16 v[228:231], v[36:39], v[96:99], v[228:231]
    ds_read_b128 v[56:59], v21 offset:36864
    v_add_u32 v65, s48, v16
    v_mfma_f32_16x16x32_bf16 v[244:247], v[36:39], v[100:103], v[244:247]
    ds_read_b128 v[60:63], v21 offset:38912
    v_mov_b32 v66, 0xdddddddd
    s_add_u32 s15, s44, 9
    s_cmp_ge_u32 s15, 10
    s_cselect_b32 s14, 10, 0
    s_sub_u32 s15, s15, s14
    s_lshl_b32 s14, s15, 7
    s_add_u32 s14, s14, s45
    s_add_u32 m0, s47, 147456
    s_add_u32 s50, s14, 1310720
    buffer_load_dwordx4 v2, s[4:7], s50 offen lds
    s_waitcnt lgkmcnt(5)
    v_mfma_f32_16x16x32_bf16 v[232:235], v[40:43], v[96:99], v[232:235]
    v_lshrrev_b32 v10, 4, v0
    v_mfma_f32_16x16x32_bf16 v[248:251], v[40:43], v[100:103], v[248:251]
    v_lshlrev_b32 v16, 9, v10
    s_waitcnt lgkmcnt(4)
    v_mfma_f32_16x16x32_bf16 v[236:239], v[44:47], v[96:99], v[236:239]
    v_and_b32 v15, 15, v0
    v_mfma_f32_16x16x32_bf16 v[252:255], v[44:47], v[100:103], v[252:255]
    v_lshl_add_u32 v69, v15, 4, v16
    s_add_u32 m0, s47, 148480
    s_add_u32 s50, s14, 1320960
    buffer_load_dwordx4 v3, s[4:7], s50 offen lds
    s_waitcnt lgkmcnt(3)
    v_mfma_f32_16x16x32_bf16 v[224:227], v[48:51], v[104:107], v[224:227]
    ds_read_b128 v[32:35], v20 offset:49152
    v_mul_u32_u24 v15, 2560, v15
    v_mfma_f32_16x16x32_bf16 v[240:243], v[48:51], v[108:111], v[240:243]
    ds_read_b128 v[36:39], v20 offset:51200
    v_lshl_add_u32 v71, v10, 4, v15
    s_waitcnt lgkmcnt(4)
    v_mfma_f32_16x16x32_bf16 v[228:231], v[52:55], v[104:107], v[228:231]
    ds_read_b128 v[40:43], v20 offset:53248
    v_lshl_add_u32 v73, v10, 3, v15
    v_mfma_f32_16x16x32_bf16 v[244:247], v[52:55], v[108:111], v[244:247]
    ds_read_b128 v[44:47], v20 offset:55296
    s_lshl_b32 s48, s67, 1
    s_waitcnt lgkmcnt(5)
    v_mfma_f32_16x16x32_bf16 v[232:235], v[56:59], v[104:107], v[232:235]
    v_add_u32 v70, s48, v67
    v_mfma_f32_16x16x32_bf16 v[248:251], v[56:59], v[108:111], v[248:251]
    s_mul_i32 s48, s41, 5120
    s_waitcnt lgkmcnt(4)
    v_mfma_f32_16x16x32_bf16 v[236:239], v[60:63], v[104:107], v[236:239]
    v_add_u32 v72, s48, v67
    v_mfma_f32_16x16x32_bf16 v[252:255], v[60:63], v[108:111], v[252:255]
    s_and_b32 s48, s56, 14
    s_waitcnt lgkmcnt(3)
    v_mfma_f32_16x16x32_bf16 v[224:227], v[32:35], v[112:115], v[224:227]
    ds_read_b128 v[48:51], v21 offset:49152
    s_lshl_b32 s48, s48, 7
    v_mfma_f32_16x16x32_bf16 v[240:243], v[32:35], v[116:119], v[240:243]
    ds_read_b128 v[52:55], v21 offset:51200
    v_lshl_add_u32 v74, v12, 2, s48
    s_waitcnt lgkmcnt(4)
    v_mfma_f32_16x16x32_bf16 v[228:231], v[36:39], v[112:115], v[228:231]
    ds_read_b128 v[56:59], v21 offset:53248
    v_mov_b32 v76, 0x3f803f80
    v_mfma_f32_16x16x32_bf16 v[244:247], v[36:39], v[116:119], v[244:247]
    ds_read_b128 v[60:63], v21 offset:55296
    v_mov_b32 v77, 0x00003f80
    s_waitcnt lgkmcnt(5)
    v_mfma_f32_16x16x32_bf16 v[232:235], v[40:43], v[112:115], v[232:235]
    v_mov_b32 v78, 0x3f803f80
    v_mfma_f32_16x16x32_bf16 v[248:251], v[40:43], v[116:119], v[248:251]
    v_mov_b32 v79, 0x00003f80
    s_waitcnt lgkmcnt(4)
    v_mfma_f32_16x16x32_bf16 v[236:239], v[44:47], v[112:115], v[236:239]
    v_mov_b32 v80, v17
    v_mfma_f32_16x16x32_bf16 v[252:255], v[44:47], v[116:119], v[252:255]
    v_mov_b32 v81, v17
    s_waitcnt lgkmcnt(3)
    v_mfma_f32_16x16x32_bf16 v[224:227], v[48:51], v[120:123], v[224:227]
    ds_read_b128 v[32:35], v22 offset:0
    v_mov_b32 v82, v17
    v_mfma_f32_16x16x32_bf16 v[240:243], v[48:51], v[124:127], v[240:243]
    ds_read_b128 v[36:39], v22 offset:2048
    v_mov_b32 v83, v17
    s_waitcnt lgkmcnt(4)
    v_mfma_f32_16x16x32_bf16 v[228:231], v[52:55], v[120:123], v[228:231]
    ds_read_b128 v[40:43], v22 offset:4096
    v_mov_b32 v84, v17
    v_mfma_f32_16x16x32_bf16 v[244:247], v[52:55], v[124:127], v[244:247]
    ds_read_b128 v[44:47], v22 offset:6144
    v_mov_b32 v85, v17
    s_waitcnt lgkmcnt(5)
    v_mfma_f32_16x16x32_bf16 v[232:235], v[56:59], v[120:123], v[232:235]
    v_mov_b32 v86, v17
    v_mfma_f32_16x16x32_bf16 v[248:251], v[56:59], v[124:127], v[248:251]
    v_mov_b32 v87, v17
    s_waitcnt lgkmcnt(4)
    v_mfma_f32_16x16x32_bf16 v[236:239], v[60:63], v[120:123], v[236:239]
    v_mov_b32 v88, v17
    v_mfma_f32_16x16x32_bf16 v[252:255], v[60:63], v[124:127], v[252:255]
    v_mov_b32 v89, v17
    s_waitcnt lgkmcnt(3)
    v_mfma_f32_16x16x32_bf16 v[224:227], v[32:35], v[144:147], v[224:227]
    ds_read_b128 v[48:51], v23 offset:0
    v_mov_b32 v90, v17
    v_mfma_f32_16x16x32_bf16 v[240:243], v[32:35], v[148:151], v[240:243]
    ds_read_b128 v[52:55], v23 offset:2048
    v_mov_b32 v91, v17
    s_waitcnt lgkmcnt(4)
    v_mfma_f32_16x16x32_bf16 v[228:231], v[36:39], v[144:147], v[228:231]
    ds_read_b128 v[56:59], v23 offset:4096
    v_mov_b32 v92, v17
    v_mfma_f32_16x16x32_bf16 v[244:247], v[36:39], v[148:151], v[244:247]
    ds_read_b128 v[60:63], v23 offset:6144
    v_mov_b32 v93, v17
    s_waitcnt lgkmcnt(5)
    v_mfma_f32_16x16x32_bf16 v[232:235], v[40:43], v[144:147], v[232:235]
    v_mov_b32 v94, v17
    v_mfma_f32_16x16x32_bf16 v[248:251], v[40:43], v[148:151], v[248:251]
    v_mov_b32 v95, v17
    s_waitcnt lgkmcnt(4)
    v_mfma_f32_16x16x32_bf16 v[236:239], v[44:47], v[144:147], v[236:239]
    v_cmp_le_i32 vcc, 0, v13
    v_mfma_f32_16x16x32_bf16 v[252:255], v[44:47], v[148:151], v[252:255]
    v_cmp_le_i32 s[52:53], 1, v13
    s_cmp_lg_u32 s40, 0
    s_cbranch_scc1 L_w_6
    s_mov_b32 s17, 20987904
    buffer_load_dwordx2 v[8:9], v6, s[20:23], s17 offen sc1
L_w_6:
    s_waitcnt lgkmcnt(3)
    v_mfma_f32_16x16x32_bf16 v[224:227], v[48:51], v[152:155], v[224:227]
    ds_read_b128 v[32:35], v22 offset:16384
    s_nop 0
    v_mfma_f32_16x16x32_bf16 v[240:243], v[48:51], v[156:159], v[240:243]
    ds_read_b128 v[36:39], v22 offset:18432
    v_cndmask_b32 v96, 0, v14, vcc
    s_waitcnt lgkmcnt(4)
    v_mfma_f32_16x16x32_bf16 v[228:231], v[52:55], v[152:155], v[228:231]
    ds_read_b128 v[40:43], v22 offset:20480
    v_cndmask_b32 v97, 0, v14, s[52:53]
    v_mfma_f32_16x16x32_bf16 v[244:247], v[52:55], v[156:159], v[244:247]
    ds_read_b128 v[44:47], v22 offset:22528
    v_sub_f32 v112, v14, v96
    s_waitcnt lgkmcnt(5)
    v_mfma_f32_16x16x32_bf16 v[232:235], v[56:59], v[152:155], v[232:235]
    v_cmp_le_i32 vcc, 2, v13
    v_mfma_f32_16x16x32_bf16 v[248:251], v[56:59], v[156:159], v[248:251]
    v_cmp_le_i32 s[52:53], 3, v13
    s_waitcnt lgkmcnt(4)
    v_mfma_f32_16x16x32_bf16 v[236:239], v[60:63], v[152:155], v[236:239]
    v_sub_f32 v113, v14, v97
    v_mfma_f32_16x16x32_bf16 v[252:255], v[60:63], v[156:159], v[252:255]
    v_cndmask_b32 v98, 0, v14, vcc
    s_waitcnt lgkmcnt(3)
    v_mfma_f32_16x16x32_bf16 v[224:227], v[32:35], v[160:163], v[224:227]
    ds_read_b128 v[48:51], v23 offset:16384
    v_cndmask_b32 v99, 0, v14, s[52:53]
    v_mfma_f32_16x16x32_bf16 v[240:243], v[32:35], v[164:167], v[240:243]
    ds_read_b128 v[52:55], v23 offset:18432
    v_sub_f32 v114, v14, v98
    s_waitcnt lgkmcnt(4)
    v_mfma_f32_16x16x32_bf16 v[228:231], v[36:39], v[160:163], v[228:231]
    ds_read_b128 v[56:59], v23 offset:20480
    v_cmp_le_i32 vcc, 4, v13
    v_mfma_f32_16x16x32_bf16 v[244:247], v[36:39], v[164:167], v[244:247]
    ds_read_b128 v[60:63], v23 offset:22528
    v_cmp_le_i32 s[52:53], 5, v13
    s_waitcnt lgkmcnt(5)
    v_mfma_f32_16x16x32_bf16 v[232:235], v[40:43], v[160:163], v[232:235]
    v_sub_f32 v115, v14, v99
    v_mfma_f32_16x16x32_bf16 v[248:251], v[40:43], v[164:167], v[248:251]
    v_cndmask_b32 v100, 0, v14, vcc
    s_waitcnt lgkmcnt(4)
    v_mfma_f32_16x16x32_bf16 v[236:239], v[44:47], v[160:163], v[236:239]
    v_cndmask_b32 v101, 0, v14, s[52:53]
    v_mfma_f32_16x16x32_bf16 v[252:255], v[44:47], v[164:167], v[252:255]
    v_sub_f32 v116, v14, v100
    s_cmp_lg_u32 s40, 0
    s_cbranch_scc1 L_w_7
    s_mov_b32 s70, 0x20000
    s_waitcnt vmcnt(0)
L_spin_8:
    v_cmp_eq_u32 s[32:33], s3, v8
    v_cmp_eq_u32 s[18:19], s3, v9
    s_orn2_b64 s[18:19], s[18:19], s[26:27]
    s_and_b64 s[32:33], s[32:33], s[18:19]
    s_orn2_b64 s[32:33], s[32:33], s[12:13]
    s_cmp_eq_u64 s[32:33], -1
    s_cbranch_scc1 L_w_7
    s_sleep 4
    s_mov_b32 s17, 20987904
    buffer_load_dwordx2 v[8:9], v6, s[20:23], s17 offen sc1
    s_sub_u32 s70, s70, 1
    s_cmp_lg_u32 s70, 0
    s_waitcnt vmcnt(0)
    s_cbranch_scc1 L_spin_8
L_w_7:
    s_waitcnt vmcnt(8)
    s_barrier
    s_waitcnt lgkmcnt(3)
    v_mfma_f32_16x16x32_bf16 v[224:227], v[48:51], v[168:171], v[224:227]
    ds_read_b128 v[32:35], v22 offset:32768
    v_cmp_le_i32 vcc, 6, v13
    v_mfma_f32_16x16x32_bf16 v[240:243], v[48:51], v[172:175], v[240:243]
    ds_read_b128 v[36:39], v22 offset:34816
    v_cmp_le_i32 s[52:53], 7, v13
    s_mul_i32 s50, s56, 64
    s_and_b32 s17, s58, 31
    s_add_u32 s50, s50, s17
    s_mul_i32 s50, s50, 1280
    s_add_u32 s50, s50, 2621440
    buffer_load_dwordx2 v[144:145], v68, s[20:23], s50 offen sc1
    buffer_load_dwordx2 v[146:147], v68, s[20:23], s50 offen offset:512 sc1
    s_mov_b64 exec, s[62:63]
    buffer_load_dwordx2 v[148:149], v68, s[20:23], s50 offen offset:1024 sc1
    s_mov_b64 exec, -1
    s_waitcnt lgkmcnt(4)
    v_mfma_f32_16x16x32_bf16 v[228:231], v[52:55], v[168:171], v[228:231]
    ds_read_b128 v[40:43], v22 offset:36864
    v_sub_f32 v117, v14, v101
    v_mfma_f32_16x16x32_bf16 v[244:247], v[52:55], v[172:175], v[244:247]
    ds_read_b128 v[44:47], v22 offset:38912
    v_cndmask_b32 v102, 0, v14, vcc
    s_add_u32 m0, s59, 0
    s_add_u32 s50, s71, 5242880
    buffer_load_dwordx4 v67, s[20:23], s50 offen sc1 lds
    s_waitcnt lgkmcnt(5)
    v_mfma_f32_16x16x32_bf16 v[232:235], v[56:59], v[168:171], v[232:235]
    v_cndmask_b32 v103, 0, v14, s[52:53]
    v_mfma_f32_16x16x32_bf16 v[248:251], v[56:59], v[172:175], v[248:251]
    v_sub_f32 v118, v14, v102
    s_add_u32 m0, s59, 8192
    s_add_u32 s50, s71, 5251072
    buffer_load_dwordx4 v67, s[20:23], s50 offen sc1 lds
    s_waitcnt lgkmcnt(4)
    v_mfma_f32_16x16x32_bf16 v[236:239], v[60:63], v[168:171], v[236:239]
    v_cmp_le_i32 vcc, 8, v13
    v_mfma_f32_16x16x32_bf16 v[252:255], v[60:63], v[172:175], v[252:255]
    v_cmp_le_i32 s[52:53], 9, v13
    s_add_u32 m0, s59, 16384
    s_add_u32 s50, s71, 5259264
    buffer_load_dwordx4 v67, s[20:23], s50 offen sc1 lds
    s_waitcnt lgkmcnt(3)
    v_mfma_f32_16x16x32_bf16 v[224:227], v[32:35], v[176:179], v[224:227]
    ds_read_b128 v[48:51], v23 offset:32768
    v_sub_f32 v119, v14, v103
    v_mfma_f32_16x16x32_bf16 v[240:243], v[32:35], v[180:183], v[240:243]
    ds_read_b128 v[52:55], v23 offset:34816
    v_cndmask_b32 v104, 0, v14, vcc
    s_add_u32 m0, s59, 24576
    s_add_u32 s50, s71, 5267456
    buffer_load_dwordx4 v67, s[20:23], s50 offen sc1 lds
    s_waitcnt lgkmcnt(4)
    v_mfma_f32_16x16x32_bf16 v[228:231], v[36:39], v[176:179], v[228:231]
    ds_read_b128 v[56:59], v23 offset:36864
    v_cndmask_b32 v105, 0, v14, s[52:53]
    v_mfma_f32_16x16x32_bf16 v[244:247], v[36:39], v[180:183], v[244:247]
    ds_read_b128 v[60:63], v23 offset:38912
    v_sub_f32 v120, v14, v104
    s_add_u32 m0, s59, 32768
    s_add_u32 s50, s71, 5275648
    buffer_load_dwordx4 v67, s[20:23], s50 offen sc1 lds
    s_waitcnt lgkmcnt(5)
    v_mfma_f32_16x16x32_bf16 v[232:235], v[40:43], v[176:179], v[232:235]
    v_cmp_le_i32 vcc, 10, v13
    v_mfma_f32_16x16x32_bf16 v[248:251], v[40:43], v[180:183], v[248:251]
    v_cmp_le_i32 s[52:53], 11, v13
    s_add_u32 m0, s59, 40960
    s_add_u32 s50, s71, 5283840
    buffer_load_dwordx4 v67, s[20:23], s50 offen sc1 lds
    s_waitcnt lgkmcnt(4)
    v_mfma_f32_16x16x32_bf16 v[236:239], v[44:47], v[176:179], v[236:239]
    v_sub_f32 v121, v14, v105
    v_mfma_f32_16x16x32_bf16 v[252:255], v[44:47], v[180:183], v[252:255]
    v_cndmask_b32 v106, 0, v14, vcc
    s_add_u32 m0, s59, 49152
    s_add_u32 s50, s71, 5292032
    buffer_load_dwordx4 v67, s[20:23], s50 offen sc1 lds
    s_waitcnt lgkmcnt(3)
    v_mfma_f32_16x16x32_bf16 v[224:227], v[48:51], v[184:187], v[224:227]
    ds_read_b128 v[32:35], v22 offset:49152
    v_cndmask_b32 v107, 0, v14, s[52:53]
    v_mfma_f32_16x16x32_bf16 v[240:243], v[48:51], v[188:191], v[240:243]
    ds_read_b128 v[36:39], v22 offset:51200
    v_sub_f32 v122, v14, v106
    s_waitcnt lgkmcnt(4)
    v_mfma_f32_16x16x32_bf16 v[228:231], v[52:55], v[184:187], v[228:231]
    ds_read_b128 v[40:43], v22 offset:53248
    v_cmp_le_i32 vcc, 12, v13
    v_mfma_f32_16x16x32_bf16 v[244:247], v[52:55], v[188:191], v[244:247]
    ds_read_b128 v[44:47], v22 offset:55296
    v_cmp_le_i32 s[52:53], 13, v13
    s_add_u32 m0, s59, 57344
    s_add_u32 s50, s71, 5300224
    buffer_load_dwordx4 v67, s[20:23], s50 offen sc1 lds
    s_waitcnt lgkmcnt(5)
    v_mfma_f32_16x16x32_bf16 v[232:235], v[56:59], v[184:187], v[232:235]
    v_sub_f32 v123, v14, v107
    v_mfma_f32_16x16x32_bf16 v[248:251], v[56:59], v[188:191], v[248:251]
    v_cndmask_b32 v108, 0, v14, vcc
    s_waitcnt lgkmcnt(4)
    v_mfma_f32_16x16x32_bf16 v[236:239], v[60:63], v[184:187], v[236:239]
    v_cndmask_b32 v109, 0, v14, s[52:53]
    v_mfma_f32_16x16x32_bf16 v[252:255], v[60:63], v[188:191], v[252:255]
    v_sub_f32 v124, v14, v108
    s_add_u32 m0, s59, 65536
    s_add_u32 s50, s71, 5308416
    buffer_load_dwordx4 v67, s[20:23], s50 offen sc1 lds
    s_waitcnt lgkmcnt(3)
    v_mfma_f32_16x16x32_bf16 v[224:227], v[32:35], v[192:195], v[224:227]
    ds_read_b128 v[48:51], v23 offset:49152
    v_cmp_le_i32 vcc, 14, v13
    v_mfma_f32_16x16x32_bf16 v[240:243], v[32:35], v[196:199], v[240:243]
    ds_read_b128 v[52:55], v23 offset:51200
    v_cmp_le_i32 s[52:53], 15, v13
    s_waitcnt lgkmcnt(4)
    v_mfma_f32_16x16x32_bf16 v[228:231], v[36:39], v[192:195], v[228:231]
    ds_read_b128 v[56:59], v23 offset:53248
    v_sub_f32 v125, v14, v109
    v_mfma_f32_16x16x32_bf16 v[244:247], v[36:39], v[196:199], v[244:247]
    ds_read_b128 v[60:63], v23 offset:55296
    v_cndmask_b32 v110, 0, v14, vcc
    s_add_u32 m0, s59, 73728
    s_add_u32 s50, s71, 5316608
    buffer_load_dwordx4 v67, s[20:23], s50 offen sc1 lds
    s_waitcnt lgkmcnt(5)
    v_mfma_f32_16x16x32_bf16 v[232:235], v[40:43], v[192:195], v[232:235]
    v_cndmask_b32 v111, 0, v14, s[52:53]
    v_mfma_f32_16x16x32_bf16 v[248:251], v[40:43], v[196:199], v[248:251]
    v_sub_f32 v126, v14, v110
    s_waitcnt lgkmcnt(4)
    v_mfma_f32_16x16x32_bf16 v[236:239], v[44:47], v[192:195], v[236:239]
    v_sub_f32 v127, v14, v111
    v_mfma_f32_16x16x32_bf16 v[252:255], v[44:47], v[196:199], v[252:255]
    s_waitcnt vmcnt(13)
    s_barrier
    s_waitcnt lgkmcnt(3)
    v_mfma_f32_16x16x32_bf16 v[224:227], v[48:51], v[200:203], v[224:227]
    ds_read_b128 v[32:35], v24 offset:0
    v_mfma_f32_16x16x32_bf16 v[240:243], v[48:51], v[204:207], v[240:243]
    ds_read_b128 v[36:39], v24 offset:2048
    s_waitcnt lgkmcnt(4)
    v_mfma_f32_16x16x32_bf16 v[228:231], v[52:55], v[200:203], v[228:231]
    ds_read_b128 v[40:43], v24 offset:4096
    v_mfma_f32_16x16x32_bf16 v[244:247], v[52:55], v[204:207], v[244:247]
    ds_read_b128 v[44:47], v24 offset:6144
    s_waitcnt lgkmcnt(5)
    v_mfma_f32_16x16x32_bf16 v[232:235], v[56:59], v[200:203], v[232:235]
    v_mfma_f32_16x16x32_bf16 v[248:251], v[56:59], v[204:207], v[248:251]
    s_waitcnt lgkmcnt(4)
    v_mfma_f32_16x16x32_bf16 v[236:239], v[60:63], v[200:203], v[236:239]
    v_mfma_f32_16x16x32_bf16 v[252:255], v[60:63], v[204:207], v[252:255]
    s_waitcnt lgkmcnt(3)
    v_mfma_f32_16x16x32_bf16 v[224:227], v[32:35], v[128:131], v[224:227]
    ds_read_b128 v[48:51], v25 offset:0
    v_mfma_f32_16x16x32_bf16 v[240:243], v[32:35], v[132:135], v[240:243]
    ds_read_b128 v[52:55], v25 offset:2048
    s_waitcnt lgkmcnt(4)
    v_mfma_f32_16x16x32_bf16 v[228:231], v[36:39], v[128:131], v[228:231]
    ds_read_b128 v[56:59], v25 offset:4096
    v_mfma_f32_16x16x32_bf16 v[244:247], v[36:39], v[132:135], v[244:247]
    ds_read_b128 v[60:63], v25 offset:6144
    s_waitcnt lgkmcnt(5)
    v_mfma_f32_16x16x32_bf16 v[232:235], v[40:43], v[128:131], v[232:235]
    v_mfma_f32_16x16x32_bf16 v[248:251], v[40:43], v[132:135], v[248:251]
    s_waitcnt lgkmcnt(4)
    v_mfma_f32_16x16x32_bf16 v[236:239], v[44:47], v[128:131], v[236:239]
    v_mfma_f32_16x16x32_bf16 v[252:255], v[44:47], v[132:135], v[252:255]
    s_waitcnt lgkmcnt(3)
    v_mfma_f32_16x16x32_bf16 v[224:227], v[48:51], v[136:139], v[224:227]
    ds_read_b128 v[32:35], v24 offset:16384
    v_mfma_f32_16x16x32_bf16 v[240:243], v[48:51], v[140:143], v[240:243]
    ds_read_b128 v[36:39], v24 offset:18432
    s_waitcnt lgkmcnt(4)
    v_mfma_f32_16x16x32_bf16 v[228:231], v[52:55], v[136:139], v[228:231]
    ds_read_b128 v[40:43], v24 offset:20480
    v_mfma_f32_16x16x32_bf16 v[244:247], v[52:55], v[140:143], v[244:247]
    ds_read_b128 v[44:47], v24 offset:22528
    s_waitcnt lgkmcnt(5)
    v_mfma_f32_16x16x32_bf16 v[232:235], v[56:59], v[136:139], v[232:235]
    v_mfma_f32_16x16x32_bf16 v[248:251], v[56:59], v[140:143], v[248:251]
    s_waitcnt lgkmcnt(4)
    v_mfma_f32_16x16x32_bf16 v[236:239], v[60:63], v[136:139], v[236:239]
    v_mfma_f32_16x16x32_bf16 v[252:255], v[60:63], v[140:143], v[252:255]
    s_waitcnt lgkmcnt(3)
    v_mfma_f32_16x16x32_bf16 v[224:227], v[32:35], v[208:211], v[224:227]
    ds_read_b128 v[48:51], v25 offset:16384
    v_mfma_f32_16x16x32_bf16 v[240:243], v[32:35], v[212:215], v[240:243]
    ds_read_b128 v[52:55], v25 offset:18432
    s_waitcnt lgkmcnt(4)
    v_mfma_f32_16x16x32_bf16 v[228:231], v[36:39], v[208:211], v[228:231]
    ds_read_b128 v[56:59], v25 offset:20480
    v_mfma_f32_16x16x32_bf16 v[244:247], v[36:39], v[212:215], v[244:247]
    ds_read_b128 v[60:63], v25 offset:22528
    s_waitcnt lgkmcnt(5)
    v_mfma_f32_16x16x32_bf16 v[232:235], v[40:43], v[208:211], v[232:235]
    v_mfma_f32_16x16x32_bf16 v[248:251], v[40:43], v[212:215], v[248:251]
    s_waitcnt lgkmcnt(4)
    v_mfma_f32_16x16x32_bf16 v[236:239], v[44:47], v[208:211], v[236:239]
    v_mfma_f32_16x16x32_bf16 v[252:255], v[44:47], v[212:215], v[252:255]
    s_waitcnt lgkmcnt(3)
    v_mfma_f32_16x16x32_bf16 v[224:227], v[48:51], v[216:219], v[224:227]
    v_mfma_f32_16x16x32_bf16 v[240:243], v[48:51], v[220:223], v[240:243]
    s_waitcnt lgkmcnt(2)
    v_mfma_f32_16x16x32_bf16 v[228:231], v[52:55], v[216:219], v[228:231]
    v_mfma_f32_16x16x32_bf16 v[244:247], v[52:55], v[220:223], v[244:247]
    s_waitcnt lgkmcnt(1)
    v_mfma_f32_16x16x32_bf16 v[232:235], v[56:59], v[216:219], v[232:235]
    v_mfma_f32_16x16x32_bf16 v[248:251], v[56:59], v[220:223], v[248:251]
    s_waitcnt lgkmcnt(0)
    v_mfma_f32_16x16x32_bf16 v[236:239], v[60:63], v[216:219], v[236:239]
    v_mfma_f32_16x16x32_bf16 v[252:255], v[60:63], v[220:223], v[252:255]
L_g1epi:
    s_nop 5
    s_add_u32 s50, s54, s55
    v_cvt_pk_bf16_f32 v48, v224, v225
    v_cvt_pk_bf16_f32 v49, v226, v227
    v_cvt_pk_bf16_f32 v50, v228, v229
    v_cvt_pk_bf16_f32 v51, v230, v231
    buffer_store_dwordx4 v[48:51], v18, s[20:23], s54 offen sc1
    v_cvt_pk_bf16_f32 v52, v232, v233
    v_cvt_pk_bf16_f32 v53, v234, v235
    v_cvt_pk_bf16_f32 v54, v236, v237
    v_cvt_pk_bf16_f32 v55, v238, v239
    buffer_store_dwordx4 v[52:55], v18, s[20:23], s50 offen sc1
    v_cvt_pk_bf16_f32 v56, v240, v241
    v_cvt_pk_bf16_f32 v57, v242, v243
    v_cvt_pk_bf16_f32 v58, v244, v245
    v_cvt_pk_bf16_f32 v59, v246, v247
    buffer_store_dwordx4 v[56:59], v19, s[20:23], s54 offen sc1
    v_cvt_pk_bf16_f32 v60, v248, v249
    v_cvt_pk_bf16_f32 v61, v250, v251
    v_cvt_pk_bf16_f32 v62, v252, v253
    v_cvt_pk_bf16_f32 v63, v254, v255
    buffer_store_dwordx4 v[60:63], v19, s[20:23], s50 offen sc1
L_attn:
    s_mov_b32 s46, 528482304
    v_mov_b32 v162, 0
    v_mov_b32 v163, 0
    v_subrev_u32 v46, s67, v64
    v_mov_b32 v44, 0x3f803f80
    v_mov_b32 v45, 0x3f80
    s_waitcnt vmcnt(14)
    v_lshlrev_b32 v15, 16, v144
    v_and_b32 v16, 0xffff0000, v144
    v_mul_f32 v15, s64, v15
    v_mul_f32 v16, s64, v16
    v_cvt_pk_bf16_f32 v144, v15, v16
    v_lshlrev_b32 v15, 16, v145
    v_and_b32 v16, 0xffff0000, v145
    v_mul_f32 v15, s64, v15
    v_mul_f32 v16, s64, v16
    v_cvt_pk_bf16_f32 v145, v15, v16
    v_lshlrev_b32 v15, 16, v146
    v_and_b32 v16, 0xffff0000, v146
    v_mul_f32 v15, s64, v15
    v_mul_f32 v16, s64, v16
    v_cvt_pk_bf16_f32 v146, v15, v16
    v_lshlrev_b32 v15, 16, v147
    v_and_b32 v16, 0xffff0000, v147
    v_mul_f32 v15, s64, v15
    v_mul_f32 v16, s64, v16
    v_cvt_pk_bf16_f32 v147, v15, v16
    v_lshlrev_b32 v15, 16, v148
    v_and_b32 v16, 0xffff0000, v148
    v_mul_f32 v15, s64, v15
    v_mul_f32 v16, s64, v16
    v_cvt_pk_bf16_f32 v148, v15, v16
    v_lshlrev_b32 v15, 16, v149
    v_and_b32 v16, 0xffff0000, v149
    v_mul_f32 v15, s64, v15
    v_mul_f32 v16, s64, v16
    v_cvt_pk_bf16_f32 v149, v15, v16
    v_mov_b32 v15, 0x3f800000
    v_cndmask_b32 v148, 0, v148, s[62:63]
    v_cndmask_b32 v149, v15, v149, s[62:63]
    v_mfma_f32_32x32x8_bf16 v[128:143], v[162:163], v[162:163], 0
    s_waitcnt vmcnt(9)
    s_barrier
    ds_read2st64_b64 v[40:43], v46 offset0:0 offset1:1
    s_mov_b64 exec, s[62:63]
    ds_read_b64 v[44:45], v46 offset:1024
    s_mov_b64 exec, -1
    ds_read2st64_b64 v[164:167], v64 offset0:0 offset1:1
    s_mov_b64 exec, s[62:63]
    ds_read_b64 v[76:77], v64 offset:1024
    s_mov_b64 exec, -1
    ds_read2st64_b64 v[168:171], v64 offset0:10 offset1:11
    s_mov_b64 exec, s[62:63]
    ds_read_b64 v[78:79], v64 offset:6144
    s_mov_b64 exec, -1
    s_waitcnt lgkmcnt(4)
    v_mfma_f32_32x32x16_bf16 v[24:39], v[40:43], v[144:147], 0
    v_mfma_f32_32x32x8_bf16 v[24:39], v[44:45], v[148:149], v[24:39]
    s_nop 11
    v_max3_f32 v2, v24, v25, v26
    v_max3_f32 v2, v2, v27, v28
    v_max3_f32 v2, v2, v29, v30
    v_max3_f32 v2, v2, v31, v32
    v_max3_f32 v2, v2, v33, v34
    v_max3_f32 v2, v2, v35, v36
    v_max3_f32 v2, v2, v37, v38
    v_max_f32 v2, v2, v39
    v_mov_b32 v15, v2
    s_nop 1
    v_permlane32_swap_b32 v15, v2
    s_nop 1
    v_max_f32 v15, v15, v2
    v_sub_f32 v15, 0, v15
    v_lshrrev_b32 v15, 16, v15
    v_cndmask_b32 v148, v15, v148, s[62:63]
    s_waitcnt lgkmcnt(2)
    s_nop 0
    v_mfma_f32_32x32x16_bf16 v[208:223], v[164:167], v[144:147], 0
    v_mfma_f32_32x32x8_bf16 v[208:223], v[76:77], v[148:149], v[208:223]
    s_setprio 3
    s_waitcnt lgkmcnt(0)
    s_nop 10
    v_mfma_f32_32x32x16_bf16 v[224:239], v[168:171], v[144:147], 0
    v_exp_f32 v208, v208
    v_exp_f32 v209, v209
    ds_read2st64_b64 v[164:167], v64 offset0:20 offset1:21
    s_mov_b64 exec, s[62:63]
    ds_read_b64 v[76:77], v64 offset:11264
    s_mov_b64 exec, s[60:61]
    ds_read_b128 v[80:83], v65 offset:0
    ds_read_b128 v[84:87], v65 offset:640
    s_mov_b64 exec, -1
    v_exp_f32 v210, v210
    v_exp_f32 v211, v211
    v_mfma_f32_32x32x8_bf16 v[224:239], v[78:79], v[148:149], v[224:239]
    v_exp_f32 v212, v212
    v_exp_f32 v213, v213
    v_exp_f32 v214, v214
    v_exp_f32 v215, v215
    v_exp_f32 v216, v216
    v_exp_f32 v217, v217
    v_exp_f32 v218, v218
    v_exp_f32 v219, v219
    v_exp_f32 v220, v220
    v_exp_f32 v221, v221
    v_exp_f32 v222, v222
    v_exp_f32 v223, v223
    s_setprio 2
    s_waitcnt lgkmcnt(0)
    v_mfma_f32_32x32x16_bf16 v[240:255], v[164:167], v[144:147], 0
    v_exp_f32 v224, v224
    v_exp_f32 v225, v225
    ds_read2st64_b64 v[168:171], v64 offset0:30 offset1:31
    s_mov_b64 exec, s[62:63]
    ds_read_b64 v[78:79], v64 offset:16384
    s_mov_b64 exec, s[60:61]
    ds_read_b128 v[88:91], v65 offset:5120
    ds_read_b128 v[92:95], v65 offset:5760
    s_mov_b64 exec, -1
    v_exp_f32 v226, v226
    v_exp_f32 v227, v227
    v_smfmac_f32_32x32x32_bf16 v[128:143], v[80:83], v[208:215], v66
    v_exp_f32 v228, v228
    v_exp_f32 v229, v229
    v_exp_f32 v230, v230
    v_exp_f32 v231, v231
    v_mfma_f32_32x32x8_bf16 v[240:255], v[76:77], v[148:149], v[240:255]
    v_exp_f32 v232, v232
    v_exp_f32 v233, v233
    v_exp_f32 v234, v234
    v_exp_f32 v235, v235
    v_smfmac_f32_32x32x32_bf16 v[128:143], v[84:87], v[216:223], v66
    v_exp_f32 v236, v236
    v_exp_f32 v237, v237
    v_exp_f32 v238, v238
    v_exp_f32 v239, v239
    s_setprio 1
    s_waitcnt lgkmcnt(0)
    v_mfma_f32_32x32x16_bf16 v[208:223], v[168:171], v[144:147], 0
    v_exp_f32 v240, v240
    v_exp_f32 v241, v241
    ds_read2st64_b64 v[164:167], v64 offset0:40 offset1:41
    s_mov_b64 exec, s[62:63]
    ds_read_b64 v[76:77], v64 offset:21504
    s_mov_b64 exec, s[60:61]
    ds_read_b128 v[80:83], v65 offset:10240
    ds_read_b128 v[84:87], v65 offset:10880
    s_mov_b64 exec, -1
    v_exp_f32 v242, v242
    v_exp_f32 v243, v243
    v_smfmac_f32_32x32x32_bf16 v[128:143], v[88:91], v[224:231], v66
    v_exp_f32 v244, v244
    v_exp_f32 v245, v245
    v_exp_f32 v246, v246
    v_exp_f32 v247, v247
    v_mfma_f32_32x32x8_bf16 v[208:223], v[78:79], v[148:149], v[208:223]
    v_exp_f32 v248, v248
    v_exp_f32 v249, v249
    v_exp_f32 v250, v250
    v_exp_f32 v251, v251
    v_smfmac_f32_32x32x32_bf16 v[128:143], v[92:95], v[232:239], v66
    v_exp_f32 v252, v252
    v_exp_f32 v253, v253
    v_exp_f32 v254, v254
    v_exp_f32 v255, v255
    s_setprio 0
    s_waitcnt lgkmcnt(0)
    v_mfma_f32_32x32x16_bf16 v[224:239], v[164:167], v[144:147], 0
    v_exp_f32 v208, v208
    v_exp_f32 v209, v209
    ds_read2st64_b64 v[168:171], v64 offset0:50 offset1:51
    s_mov_b64 exec, s[62:63]
    ds_read_b64 v[78:79], v64 offset:26624
    s_mov_b64 exec, s[60:61]
    ds_read_b128 v[88:91], v65 offset:15360
    ds_read_b128 v[92:95], v65 offset:16000
    s_mov_b64 exec, -1
    v_exp_f32 v210, v210
    v_exp_f32 v211, v211
    v_smfmac_f32_32x32x32_bf16 v[128:143], v[80:83], v[240:247], v66
    v_exp_f32 v212, v212
    v_exp_f32 v213, v213
    v_exp_f32 v214, v214
    v_exp_f32 v215, v215
    v_mfma_f32_32x32x8_bf16 v[224:239], v[76:77], v[148:149], v[224:239]
    v_exp_f32 v216, v216
    v_exp_f32 v217, v217
    v_exp_f32 v218, v218
    v_exp_f32 v219, v219
    v_smfmac_f32_32x32x32_bf16 v[128:143], v[84:87], v[248:255], v66
    v_exp_f32 v220, v220
    v_exp_f32 v221, v221
    v_exp_f32 v222, v222
    v_exp_f32 v223, v223
    s_waitcnt vmcnt(0)
    s_barrier
    s_cmp_lg_u32 s40, 1
    s_cbranch_scc1 L_w_12
    s_cmp_eq_u32 s43, 15
    s_cbranch_scc1 L_w_12
    v_mov_b32 v1, s3
    s_mov_b32 s50, 20971584
    s_mov_b64 exec, s[24:25]
    buffer_store_dword v1, v5, s[20:23], s50 offen sc1
    s_mov_b64 exec, -1
L_w_12:
    s_setprio 3
    s_waitcnt lgkmcnt(0)
    v_mfma_f32_32x32x16_bf16 v[240:255], v[168:171], v[144:147], 0
    v_exp_f32 v224, v224
    v_exp_f32 v225, v225
    ds_read2st64_b64 v[164:167], v64 offset0:60 offset1:61
    s_mov_b64 exec, s[62:63]
    ds_read_b64 v[76:77], v64 offset:31744
    s_mov_b64 exec, s[60:61]
    ds_read_b128 v[80:83], v65 offset:20480
    ds_read_b128 v[84:87], v65 offset:21120
    s_mov_b64 exec, -1
    v_exp_f32 v226, v226
    v_exp_f32 v227, v227
    v_smfmac_f32_32x32x32_bf16 v[128:143], v[88:91], v[208:215], v66
    v_exp_f32 v228, v228
    v_exp_f32 v229, v229
    v_exp_f32 v230, v230
    v_exp_f32 v231, v231
    v_mfma_f32_32x32x8_bf16 v[240:255], v[78:79], v[148:149], v[240:255]
    v_exp_f32 v232, v232
    v_exp_f32 v233, v233
    v_exp_f32 v234, v234
    v_exp_f32 v235, v235
    v_smfmac_f32_32x32x32_bf16 v[128:143], v[92:95], v[216:223], v66
    v_exp_f32 v236, v236
    v_exp_f32 v237, v237
    v_exp_f32 v238, v238
    v_exp_f32 v239, v239
    s_setprio 2
    s_waitcnt lgkmcnt(0)
    v_mfma_f32_32x32x16_bf16 v[208:223], v[164:167], v[144:147], 0
    v_exp_f32 v240, v240
    v_exp_f32 v241, v241
    ds_read2st64_b64 v[168:171], v64 offset0:70 offset1:71
    s_mov_b64 exec, s[62:63]
    ds_read_b64 v[78:79], v64 offset:36864
    s_mov_b64 exec, s[60:61]
    ds_read_b128 v[88:91], v65 offset:25600
    ds_read_b128 v[92:95], v65 offset:26240
    s_mov_b64 exec, -1
    v_exp_f32 v242, v242
    v_exp_f32 v243, v243
    v_smfmac_f32_32x32x32_bf16 v[128:143], v[80:83], v[224:231], v66
    v_exp_f32 v244, v244
    v_exp_f32 v245, v245
    v_exp_f32 v246, v246
    v_exp_f32 v247, v247
    v_mfma_f32_32x32x8_bf16 v[208:223], v[76:77], v[148:149], v[208:223]
    v_exp_f32 v248, v248
    v_exp_f32 v249, v249
    v_exp_f32 v250, v250
    v_exp_f32 v251, v251
    v_smfmac_f32_32x32x32_bf16 v[128:143], v[84:87], v[232:239], v66
    v_exp_f32 v252, v252
    v_exp_f32 v253, v253
    v_exp_f32 v254, v254
    v_exp_f32 v255, v255
    s_setprio 1
    s_waitcnt lgkmcnt(0)
    v_mfma_f32_32x32x16_bf16 v[224:239], v[168:171], v[144:147], 0
    v_exp_f32 v208, v208
    v_exp_f32 v209, v209
    v_add_u32 v64, 40960, v64
    ds_read2st64_b64 v[164:167], v64 offset0:0 offset1:1
    s_mov_b64 exec, s[62:63]
    ds_read_b64 v[76:77], v64 offset:1024
    s_mov_b64 exec, s[60:61]
    ds_read_b128 v[80:83], v65 offset:30720
    ds_read_b128 v[84:87], v65 offset:31360
    s_mov_b64 exec, -1
    v_exp_f32 v210, v210
    v_exp_f32 v211, v211
    v_smfmac_f32_32x32x32_bf16 v[128:143], v[88:91], v[240:247], v66
    v_exp_f32 v212, v212
    v_exp_f32 v213, v213
    v_exp_f32 v214, v214
    v_exp_f32 v215, v215
    v_mfma_f32_32x32x8_bf16 v[224:239], v[78:79], v[148:149], v[224:239]
    v_exp_f32 v216, v216
    v_exp_f32 v217, v217
    v_exp_f32 v218, v218
    v_exp_f32 v219, v219
    v_smfmac_f32_32x32x32_bf16 v[128:143], v[92:95], v[248:255], v66
    v_exp_f32 v220, v220
    v_exp_f32 v221, v221
    v_exp_f32 v222, v222
    v_exp_f32 v223, v223
    s_setprio 0
    s_waitcnt lgkmcnt(0)
    v_mfma_f32_32x32x16_bf16 v[240:255], v[164:167], v[144:147], 0
    v_exp_f32 v224, v224
    v_exp_f32 v225, v225
    ds_read2st64_b64 v[168:171], v64 offset0:10 offset1:11
    s_mov_b64 exec, s[62:63]
    ds_read_b64 v[78:79], v64 offset:6144
    s_mov_b64 exec, s[60:61]
    ds_read_b128 v[88:91], v65 offset:35840
    ds_read_b128 v[92:95], v65 offset:36480
    s_mov_b64 exec, -1
    v_exp_f32 v226, v226
    v_exp_f32 v227, v227
    v_smfmac_f32_32x32x32_bf16 v[128:143], v[80:83], v[208:215], v66
    v_exp_f32 v228, v228
    v_exp_f32 v229, v229
    v_exp_f32 v230, v230
    v_exp_f32 v231, v231
    v_mfma_f32_32x32x8_bf16 v[240:255], v[76:77], v[148:149], v[240:255]
    v_exp_f32 v232, v232
    v_exp_f32 v233, v233
    v_exp_f32 v234, v234
    v_exp_f32 v235, v235
    v_smfmac_f32_32x32x32_bf16 v[128:143], v[84:87], v[216:223], v66
    v_exp_f32 v236, v236
    v_exp_f32 v237, v237
    v_exp_f32 v238, v238
    v_exp_f32 v239, v239
    s_cmp_lg_u32 s40, 0
    s_cbranch_scc1 L_w_13
    s_mov_b32 s17, 20987904
    buffer_load_dwordx2 v[8:9], v6, s[20:23], s17 offen sc1
L_w_13:
    s_setprio 3
    s_waitcnt lgkmcnt(0)
    v_mfma_f32_32x32x16_bf16 v[208:223], v[168:171], v[144:147], 0
    v_exp_f32 v240, v240
    v_exp_f32 v241, v241
    v_add_u32 v65, 40960, v65
    ds_read2st64_b64 v[164:167], v64 offset0:20 offset1:21
    s_mov_b64 exec, s[62:63]
    ds_read_b64 v[76:77], v64 offset:11264
    s_mov_b64 exec, s[60:61]
    ds_read_b128 v[80:83], v65 offset:0
    ds_read_b128 v[84:87], v65 offset:640
    s_mov_b64 exec, -1
    v_exp_f32 v242, v242
    v_exp_f32 v243, v243
    v_smfmac_f32_32x32x32_bf16 v[128:143], v[88:91], v[224:231], v66
    v_exp_f32 v244, v244
    v_exp_f32 v245, v245
    v_exp_f32 v246, v246
    v_exp_f32 v247, v247
    v_mfma_f32_32x32x8_bf16 v[208:223], v[78:79], v[148:149], v[208:223]
    v_exp_f32 v248, v248
    v_exp_f32 v249, v249
    v_exp_f32 v250, v250
    v_exp_f32 v251, v251
    v_smfmac_f32_32x32x32_bf16 v[128:143], v[92:95], v[232:239], v66
    v_exp_f32 v252, v252
    v_exp_f32 v253, v253
    v_exp_f32 v254, v254
    v_exp_f32 v255, v255
    s_setprio 2
    s_waitcnt lgkmcnt(0)
    v_mfma_f32_32x32x16_bf16 v[224:239], v[164:167], v[144:147], 0
    v_exp_f32 v208, v208
    v_exp_f32 v209, v209
    ds_read2st64_b64 v[168:171], v64 offset0:30 offset1:31
    s_mov_b64 exec, s[62:63]
    ds_read_b64 v[78:79], v64 offset:16384
    s_mov_b64 exec, s[60:61]
    ds_read_b128 v[88:91], v65 offset:5120
    ds_read_b128 v[92:95], v65 offset:5760
    s_mov_b64 exec, -1
    v_exp_f32 v210, v210
    v_exp_f32 v211, v211
    v_smfmac_f32_32x32x32_bf16 v[128:143], v[80:83], v[240:247], v66
    v_exp_f32 v212, v212
    v_exp_f32 v213, v213
    v_exp_f32 v214, v214
    v_exp_f32 v215, v215
    v_mfma_f32_32x32x8_bf16 v[224:239], v[76:77], v[148:149], v[224:239]
    v_exp_f32 v216, v216
    v_exp_f32 v217, v217
    v_exp_f32 v218, v218
    v_exp_f32 v219, v219
    v_smfmac_f32_32x32x32_bf16 v[128:143], v[84:87], v[248:255], v66
    v_exp_f32 v220, v220
    v_exp_f32 v221, v221
    v_exp_f32 v222, v222
    v_exp_f32 v223, v223
    s_cmp_lg_u32 s40, 0
    s_cbranch_scc1 L_w_14
    s_mov_b32 s70, 0x20000
    s_waitcnt vmcnt(0)
L_spin_15:
    v_cmp_eq_u32 s[32:33], s3, v8
    v_cmp_eq_u32 s[18:19], s3, v9
    s_orn2_b64 s[18:19], s[18:19], s[26:27]
    s_and_b64 s[32:33], s[32:33], s[18:19]
    s_or_b32 s33, s33, 0xffff0000
    s_cmp_eq_u64 s[32:33], -1
    s_cbranch_scc1 L_w_14
    s_sleep 4
    s_mov_b32 s17, 20987904
    buffer_load_dwordx2 v[8:9], v6, s[20:23], s17 offen sc1
    s_sub_u32 s70, s70, 1
    s_cmp_lg_u32 s70, 0
    s_waitcnt vmcnt(0)
    s_cbranch_scc1 L_spin_15
L_w_14:
    s_barrier
    s_setprio 3
    s_waitcnt lgkmcnt(0)
    v_mfma_f32_32x32x16_bf16 v[240:255], v[168:171], v[144:147], 0
    v_exp_f32 v224, v224
    v_exp_f32 v225, v225
    ds_read2st64_b64 v[164:167], v64 offset0:40 offset1:41
    s_mov_b64 exec, s[62:63]
    ds_read_b64 v[76:77], v64 offset:21504
    s_mov_b64 exec, s[60:61]
    ds_read_b128 v[80:83], v65 offset:10240
    ds_read_b128 v[84:87], v65 offset:10880
    s_mov_b64 exec, -1
    v_exp_f32 v226, v226
    v_exp_f32 v227, v227
    v_smfmac_f32_32x32x32_bf16 v[128:143], v[88:91], v[208:215], v66
    v_exp_f32 v228, v228
    v_exp_f32 v229, v229
    s_mul_i32 s50, s56, 64
    s_and_b32 s17, s58, 31
    s_add_u32 s50, s50, s17
    s_mul_i32 s50, s50, 1280
    s_add_u32 s50, s50, 2662400
    buffer_load_dwordx2 v[150:151], v68, s[20:23], s50 offen sc1
    buffer_load_dwordx2 v[152:153], v68, s[20:23], s50 offen offset:512 sc1
    s_mov_b64 exec, s[62:63]
    buffer_load_dwordx2 v[154:155], v68, s[20:23], s50 offen offset:1024 sc1
    s_mov_b64 exec, -1
    v_exp_f32 v230, v230
    v_exp_f32 v231, v231
    v_mfma_f32_32x32x8_bf16 v[240:255], v[78:79], v[148:149], v[240:255]
    v_exp_f32 v232, v232
    v_exp_f32 v233, v233
    v_exp_f32 v234, v234
    v_exp_f32 v235, v235
    v_smfmac_f32_32x32x32_bf16 v[128:143], v[92:95], v[216:223], v66
    v_exp_f32 v236, v236
    v_exp_f32 v237, v237
    v_exp_f32 v238, v238
    v_exp_f32 v239, v239
    s_setprio 2
    s_waitcnt lgkmcnt(0)
    v_mfma_f32_32x32x16_bf16 v[208:223], v[164:167], v[144:147], 0
    v_exp_f32 v240, v240
    v_exp_f32 v241, v241
    ds_read2st64_b64 v[168:171], v64 offset0:50 offset1:51
    s_mov_b64 exec, s[62:63]
    ds_read_b64 v[78:79], v64 offset:26624
    s_mov_b64 exec, s[60:61]
    ds_read_b128 v[88:91], v65 offset:15360
    ds_read_b128 v[92:95], v65 offset:16000
    s_mov_b64 exec, -1
    v_exp_f32 v242, v242
    v_exp_f32 v243, v243
    v_smfmac_f32_32x32x32_bf16 v[128:143], v[80:83], v[224:231], v66
    v_exp_f32 v244, v244
    v_exp_f32 v245, v245
    v_exp_f32 v246, v246
    v_exp_f32 v247, v247
    v_mfma_f32_32x32x8_bf16 v[208:223], v[76:77], v[148:149], v[208:223]
    v_exp_f32 v248, v248
    v_exp_f32 v249, v249
    v_exp_f32 v250, v250
    v_exp_f32 v251, v251
    v_smfmac_f32_32x32x32_bf16 v[128:143], v[84:87], v[232:239], v66
    v_exp_f32 v252, v252
    v_exp_f32 v253, v253
    v_exp_f32 v254, v254
    v_exp_f32 v255, v255
    s_setprio 1
    s_waitcnt lgkmcnt(0)
    v_mfma_f32_32x32x16_bf16 v[224:239], v[168:171], v[144:147], 0
    v_exp_f32 v208, v208
    v_exp_f32 v209, v209
    ds_read2st64_b64 v[164:167], v64 offset0:60 offset1:61
    s_mov_b64 exec, s[62:63]
    ds_read_b64 v[76:77], v64 offset:31744
    s_mov_b64 exec, s[60:61]
    ds_read_b128 v[80:83], v65 offset:20480
    ds_read_b128 v[84:87], v65 offset:21120
    s_mov_b64 exec, -1
    v_exp_f32 v210, v210
    v_exp_f32 v211, v211
    v_smfmac_f32_32x32x32_bf16 v[128:143], v[88:91], v[240:247], v66
    v_exp_f32 v212, v212
    v_exp_f32 v213, v213
    v_exp_f32 v214, v214
    v_exp_f32 v215, v215
    v_mfma_f32_32x32x8_bf16 v[224:239], v[78:79], v[148:149], v[224:239]
    v_exp_f32 v216, v216
    v_exp_f32 v217, v217
    v_exp_f32 v218, v218
    v_exp_f32 v219, v219
    v_smfmac_f32_32x32x32_bf16 v[128:143], v[92:95], v[248:255], v66
    v_exp_f32 v220, v220
    v_exp_f32 v221, v221
    v_exp_f32 v222, v222
    v_exp_f32 v223, v223
    s_setprio 0
    s_waitcnt lgkmcnt(0)
    v_mfma_f32_32x32x16_bf16 v[240:255], v[164:167], v[144:147], 0
    v_exp_f32 v224, v224
    v_exp_f32 v225, v225
    ds_read2st64_b64 v[168:171], v64 offset0:70 offset1:71
    s_mov_b64 exec, s[62:63]
    ds_read_b64 v[78:79], v64 offset:36864
    s_mov_b64 exec, s[60:61]
    ds_read_b128 v[88:91], v65 offset:25600
    ds_read_b128 v[92:95], v65 offset:26240
    s_mov_b64 exec, -1
    v_exp_f32 v226, v226
    v_exp_f32 v227, v227
    v_smfmac_f32_32x32x32_bf16 v[128:143], v[80:83], v[208:215], v66
    v_exp_f32 v228, v228
    v_exp_f32 v229, v229
    s_waitcnt vmcnt(0)
    v_lshlrev_b32 v15, 16, v150
    v_and_b32 v16, 0xffff0000, v150
    v_mul_f32 v15, s64, v15
    v_mul_f32 v16, s64, v16
    v_cvt_pk_bf16_f32 v150, v15, v16
    v_lshlrev_b32 v15, 16, v151
    v_and_b32 v16, 0xffff0000, v151
    v_mul_f32 v15, s64, v15
    v_mul_f32 v16, s64, v16
    v_cvt_pk_bf16_f32 v151, v15, v16
    v_lshlrev_b32 v15, 16, v152
    v_exp_f32 v230, v230
    v_exp_f32 v231, v231
    v_mfma_f32_32x32x8_bf16 v[240:255], v[76:77], v[148:149], v[240:255]
    v_exp_f32 v232, v232
    v_exp_f32 v233, v233
    v_and_b32 v16, 0xffff0000, v152
    v_mul_f32 v15, s64, v15
    v_mul_f32 v16, s64, v16
    v_cvt_pk_bf16_f32 v152, v15, v16
    v_lshlrev_b32 v15, 16, v153
    v_and_b32 v16, 0xffff0000, v153
    v_mul_f32 v15, s64, v15
    v_mul_f32 v16, s64, v16
    v_cvt_pk_bf16_f32 v153, v15, v16
    v_lshlrev_b32 v15, 16, v154
    v_and_b32 v16, 0xffff0000, v154
    v_exp_f32 v234, v234
    v_exp_f32 v235, v235
    v_smfmac_f32_32x32x32_bf16 v[128:143], v[84:87], v[216:223], v66
    v_exp_f32 v236, v236
    v_exp_f32 v237, v237
    v_mul_f32 v15, s64, v15
    v_mul_f32 v16, s64, v16
    v_cvt_pk_bf16_f32 v154, v15, v16
    v_lshlrev_b32 v15, 16, v155
    v_and_b32 v16, 0xffff0000, v155
    v_mul_f32 v15, s64, v15
    v_mul_f32 v16, s64, v16
    v_cvt_pk_bf16_f32 v155, v15, v16
    v_mov_b32 v15, 0x3f800000
    v_cndmask_b32 v154, 0, v154, s[62:63]
    v_cndmask_b32 v155, v15, v155, s[62:63]
    v_exp_f32 v238, v238
    v_exp_f32 v239, v239
    s_setprio 3
    s_waitcnt lgkmcnt(0)
    v_mfma_f32_32x32x16_bf16 v[208:223], v[168:171], v[144:147], 0
    v_exp_f32 v240, v240
    v_exp_f32 v241, v241
    v_add_u32 v64, 4294926336, v64
    ds_read2st64_b64 v[164:167], v64 offset0:0 offset1:1
    s_mov_b64 exec, s[62:63]
    ds_read_b64 v[76:77], v64 offset:1024
    s_mov_b64 exec, s[60:61]
    ds_read_b128 v[80:83], v65 offset:30720
    ds_read_b128 v[84:87], v65 offset:31360
    s_mov_b64 exec, -1
    v_exp_f32 v242, v242
    v_exp_f32 v243, v243
    v_smfmac_f32_32x32x32_bf16 v[128:143], v[88:91], v[224:231], v66
    v_exp_f32 v244, v244
    v_exp_f32 v245, v245
    v_mfma_f32_32x32x16_bf16 v[24:39], v[40:43], v[150:153], 0
    v_mfma_f32_32x32x8_bf16 v[24:39], v[44:45], v[154:155], v[24:39]
    v_exp_f32 v246, v246
    v_exp_f32 v247, v247
    v_mfma_f32_32x32x8_bf16 v[208:223], v[78:79], v[148:149], v[208:223]
    v_exp_f32 v248, v248
    v_exp_f32 v249, v249
    v_exp_f32 v250, v250
    v_exp_f32 v251, v251
    v_smfmac_f32_32x32x32_bf16 v[128:143], v[92:95], v[232:239], v66
    v_exp_f32 v252, v252
    v_exp_f32 v253, v253
    s_nop 1
    v_max3_f32 v2, v24, v25, v26
    v_max3_f32 v2, v2, v27, v28
    v_max3_f32 v2, v2, v29, v30
    v_max3_f32 v2, v2, v31, v32
    v_max3_f32 v2, v2, v33, v34
    v_max3_f32 v2, v2, v35, v36
    v_max3_f32 v2, v2, v37, v38
    v_max_f32 v2, v2, v39
    v_mov_b32 v15, v2
    s_nop 1
    v_permlane32_swap_b32 v15, v2
    s_nop 1
    v_max_f32 v15, v15, v2
    v_sub_f32 v15, 0, v15
    v_lshrrev_b32 v15, 16, v15
    v_cndmask_b32 v154, v15, v154, s[62:63]
    v_exp_f32 v254, v254
    v_exp_f32 v255, v255
    s_setprio 2
    s_waitcnt lgkmcnt(0)
    v_mfma_f32_32x32x16_bf16 v[224:239], v[164:167], v[150:153], 0
    v_exp_f32 v208, v208
    v_exp_f32 v209, v209
    ds_read2st64_b64 v[168:171], v64 offset0:10 offset1:11
    s_mov_b64 exec, s[62:63]
    ds_read_b64 v[78:79], v64 offset:6144
    s_mov_b64 exec, s[60:61]
    ds_read_b128 v[88:91], v65 offset:35840
    ds_read_b128 v[92:95], v65 offset:36480
    s_mov_b64 exec, -1
    v_exp_f32 v210, v210
    v_exp_f32 v211, v211
    v_smfmac_f32_32x32x32_bf16 v[128:143], v[80:83], v[240:247], v66
    v_exp_f32 v212, v212
    v_exp_f32 v213, v213
    v_mfma_f32_32x32x8_bf16 v[172:187], v[162:163], v[162:163], 0
    v_exp_f32 v214, v214
    v_exp_f32 v215, v215
    v_mfma_f32_32x32x8_bf16 v[224:239], v[76:77], v[154:155], v[224:239]
    v_exp_f32 v216, v216
    v_exp_f32 v217, v217
    s_add_u32 m0, s59, 81920
    s_add_u32 s50, s71, 5324800
    buffer_load_dwordx4 v67, s[20:23], s50 offen sc1 lds
    v_exp_f32 v218, v218
    v_exp_f32 v219, v219
    v_smfmac_f32_32x32x32_bf16 v[128:143], v[84:87], v[248:255], v66
    v_exp_f32 v220, v220
    v_exp_f32 v221, v221
    v_exp_f32 v222, v222
    v_exp_f32 v223, v223
    s_setprio 1
    s_waitcnt lgkmcnt(0)
    v_mfma_f32_32x32x16_bf16 v[240:255], v[168:171], v[150:153], 0
    v_exp_f32 v224, v224
    v_exp_f32 v225, v225
    v_add_u32 v65, 4294926336, v65
    ds_read2st64_b64 v[164:167], v64 offset0:20 offset1:21
    s_mov_b64 exec, s[62:63]
    ds_read_b64 v[76:77], v64 offset:11264
    s_mov_b64 exec, s[60:61]
    ds_read_b128 v[80:83], v65 offset:0
    ds_read_b128 v[84:87], v65 offset:640
    s_mov_b64 exec, -1
    v_exp_f32 v226, v226
    v_exp_f32 v227, v227
    v_smfmac_f32_32x32x32_bf16 v[128:143], v[88:91], v[208:215], v66
    v_exp_f32 v228, v228
    v_exp_f32 v229, v229
    v_mov_b32 v18, -1
    v_mov_b32 v19, -1
    v_mov_b32 v20, -1
    v_mov_b32 v21, -1
    v_mov_b32 v22, -1
    v_mov_b32 v23, -1
    v_exp_f32 v230, v230
    v_exp_f32 v231, v231
    v_mfma_f32_32x32x8_bf16 v[240:255], v[78:79], v[154:155], v[240:255]
    v_exp_f32 v232, v232
    v_exp_f32 v233, v233
    s_add_u32 s49, s28, 0
    s_add_u32 s51, s29, 0
    buffer_store_dwordx4 v[18:21], v67, s[20:23], s49 offen sc1
    s_mov_b64 exec, s[62:63]
    buffer_store_dwordx2 v[22:23], v67, s[20:23], s51 offen sc1
    s_mov_b64 exec, -1
    v_exp_f32 v234, v234
    v_exp_f32 v235, v235
    v_smfmac_f32_32x32x32_bf16 v[128:143], v[92:95], v[216:223], v66
    v_exp_f32 v236, v236
    v_exp_f32 v237, v237
    s_add_u32 m0, s59, 90112
    s_add_u32 s50, s71, 5332992
    buffer_load_dwordx4 v67, s[20:23], s50 offen sc1 lds
    v_exp_f32 v238, v238
    v_exp_f32 v239, v239
    s_setprio 0
    s_waitcnt lgkmcnt(0)
    v_mfma_f32_32x32x16_bf16 v[208:223], v[164:167], v[150:153], 0
    v_exp_f32 v240, v240
    v_exp_f32 v241, v241
    ds_read2st64_b64 v[168:171], v64 offset0:30 offset1:31
    s_mov_b64 exec, s[62:63]
    ds_read_b64 v[78:79], v64 offset:16384
    s_mov_b64 exec, s[60:61]
    ds_read_b128 v[88:91], v65 offset:5120
    ds_read_b128 v[92:95], v65 offset:5760
    s_mov_b64 exec, -1
    v_exp_f32 v242, v242
    v_exp_f32 v243, v243
    v_smfmac_f32_32x32x32_bf16 v[172:187], v[80:83], v[224:231], v66
    v_exp_f32 v244, v244
    v_exp_f32 v245, v245
    s_add_u32 s49, s28, 2621440
    s_add_u32 s51, s29, 2621440
    buffer_store_dwordx4 v[18:21], v67, s[20:23], s49 offen sc1
    s_mov_b64 exec, s[62:63]
    buffer_store_dwordx2 v[22:23], v67, s[20:23], s51 offen sc1
    s_mov_b64 exec, -1
    v_exp_f32 v246, v246
    v_exp_f32 v247, v247
    v_mfma_f32_32x32x8_bf16 v[208:223], v[76:77], v[154:155], v[208:223]
    v_exp_f32 v248, v248
    v_exp_f32 v249, v249
    s_add_u32 m0, s59, 98304
    s_add_u32 s50, s71, 5341184
    buffer_load_dwordx4 v67, s[20:23], s50 offen sc1 lds
    v_exp_f32 v250, v250
    v_exp_f32 v251, v251
    v_smfmac_f32_32x32x32_bf16 v[172:187], v[84:87], v[232:239], v66
    v_exp_f32 v252, v252
    v_exp_f32 v253, v253
    v_exp_f32 v254, v254
    v_exp_f32 v255, v255
    s_setprio 3
    s_waitcnt lgkmcnt(0)
    v_mfma_f32_32x32x16_bf16 v[224:239], v[168:171], v[150:153], 0
    v_exp_f32 v208, v208
    v_exp_f32 v209, v209
    ds_read2st64_b64 v[164:167], v64 offset0:40 offset1:41
    s_mov_b64 exec, s[62:63]
    ds_read_b64 v[76:77], v64 offset:21504
    s_mov_b64 exec, s[60:61]
    ds_read_b128 v[80:83], v65 offset:10240
    ds_read_b128 v[84:87], v65 offset:10880
    s_mov_b64 exec, -1
    v_exp_f32 v210, v210
    v_exp_f32 v211, v211
    v_smfmac_f32_32x32x32_bf16 v[172:187], v[88:91], v[240:247], v66
    v_exp_f32 v212, v212
    v_exp_f32 v213, v213
    s_add_u32 m0, s59, 106496
    s_add_u32 s50, s71, 5349376
    buffer_load_dwordx4 v67, s[20:23], s50 offen sc1 lds
    v_exp_f32 v214, v214
    v_exp_f32 v215, v215
    v_mfma_f32_32x32x8_bf16 v[224:239], v[78:79], v[154:155], v[224:239]
    v_exp_f32 v216, v216
    v_exp_f32 v217, v217
    v_exp_f32 v218, v218
    v_exp_f32 v219, v219
    v_smfmac_f32_32x32x32_bf16 v[172:187], v[92:95], v[248:255], v66
    v_exp_f32 v220, v220
    v_exp_f32 v221, v221
    v_exp_f32 v222, v222
    v_exp_f32 v223, v223
    s_setprio 2
    s_waitcnt lgkmcnt(0)
    v_mfma_f32_32x32x16_bf16 v[240:255], v[164:167], v[150:153], 0
    v_exp_f32 v224, v224
    v_exp_f32 v225, v225
    ds_read2st64_b64 v[168:171], v64 offset0:50 offset1:51
    s_mov_b64 exec, s[62:63]
    ds_read_b64 v[78:79], v64 offset:26624
    s_mov_b64 exec, s[60:61]
    ds_read_b128 v[88:91], v65 offset:15360
    ds_read_b128 v[92:95], v65 offset:16000
    s_mov_b64 exec, -1
    v_exp_f32 v226, v226
    v_exp_f32 v227, v227
    v_smfmac_f32_32x32x32_bf16 v[172:187], v[80:83], v[208:215], v66
    v_exp_f32 v228, v228
    v_exp_f32 v229, v229
    s_add_u32 m0, s59, 114688
    s_add_u32 s50, s71, 5357568
    buffer_load_dwordx4 v67, s[20:23], s50 offen sc1 lds
    v_exp_f32 v230, v230
    v_exp_f32 v231, v231
    v_mfma_f32_32x32x8_bf16 v[240:255], v[76:77], v[154:155], v[240:255]
    v_exp_f32 v232, v232
    v_exp_f32 v233, v233
    v_exp_f32 v234, v234
    v_exp_f32 v235, v235
    v_smfmac_f32_32x32x32_bf16 v[172:187], v[84:87], v[216:223], v66
    v_exp_f32 v236, v236
    v_exp_f32 v237, v237
    v_exp_f32 v238, v238
    v_exp_f32 v239, v239
    s_setprio 1
    s_waitcnt lgkmcnt(0)
    v_mfma_f32_32x32x16_bf16 v[208:223], v[168:171], v[150:153], 0
    v_exp_f32 v240, v240
    v_exp_f32 v241, v241
    ds_read2st64_b64 v[164:167], v64 offset0:60 offset1:61
    s_mov_b64 exec, s[62:63]
    ds_read_b64 v[76:77], v64 offset:31744
    s_mov_b64 exec, s[60:61]
    ds_read_b128 v[80:83], v65 offset:20480
    ds_read_b128 v[84:87], v65 offset:21120
    s_mov_b64 exec, -1
    v_exp_f32 v242, v242
    v_exp_f32 v243, v243
    v_smfmac_f32_32x32x32_bf16 v[172:187], v[88:91], v[224:231], v66
    v_exp_f32 v244, v244
    v_exp_f32 v245, v245
    s_add_u32 m0, s59, 122880
    s_add_u32 s50, s71, 5365760
    buffer_load_dwordx4 v67, s[20:23], s50 offen sc1 lds
    v_exp_f32 v246, v246
    v_exp_f32 v247, v247
    v_mfma_f32_32x32x8_bf16 v[208:223], v[78:79], v[154:155], v[208:223]
    v_exp_f32 v248, v248
    v_exp_f32 v249, v249
    v_exp_f32 v250, v250
    v_exp_f32 v251, v251
    v_smfmac_f32_32x32x32_bf16 v[172:187], v[92:95], v[232:239], v66
    v_exp_f32 v252, v252
    v_exp_f32 v253, v253
    v_exp_f32 v254, v254
    v_exp_f32 v255, v255
    s_setprio 0
    s_waitcnt lgkmcnt(0)
    v_mfma_f32_32x32x16_bf16 v[224:239], v[164:167], v[150:153], 0
    v_exp_f32 v208, v208
    v_exp_f32 v209, v209
    ds_read2st64_b64 v[168:171], v64 offset0:70 offset1:71
    s_mov_b64 exec, s[62:63]
    ds_read_b64 v[78:79], v64 offset:36864
    s_mov_b64 exec, s[60:61]
    ds_read_b128 v[88:91], v65 offset:25600
    ds_read_b128 v[92:95], v65 offset:26240
    s_mov_b64 exec, -1
    v_exp_f32 v210, v210
    v_exp_f32 v211, v211
    v_smfmac_f32_32x32x32_bf16 v[172:187], v[80:83], v[240:247], v66
    v_exp_f32 v212, v212
    v_exp_f32 v213, v213
    s_add_u32 m0, s59, 131072
    s_add_u32 s50, s71, 5373952
    buffer_load_dwordx4 v67, s[20:23], s50 offen sc1 lds
    v_exp_f32 v214, v214
    v_exp_f32 v215, v215
    v_mfma_f32_32x32x8_bf16 v[224:239], v[76:77], v[154:155], v[224:239]
    v_exp_f32 v216, v216
    v_exp_f32 v217, v217
    v_exp_f32 v218, v218
    v_exp_f32 v219, v219
    v_smfmac_f32_32x32x32_bf16 v[172:187], v[84:87], v[248:255], v66
    v_exp_f32 v220, v220
    v_exp_f32 v221, v221
    v_exp_f32 v222, v222
    v_exp_f32 v223, v223
    s_setprio 3
    s_waitcnt lgkmcnt(0)
    v_mfma_f32_32x32x16_bf16 v[240:255], v[168:171], v[150:153], 0
    v_exp_f32 v224, v224
    v_exp_f32 v225, v225
    v_add_u32 v64, 40960, v64
    ds_read2st64_b64 v[164:167], v64 offset0:0 offset1:1
    s_mov_b64 exec, s[62:63]
    ds_read_b64 v[76:77], v64 offset:1024
    s_mov_b64 exec, s[60:61]
    ds_read_b128 v[80:83], v65 offset:30720
    ds_read_b128 v[84:87], v65 offset:31360
    s_mov_b64 exec, -1
    v_exp_f32 v226, v226
    v_exp_f32 v227, v227
    v_smfmac_f32_32x32x32_bf16 v[172:187], v[88:91], v[208:215], v66
    v_exp_f32 v228, v228
    v_exp_f32 v229, v229
    s_add_u32 m0, s59, 139264
    s_add_u32 s50, s71, 5382144
    buffer_load_dwordx4 v67, s[20:23], s50 offen sc1 lds
    v_exp_f32 v230, v230
    v_exp_f32 v231, v231
    v_mfma_f32_32x32x8_bf16 v[240:255], v[78:79], v[154:155], v[240:255]
    v_exp_f32 v232, v232
    v_exp_f32 v233, v233
    v_exp_f32 v234, v234
    v_exp_f32 v235, v235
    v_smfmac_f32_32x32x32_bf16 v[172:187], v[92:95], v[216:223], v66
    v_exp_f32 v236, v236
    v_exp_f32 v237, v237
    v_exp_f32 v238, v238
    v_exp_f32 v239, v239
    s_setprio 2
    s_waitcnt lgkmcnt(0)
    v_mfma_f32_32x32x16_bf16 v[208:223], v[164:167], v[150:153], 0
    v_exp_f32 v240, v240
    v_exp_f32 v241, v241
    ds_read2st64_b64 v[168:171], v64 offset0:10 offset1:11
    s_mov_b64 exec, s[62:63]
    ds_read_b64 v[78:79], v64 offset:6144
    s_mov_b64 exec, s[60:61]
    ds_read_b128 v[88:91], v65 offset:35840
    ds_read_b128 v[92:95], v65 offset:36480
    s_mov_b64 exec, -1
    v_exp_f32 v242, v242
    v_exp_f32 v243, v243
    v_smfmac_f32_32x32x32_bf16 v[172:187], v[80:83], v[224:231], v66
    v_exp_f32 v244, v244
    v_exp_f32 v245, v245
    s_add_u32 m0, s59, 147456
    s_add_u32 s50, s71, 5390336
    buffer_load_dwordx4 v67, s[20:23], s50 offen sc1 lds
    v_exp_f32 v246, v246
    v_exp_f32 v247, v247
    v_mfma_f32_32x32x8_bf16 v[208:223], v[76:77], v[154:155], v[208:223]
    v_exp_f32 v248, v248
    v_exp_f32 v249, v249
    v_exp_f32 v250, v250
    v_exp_f32 v251, v251
    v_smfmac_f32_32x32x32_bf16 v[172:187], v[84:87], v[232:239], v66
    v_exp_f32 v252, v252
    v_exp_f32 v253, v253
    v_exp_f32 v254, v254
    v_exp_f32 v255, v255
    s_setprio 1
    s_waitcnt lgkmcnt(0)
    v_mfma_f32_32x32x16_bf16 v[224:239], v[168:171], v[150:153], 0
    v_exp_f32 v208, v208
    v_exp_f32 v209, v209
    v_add_u32 v65, 40960, v65
    ds_read2st64_b64 v[164:167], v64 offset0:20 offset1:21
    s_mov_b64 exec, s[62:63]
    ds_read_b64 v[76:77], v64 offset:11264
    s_mov_b64 exec, s[60:61]
    ds_read_b128 v[80:83], v65 offset:0
    ds_read_b128 v[84:87], v65 offset:640
    s_mov_b64 exec, -1
    v_exp_f32 v210, v210
    v_exp_f32 v211, v211
    v_smfmac_f32_32x32x32_bf16 v[172:187], v[88:91], v[240:247], v66
    v_exp_f32 v212, v212
    v_exp_f32 v213, v213
    s_add_u32 m0, s59, 155648
    s_add_u32 s50, s71, 5398528
    buffer_load_dwordx4 v67, s[20:23], s50 offen sc1 lds
    v_exp_f32 v214, v214
    v_exp_f32 v215, v215
    v_mfma_f32_32x32x8_bf16 v[224:239], v[78:79], v[154:155], v[224:239]
    v_exp_f32 v216, v216
    v_exp_f32 v217, v217
    v_exp_f32 v218, v218
    v_exp_f32 v219, v219
    v_smfmac_f32_32x32x32_bf16 v[172:187], v[92:95], v[248:255], v66
    v_exp_f32 v220, v220
    v_exp_f32 v221, v221
    v_exp_f32 v222, v222
    v_exp_f32 v223, v223
    s_setprio 0
    s_waitcnt lgkmcnt(0)
    v_mfma_f32_32x32x16_bf16 v[240:255], v[164:167], v[150:153], 0
    v_exp_f32 v224, v224
    v_exp_f32 v225, v225
    ds_read2st64_b64 v[168:171], v64 offset0:30 offset1:31
    s_mov_b64 exec, s[62:63]
    ds_read_b64 v[78:79], v64 offset:16384
    s_mov_b64 exec, s[60:61]
    ds_read_b128 v[88:91], v65 offset:5120
    ds_read_b128 v[92:95], v65 offset:5760
    s_mov_b64 exec, -1
    v_exp_f32 v226, v226
    v_exp_f32 v227, v227
    v_smfmac_f32_32x32x32_bf16 v[172:187], v[80:83], v[208:215], v66
    v_exp_f32 v228, v228
    v_exp_f32 v229, v229
    v_exp_f32 v230, v230
    v_exp_f32 v231, v231
    v_mfma_f32_32x32x8_bf16 v[240:255], v[76:77], v[154:155], v[240:255]
    v_exp_f32 v232, v232
    v_exp_f32 v233, v233
    v_exp_f32 v234, v234
    v_exp_f32 v235, v235
    v_smfmac_f32_32x32x32_bf16 v[172:187], v[84:87], v[216:223], v66
    v_exp_f32 v236, v236
    v_exp_f32 v237, v237
    v_exp_f32 v238, v238
    v_exp_f32 v239, v239
    s_setprio 3
    s_waitcnt lgkmcnt(0)
    v_mfma_f32_32x32x16_bf16 v[208:223], v[168:171], v[150:153], 0
    v_exp_f32 v240, v240
    v_exp_f32 v241, v241
    ds_read2st64_b64 v[164:167], v64 offset0:40 offset1:41
    s_mov_b64 exec, s[62:63]
    ds_read_b64 v[76:77], v64 offset:21504
    s_mov_b64 exec, s[60:61]
    ds_read_b128 v[80:83], v65 offset:10240
    ds_read_b128 v[84:87], v65 offset:10880
    s_mov_b64 exec, -1
    v_exp_f32 v242, v242
    v_exp_f32 v243, v243
    v_smfmac_f32_32x32x32_bf16 v[172:187], v[88:91], v[224:231], v66
    v_exp_f32 v244, v244
    v_exp_f32 v245, v245
    v_exp_f32 v246, v246
    v_exp_f32 v247, v247
    v_mfma_f32_32x32x8_bf16 v[208:223], v[78:79], v[154:155], v[208:223]
    v_exp_f32 v248, v248
    v_exp_f32 v249, v249
    v_exp_f32 v250, v250
    v_exp_f32 v251, v251
    v_smfmac_f32_32x32x32_bf16 v[172:187], v[92:95], v[232:239], v66
    v_exp_f32 v252, v252
    v_exp_f32 v253, v253
    v_exp_f32 v254, v254
    v_exp_f32 v255, v255
    s_cmp_lg_u32 s40, 0
    s_cbranch_scc1 L_w_16
    s_mov_b32 s17, 20971520
    buffer_load_dwordx2 v[8:9], v6, s[20:23], s17 offen sc1
L_w_16:
    s_setprio 2
    s_waitcnt lgkmcnt(0)
    v_mfma_f32_32x32x16_bf16 v[224:239], v[164:167], v[150:153], 0
    v_exp_f32 v208, v208
    v_exp_f32 v209, v209
    ds_read2st64_b64 v[168:171], v64 offset0:50 offset1:51
    s_mov_b64 exec, s[62:63]
    ds_read_b64 v[78:79], v64 offset:26624
    s_mov_b64 exec, s[60:61]
    ds_read_b128 v[88:91], v65 offset:15360
    ds_read_b128 v[92:95], v65 offset:16000
    s_mov_b64 exec, -1
    v_exp_f32 v210, v210
    v_exp_f32 v211, v211
    v_smfmac_f32_32x32x32_bf16 v[172:187], v[80:83], v[240:247], v66
    v_exp_f32 v212, v212
    v_exp_f32 v213, v213
    v_exp_f32 v214, v214
    v_exp_f32 v215, v215
    v_mfma_f32_32x32x8_bf16 v[224:239], v[76:77], v[154:155], v[224:239]
    v_exp_f32 v216, v216
    v_exp_f32 v217, v217
    v_exp_f32 v218, v218
    v_exp_f32 v219, v219
    v_smfmac_f32_32x32x32_bf16 v[172:187], v[84:87], v[248:255], v66
    v_exp_f32 v220, v220
    v_exp_f32 v221, v221
    v_exp_f32 v222, v222
    v_exp_f32 v223, v223
    s_setprio 1
    s_waitcnt lgkmcnt(0)
    v_mfma_f32_32x32x16_bf16 v[240:255], v[168:171], v[150:153], 0
    v_exp_f32 v224, v224
    v_exp_f32 v225, v225
    ds_read2st64_b64 v[164:167], v64 offset0:60 offset1:61
    s_mov_b64 exec, s[62:63]
    ds_read_b64 v[76:77], v64 offset:31744
    s_mov_b64 exec, s[60:61]
    ds_read_b128 v[80:83], v65 offset:20480
    ds_read_b128 v[84:87], v65 offset:21120
    s_mov_b64 exec, -1
    v_exp_f32 v226, v226
    v_exp_f32 v227, v227
    v_smfmac_f32_32x32x32_bf16 v[172:187], v[88:91], v[208:215], v66
    v_exp_f32 v228, v228
    v_exp_f32 v229, v229
    v_exp_f32 v230, v230
    v_exp_f32 v231, v231
    v_mfma_f32_32x32x8_bf16 v[240:255], v[78:79], v[154:155], v[240:255]
    v_exp_f32 v232, v232
    v_exp_f32 v233, v233
    v_exp_f32 v234, v234
    v_exp_f32 v235, v235
    v_smfmac_f32_32x32x32_bf16 v[172:187], v[92:95], v[216:223], v66
    v_exp_f32 v236, v236
    v_exp_f32 v237, v237
    v_exp_f32 v238, v238
    v_exp_f32 v239, v239
    s_setprio 0
    s_waitcnt lgkmcnt(0)
    v_mfma_f32_32x32x16_bf16 v[208:223], v[164:167], v[150:153], 0
    v_exp_f32 v240, v240
    v_exp_f32 v241, v241
    ds_read2st64_b64 v[168:171], v64 offset0:70 offset1:71
    s_mov_b64 exec, s[62:63]
    ds_read_b64 v[78:79], v64 offset:36864
    s_mov_b64 exec, s[60:61]
    ds_read_b128 v[88:91], v65 offset:25600
    ds_read_b128 v[92:95], v65 offset:26240
    s_mov_b64 exec, -1
    v_exp_f32 v242, v242
    v_exp_f32 v243, v243
    v_smfmac_f32_32x32x32_bf16 v[172:187], v[80:83], v[224:231], v66
    v_exp_f32 v244, v244
    v_exp_f32 v245, v245
    v_exp_f32 v246, v246
    v_exp_f32 v247, v247
    v_mfma_f32_32x32x8_bf16 v[208:223], v[76:77], v[154:155], v[208:223]
    v_exp_f32 v248, v248
    v_exp_f32 v249, v249
    v_exp_f32 v250, v250
    v_exp_f32 v251, v251
    v_smfmac_f32_32x32x32_bf16 v[172:187], v[84:87], v[232:239], v66
    v_exp_f32 v252, v252
    v_exp_f32 v253, v253
    v_exp_f32 v254, v254
    v_exp_f32 v255, v255
    s_cmp_lg_u32 s40, 0
    s_cbranch_scc1 L_w_17
    s_mov_b32 s70, 0x20000
    s_waitcnt vmcnt(0)
L_spin_18:
    v_cmp_eq_u32 s[32:33], s3, v8
    v_cmp_eq_u32 s[18:19], s3, v9
    s_orn2_b64 s[18:19], s[18:19], s[26:27]
    s_and_b64 s[32:33], s[32:33], s[18:19]
    s_cmp_eq_u64 s[32:33], -1
    s_cbranch_scc1 L_w_17
    s_sleep 4
    s_mov_b32 s17, 20971520
    buffer_load_dwordx2 v[8:9], v6, s[20:23], s17 offen sc1
    s_sub_u32 s70, s70, 1
    s_cmp_lg_u32 s70, 0
    s_waitcnt vmcnt(0)
    s_cbranch_scc1 L_spin_18
L_w_17:
    s_waitcnt vmcnt(0) lgkmcnt(0)
    s_barrier
    s_cmp_lg_u32 s40, 1
    s_cbranch_scc1 L_w_19
    s_lshl_b32 s52, s57, 8
    s_lshl_b32 s53, s56, 2
    s_add_u32 s52, s52, s53
    s_add_u32 s52, s52, 21004288
    v_mov_b32 v1, s3
    s_mov_b64 exec, 1
    buffer_store_dword v1, off, s[20:23], s52 sc1
    s_mov_b64 exec, -1
L_w_19:
    s_setprio 3
    s_waitcnt lgkmcnt(0)
    v_mfma_f32_32x32x16_bf16 v[224:239], v[168:171], v[150:153], 0
    v_exp_f32 v208, v208
    v_exp_f32 v209, v209
    v_add_u32 v64, 40960, v64
    ds_read2st64_b64 v[164:167], v64 offset0:0 offset1:1
    s_mov_b64 exec, s[62:63]
    ds_read_b64 v[76:77], v64 offset:1024
    s_mov_b64 exec, s[60:61]
    ds_read_b128 v[80:83], v65 offset:30720
    ds_read_b128 v[84:87], v65 offset:31360
    s_mov_b64 exec, -1
    v_exp_f32 v210, v210
    v_exp_f32 v211, v211
    v_smfmac_f32_32x32x32_bf16 v[172:187], v[88:91], v[240:247], v66
    v_exp_f32 v212, v212
    v_exp_f32 v213, v213
    s_mul_i32 s50, s56, 64
    s_and_b32 s17, s58, 63
    s_add_u32 s50, s50, s17
    s_mul_i32 s50, s50, 1280
    s_add_u32 s50, s50, 0
    buffer_load_dwordx2 v[156:157], v68, s[20:23], s50 offen sc1
    buffer_load_dwordx2 v[158:159], v68, s[20:23], s50 offen offset:512 sc1
    s_mov_b64 exec, s[62:63]
    buffer_load_dwordx2 v[160:161], v68, s[20:23], s50 offen offset:1024 sc1
    s_mov_b64 exec, -1
    v_exp_f32 v214, v214
    v_exp_f32 v215, v215
    v_mfma_f32_32x32x8_bf16 v[224:239], v[78:79], v[154:155], v[224:239]
    v_exp_f32 v216, v216
    v_exp_f32 v217, v217
    s_add_u32 s50, s35, 0
    s_max_i32 s50, s50, 0
    s_add_u32 m0, s59, 0
    s_add_u32 s50, s50, s66
    buffer_load_dwordx4 v67, s[20:23], s50 offen sc1 lds
    v_exp_f32 v218, v218
    v_exp_f32 v219, v219
    v_smfmac_f32_32x32x32_bf16 v[172:187], v[92:95], v[248:255], v66
    v_exp_f32 v220, v220
    v_exp_f32 v221, v221
    v_exp_f32 v222, v222
    v_exp_f32 v223, v223
    s_setprio 2
    s_waitcnt lgkmcnt(0)
    v_mfma_f32_32x32x16_bf16 v[240:255], v[164:167], v[144:147], 0
    v_exp_f32 v224, v224
    v_exp_f32 v225, v225
    s_mov_b64 exec, s[60:61]
    ds_read_b128 v[88:91], v65 offset:35840
    ds_read_b128 v[92:95], v65 offset:36480
    s_mov_b64 exec, -1
    v_exp_f32 v226, v226
    v_exp_f32 v227, v227
    v_smfmac_f32_32x32x32_bf16 v[172:187], v[80:83], v[208:215], v66
    v_exp_f32 v228, v228
    v_exp_f32 v229, v229
    s_add_u32 s50, s35, 8192
    s_max_i32 s50, s50, 0
    s_add_u32 m0, s59, 8192
    s_add_u32 s50, s50, s66
    buffer_load_dwordx4 v67, s[20:23], s50 offen sc1 lds
    v_exp_f32 v230, v230
    v_exp_f32 v231, v231
    v_mfma_f32_32x32x8_bf16 v[240:255], v[76:77], v[148:149], v[240:255]
    v_exp_f32 v232, v232
    v_exp_f32 v233, v233
    s_add_u32 s50, s35, 16384
    s_max_i32 s50, s50, 0
    s_add_u32 m0, s59, 16384
    s_add_u32 s50, s50, s66
    buffer_load_dwordx4 v67, s[20:23], s50 offen sc1 lds
    v_exp_f32 v234, v234
    v_exp_f32 v235, v235
    v_smfmac_f32_32x32x32_bf16 v[172:187], v[84:87], v[216:223], v66
    v_exp_f32 v236, v236
    v_exp_f32 v237, v237
    v_exp_f32 v238, v238
    v_exp_f32 v239, v239
    s_setprio 1
    s_waitcnt lgkmcnt(0)
    v_mfma_f32_32x32x16_bf16 v[208:223], v[164:167], v[150:153], 0
    v_exp_f32 v240, v240
    v_exp_f32 v241, v241
    v_add_u32 v65, 40960, v65
    ds_read2st64_b64 v[168:171], v64 offset0:10 offset1:11
    s_mov_b64 exec, s[62:63]
    ds_read_b64 v[78:79], v64 offset:6144
    s_mov_b64 exec, s[60:61]
    ds_read_b128 v[80:83], v65 offset:0
    ds_read_b128 v[84:87], v65 offset:640
    s_mov_b64 exec, -1
    v_exp_f32 v242, v242
    v_exp_f32 v243, v243
    v_smfmac_f32_32x32x32_bf16 v[172:187], v[88:91], v[224:231], v66
    v_exp_f32 v244, v244
    v_exp_f32 v245, v245
    s_add_u32 s50, s35, 24576
    s_cmp_ge_u32 s40, 6
    s_cselect_b32 s48, 51200, 0
    s_add_u32 s50, s50, s48
    s_add_u32 m0, s59, 24576
    s_add_u32 s50, s50, s66
    buffer_load_dwordx4 v67, s[20:23], s50 offen sc1 lds
    v_exp_f32 v246, v246
    v_exp_f32 v247, v247
    v_mfma_f32_32x32x8_bf16 v[208:223], v[76:77], v[154:155], v[208:223]
    v_exp_f32 v248, v248
    v_exp_f32 v249, v249
    s_add_u32 s50, s35, 83968
    s_add_u32 m0, s59, 32768
    s_add_u32 s50, s50, s66
    buffer_load_dwordx4 v67, s[20:23], s50 offen sc1 lds
    v_exp_f32 v250, v250
    v_exp_f32 v251, v251
    v_smfmac_f32_32x32x32_bf16 v[172:187], v[92:95], v[232:239], v66
    v_exp_f32 v252, v252
    v_exp_f32 v253, v253
    v_exp_f32 v254, v254
    v_exp_f32 v255, v255
    s_setprio 0
    s_waitcnt lgkmcnt(0)
    v_mfma_f32_32x32x16_bf16 v[224:239], v[168:171], v[144:147], 0
    v_exp_f32 v208, v208
    v_exp_f32 v209, v209
    v_exp_f32 v210, v210
    v_exp_f32 v211, v211
    v_smfmac_f32_32x32x32_bf16 v[128:143], v[80:83], v[240:247], v66
    v_exp_f32 v212, v212
    v_exp_f32 v213, v213
    s_add_u32 s50, s35, 92160
    s_add_u32 m0, s59, 40960
    s_add_u32 s50, s50, s66
    buffer_load_dwordx4 v67, s[20:23], s50 offen sc1 lds
    v_exp_f32 v214, v214
    v_exp_f32 v215, v215
    v_mfma_f32_32x32x8_bf16 v[224:239], v[78:79], v[148:149], v[224:239]
    v_exp_f32 v216, v216
    v_exp_f32 v217, v217
    s_add_u32 s50, s35, 100352
    s_add_u32 m0, s59, 49152
    s_add_u32 s50, s50, s66
    buffer_load_dwordx4 v67, s[20:23], s50 offen sc1 lds
    v_exp_f32 v218, v218
    v_exp_f32 v219, v219
    v_smfmac_f32_32x32x32_bf16 v[128:143], v[84:87], v[248:255], v66
    v_exp_f32 v220, v220
    v_exp_f32 v221, v221
    v_exp_f32 v222, v222
    v_exp_f32 v223, v223
    s_setprio 3
    s_waitcnt lgkmcnt(0)
    v_mfma_f32_32x32x16_bf16 v[240:255], v[168:171], v[150:153], 0
    v_exp_f32 v224, v224
    v_exp_f32 v225, v225
    ds_read2st64_b64 v[164:167], v64 offset0:20 offset1:21
    s_mov_b64 exec, s[62:63]
    ds_read_b64 v[76:77], v64 offset:11264
    s_mov_b64 exec, s[60:61]
    ds_read_b128 v[88:91], v65 offset:5120
    ds_read_b128 v[92:95], v65 offset:5760
    s_mov_b64 exec, -1
    v_exp_f32 v226, v226
    v_exp_f32 v227, v227
    v_smfmac_f32_32x32x32_bf16 v[172:187], v[80:83], v[208:215], v66
    v_exp_f32 v228, v228
    v_exp_f32 v229, v229
    s_cmp_ge_u32 s40, 4
    s_cbranch_scc1 L_da_9
    s_add_u32 s50, s35, 108544
    s_add_u32 m0, s59, 57344
    s_add_u32 s50, s50, s66
    buffer_load_dwordx4 v67, s[20:23], s50 offen sc1 lds
L_da_9:
    v_exp_f32 v230, v230
    v_exp_f32 v231, v231
    v_mfma_f32_32x32x8_bf16 v[240:255], v[78:79], v[154:155], v[240:255]
    v_exp_f32 v232, v232
    v_exp_f32 v233, v233
    v_exp_f32 v234, v234
    v_exp_f32 v235, v235
    v_smfmac_f32_32x32x32_bf16 v[172:187], v[84:87], v[216:223], v66
    v_exp_f32 v236, v236
    v_exp_f32 v237, v237
    v_exp_f32 v238, v238
    v_exp_f32 v239, v239
    s_setprio 2
    s_waitcnt lgkmcnt(0)
    v_mfma_f32_32x32x16_bf16 v[208:223], v[164:167], v[144:147], 0
    v_exp_f32 v240, v240
    v_exp_f32 v241, v241
    v_exp_f32 v242, v242
    v_exp_f32 v243, v243
    v_smfmac_f32_32x32x32_bf16 v[128:143], v[88:91], v[224:231], v66
    v_exp_f32 v244, v244
    v_exp_f32 v245, v245
    v_exp_f32 v246, v246
    v_exp_f32 v247, v247
    v_mfma_f32_32x32x8_bf16 v[208:223], v[76:77], v[148:149], v[208:223]
    v_exp_f32 v248, v248
    v_exp_f32 v249, v249
    v_exp_f32 v250, v250
    v_exp_f32 v251, v251
    v_smfmac_f32_32x32x32_bf16 v[128:143], v[92:95], v[232:239], v66
    v_exp_f32 v252, v252
    v_exp_f32 v253, v253
    v_exp_f32 v254, v254
    v_exp_f32 v255, v255
    s_setprio 1
    s_waitcnt lgkmcnt(0)
    v_mfma_f32_32x32x16_bf16 v[224:239], v[164:167], v[150:153], 0
    v_exp_f32 v208, v208
    v_exp_f32 v209, v209
    ds_read2st64_b64 v[168:171], v64 offset0:30 offset1:31
    s_mov_b64 exec, s[62:63]
    ds_read_b64 v[78:79], v64 offset:16384
    s_mov_b64 exec, s[60:61]
    ds_read_b128 v[80:83], v65 offset:10240
    ds_read_b128 v[84:87], v65 offset:10880
    s_mov_b64 exec, -1
    v_exp_f32 v210, v210
    v_exp_f32 v211, v211
    v_smfmac_f32_32x32x32_bf16 v[172:187], v[88:91], v[240:247], v66
    v_exp_f32 v212, v212
    v_exp_f32 v213, v213
    v_exp_f32 v214, v214
    v_exp_f32 v215, v215
    v_mfma_f32_32x32x8_bf16 v[224:239], v[76:77], v[154:155], v[224:239]
    v_exp_f32 v216, v216
    v_exp_f32 v217, v217
    v_exp_f32 v218, v218
    v_exp_f32 v219, v219
    v_smfmac_f32_32x32x32_bf16 v[172:187], v[92:95], v[248:255], v66
    v_exp_f32 v220, v220
    v_exp_f32 v221, v221
    v_exp_f32 v222, v222
    v_exp_f32 v223, v223
    s_setprio 0
    s_waitcnt lgkmcnt(0)
    v_mfma_f32_32x32x16_bf16 v[240:255], v[168:171], v[144:147], 0
    v_exp_f32 v224, v224
    v_exp_f32 v225, v225
    v_exp_f32 v226, v226
    v_exp_f32 v227, v227
    v_smfmac_f32_32x32x32_bf16 v[128:143], v[80:83], v[208:215], v66
    v_exp_f32 v228, v228
    v_exp_f32 v229, v229
    v_exp_f32 v230, v230
    v_exp_f32 v231, v231
    v_mfma_f32_32x32x8_bf16 v[240:255], v[78:79], v[148:149], v[240:255]
    v_exp_f32 v232, v232
    v_exp_f32 v233, v233
    v_exp_f32 v234, v234
    v_exp_f32 v235, v235
    v_smfmac_f32_32x32x32_bf16 v[128:143], v[84:87], v[216:223], v66
    v_exp_f32 v236, v236
    v_exp_f32 v237, v237
    v_exp_f32 v238, v238
    v_exp_f32 v239, v239
    s_waitcnt vmcnt(0)
    s_barrier
    s_setprio 3
    s_waitcnt lgkmcnt(0)
    v_mfma_f32_32x32x16_bf16 v[208:223], v[168:171], v[150:153], 0
    v_exp_f32 v240, v240
    v_exp_f32 v241, v241
    ds_read2st64_b64 v[164:167], v64 offset0:40 offset1:41
    s_mov_b64 exec, s[62:63]
    ds_read_b64 v[76:77], v64 offset:21504
    s_mov_b64 exec, s[60:61]
    ds_read_b128 v[88:91], v65 offset:15360
    ds_read_b128 v[92:95], v65 offset:16000
    s_mov_b64 exec, -1
    v_exp_f32 v242, v242
    v_exp_f32 v243, v243
    v_smfmac_f32_32x32x32_bf16 v[172:187], v[80:83], v[224:231], v66
    v_exp_f32 v244, v244
    v_exp_f32 v245, v245
    v_lshlrev_b32 v15, 16, v156
    v_and_b32 v16, 0xffff0000, v156
    v_mul_f32 v15, s64, v15
    v_mul_f32 v16, s64, v16
    v_cvt_pk_bf16_f32 v156, v15, v16
    v_lshlrev_b32 v15, 16, v157
    v_and_b32 v16, 0xffff0000, v157
    v_mul_f32 v15, s64, v15
    v_mul_f32 v16, s64, v16
    v_cvt_pk_bf16_f32 v157, v15, v16
    v_exp_f32 v246, v246
    v_exp_f32 v247, v247
    v_mfma_f32_32x32x8_bf16 v[208:223], v[78:79], v[154:155], v[208:223]
    v_exp_f32 v248, v248
    v_exp_f32 v249, v249
    v_lshlrev_b32 v15, 16, v158
    v_and_b32 v16, 0xffff0000, v158
    v_mul_f32 v15, s64, v15
    v_mul_f32 v16, s64, v16
    v_cvt_pk_bf16_f32 v158, v15, v16
    v_lshlrev_b32 v15, 16, v159
    v_and_b32 v16, 0xffff0000, v159
    v_mul_f32 v15, s64, v15
    v_mul_f32 v16, s64, v16
    v_cvt_pk_bf16_f32 v159, v15, v16
    v_exp_f32 v250, v250
    v_exp_f32 v251, v251
    v_smfmac_f32_32x32x32_bf16 v[172:187], v[84:87], v[232:239], v66
    v_exp_f32 v252, v252
    v_exp_f32 v253, v253
    s_cmp_eq_u32 s58, 0
    s_cselect_b32 s48, 2560, 0
    s_add_u32 s48, s48, s69
    s_add_u32 s48, s48, s67
    v_add_u32 v46, s48, v46
    v_exp_f32 v254, v254
    v_exp_f32 v255, v255
    s_setprio 2
    s_waitcnt lgkmcnt(0)
    v_mfma_f32_32x32x16_bf16 v[224:239], v[164:167], v[144:147], 0
    v_exp_f32 v208, v208
    v_exp_f32 v209, v209
    v_exp_f32 v210, v210
    v_exp_f32 v211, v211
    v_smfmac_f32_32x32x32_bf16 v[128:143], v[88:91], v[240:247], v66
    v_exp_f32 v212, v212
    v_exp_f32 v213, v213
    v_lshlrev_b32 v15, 16, v160
    v_and_b32 v16, 0xffff0000, v160
    v_mul_f32 v15, s64, v15
    v_mul_f32 v16, s64, v16
    v_cvt_pk_bf16_f32 v160, v15, v16
    v_lshlrev_b32 v15, 16, v161
    v_and_b32 v16, 0xffff0000, v161
    v_mul_f32 v15, s64, v15
    v_mul_f32 v16, s64, v16
    v_cvt_pk_bf16_f32 v161, v15, v16
    v_exp_f32 v214, v214
    v_exp_f32 v215, v215
    v_mfma_f32_32x32x8_bf16 v[224:239], v[76:77], v[148:149], v[224:239]
    v_exp_f32 v216, v216
    v_exp_f32 v217, v217
    v_mov_b32 v15, 0x3f800000
    v_cndmask_b32 v160, 0, v160, s[62:63]
    v_cndmask_b32 v161, v15, v161, s[62:63]
    v_exp_f32 v218, v218
    v_exp_f32 v219, v219
    v_smfmac_f32_32x32x32_bf16 v[128:143], v[92:95], v[248:255], v66
    v_exp_f32 v220, v220
    v_exp_f32 v221, v221
    ds_read2st64_b64 v[40:43], v46 offset0:35 offset1:36
    s_mov_b64 exec, s[62:63]
    ds_read_b64 v[44:45], v46 offset:18944
    s_mov_b64 exec, -1
    v_exp_f32 v222, v222
    v_exp_f32 v223, v223
    s_setprio 1
    s_waitcnt lgkmcnt(0)
    v_mfma_f32_32x32x16_bf16 v[240:255], v[164:167], v[150:153], 0
    v_exp_f32 v224, v224
    v_exp_f32 v225, v225
    ds_read2st64_b64 v[168:171], v64 offset0:50 offset1:51
    s_mov_b64 exec, s[62:63]
    ds_read_b64 v[78:79], v64 offset:26624
    s_mov_b64 exec, s[60:61]
    ds_read_b128 v[80:83], v65 offset:20480
    ds_read_b128 v[84:87], v65 offset:21120
    s_mov_b64 exec, -1
    v_exp_f32 v226, v226
    v_exp_f32 v227, v227
    v_smfmac_f32_32x32x32_bf16 v[172:187], v[88:91], v[208:215], v66
    v_exp_f32 v228, v228
    v_exp_f32 v229, v229
    s_cmp_eq_u32 s58, 0
    s_cbranch_scc1 L_mp0
    v_mfma_f32_32x32x16_bf16 v[24:39], v[40:43], v[156:159], 0
    s_branch L_mp1
L_mp0:
    v_mfma_f32_32x32x16_bf16 v[24:39], v[40:43], v[156:159], v[112:127]
L_mp1:
    v_exp_f32 v230, v230
    v_exp_f32 v231, v231
    v_mfma_f32_32x32x8_bf16 v[240:255], v[76:77], v[154:155], v[240:255]
    v_exp_f32 v232, v232
    v_exp_f32 v233, v233
    v_mfma_f32_32x32x8_bf16 v[24:39], v[44:45], v[160:161], v[24:39]
    v_exp_f32 v234, v234
    v_exp_f32 v235, v235
    v_smfmac_f32_32x32x32_bf16 v[172:187], v[92:95], v[216:223], v66
    v_exp_f32 v236, v236
    v_exp_f32 v237, v237
    v_exp_f32 v238, v238
    v_exp_f32 v239, v239
    s_setprio 0
    s_waitcnt lgkmcnt(0)
    v_mfma_f32_32x32x16_bf16 v[208:223], v[168:171], v[144:147], 0
    v_exp_f32 v240, v240
    v_exp_f32 v241, v241
    v_exp_f32 v242, v242
    v_exp_f32 v243, v243
    v_smfmac_f32_32x32x32_bf16 v[128:143], v[80:83], v[224:231], v66
    v_exp_f32 v244, v244
    v_exp_f32 v245, v245
    v_exp_f32 v246, v246
    v_exp_f32 v247, v247
    v_mfma_f32_32x32x8_bf16 v[208:223], v[78:79], v[148:149], v[208:223]
    v_exp_f32 v248, v248
    v_exp_f32 v249, v249
    v_max3_f32 v2, v24, v25, v26
    v_max3_f32 v2, v2, v27, v28
    v_max3_f32 v2, v2, v29, v30
    v_max3_f32 v2, v2, v31, v32
    v_exp_f32 v250, v250
    v_exp_f32 v251, v251
    v_smfmac_f32_32x32x32_bf16 v[128:143], v[84:87], v[232:239], v66
    v_exp_f32 v252, v252
    v_exp_f32 v253, v253
    v_max3_f32 v2, v2, v33, v34
    v_max3_f32 v2, v2, v35, v36
    v_max3_f32 v2, v2, v37, v38
    v_max_f32 v2, v2, v39
    v_exp_f32 v254, v254
    v_exp_f32 v255, v255
    s_setprio 3
    s_waitcnt lgkmcnt(0)
    v_mfma_f32_32x32x16_bf16 v[224:239], v[168:171], v[150:153], 0
    v_exp_f32 v208, v208
    v_exp_f32 v209, v209
    s_sub_u32 s48, s69, 81920
    v_add_u32 v64, s48, v64
    s_cmp_ge_u32 s58, 8
    s_cselect_b32 s48, s65, 4048109440
    v_mov_b32 v77, s48
    ds_read2st64_b64 v[164:167], v64 offset0:0 offset1:1
    s_mov_b64 exec, s[62:63]
    ds_read_b64 v[76:77], v64 offset:1024
    s_mov_b64 exec, s[60:61]
    ds_read_b128 v[88:91], v65 offset:25600
    ds_read_b128 v[92:95], v65 offset:26240
    s_mov_b64 exec, -1
    v_exp_f32 v210, v210
    v_exp_f32 v211, v211
    v_smfmac_f32_32x32x32_bf16 v[172:187], v[80:83], v[240:247], v66
    v_exp_f32 v212, v212
    v_exp_f32 v213, v213
    v_mov_b32 v15, v2
    s_nop 1
    v_permlane32_swap_b32 v15, v2
    s_nop 1
    v_max_f32 v15, v15, v2
    v_exp_f32 v214, v214
    v_exp_f32 v215, v215
    v_mfma_f32_32x32x8_bf16 v[224:239], v[78:79], v[154:155], v[224:239]
    v_exp_f32 v216, v216
    v_exp_f32 v217, v217
    v_sub_f32 v15, 3254779904, v15
    v_lshrrev_b32 v15, 16, v15
    v_cndmask_b32 v160, v15, v160, s[62:63]
    v_exp_f32 v218, v218
    v_exp_f32 v219, v219
    v_smfmac_f32_32x32x32_bf16 v[172:187], v[84:87], v[248:255], v66
    v_exp_f32 v220, v220
    v_exp_f32 v221, v221
    v_exp_f32 v222, v222
    v_exp_f32 v223, v223
    s_setprio 2
    s_waitcnt lgkmcnt(0)
    v_mfma_f32_32x32x16_bf16 v[240:255], v[164:167], v[156:159], v[96:111]
    v_exp_f32 v224, v224
    v_exp_f32 v225, v225
    s_cmp_ge_u32 s58, 7
    s_cselect_b32 s48, s65, 4048109440
    v_mov_b32 v79, s48
    ds_read2st64_b64 v[168:171], v64 offset0:5 offset1:6
    s_mov_b64 exec, s[62:63]
    ds_read_b64 v[78:79], v64 offset:3584
    s_mov_b64 exec, -1
    v_exp_f32 v226, v226
    v_exp_f32 v227, v227
    v_smfmac_f32_32x32x32_bf16 v[128:143], v[88:91], v[208:215], v66
    v_exp_f32 v228, v228
    v_exp_f32 v229, v229
    v_exp_f32 v230, v230
    v_exp_f32 v231, v231
    v_mfma_f32_32x32x8_bf16 v[240:255], v[76:77], v[160:161], v[240:255]
    v_exp_f32 v232, v232
    v_exp_f32 v233, v233
    v_exp_f32 v234, v234
    v_exp_f32 v235, v235
    v_smfmac_f32_32x32x32_bf16 v[128:143], v[92:95], v[216:223], v66
    v_exp_f32 v236, v236
    v_exp_f32 v237, v237
    v_exp_f32 v238, v238
    v_exp_f32 v239, v239
    s_setprio 1
    s_waitcnt lgkmcnt(0)
    v_mfma_f32_32x32x16_bf16 v[208:223], v[168:171], v[156:159], 0
    v_exp_f32 v240, v240
    v_exp_f32 v241, v241
    s_sub_u32 s48, s69, 81920
    v_add_u32 v65, s48, v65
    s_cmp_ge_u32 s58, 6
    s_cselect_b32 s48, s65, 4048109440
    v_mov_b32 v77, s48
    ds_read2st64_b64 v[164:167], v64 offset0:10 offset1:11
    s_mov_b64 exec, s[62:63]
    ds_read_b64 v[76:77], v64 offset:6144
    s_mov_b64 exec, s[60:61]
    ds_read_b128 v[80:83], v65 offset:0
    ds_read_b128 v[84:87], v65 offset:640
    s_mov_b64 exec, -1
    v_exp_f32 v242, v242
    v_exp_f32 v243, v243
    v_smfmac_f32_32x32x32_bf16 v[172:187], v[88:91], v[224:231], v66
    v_exp_f32 v244, v244
    v_exp_f32 v245, v245
    v_mfma_f32_32x32x8_bf16 v[96:111], v[162:163], v[162:163], 0
    v_exp_f32 v246, v246
    v_exp_f32 v247, v247
    v_mfma_f32_32x32x8_bf16 v[208:223], v[78:79], v[160:161], v[208:223]
    v_exp_f32 v248, v248
    v_exp_f32 v249, v249
    v_exp_f32 v250, v250
    v_exp_f32 v251, v251
    v_smfmac_f32_32x32x32_bf16 v[172:187], v[92:95], v[232:239], v66
    v_exp_f32 v252, v252
    v_exp_f32 v253, v253
    v_exp_f32 v254, v254
    v_exp_f32 v255, v255
    s_setprio 0
    s_waitcnt lgkmcnt(0)
    v_mfma_f32_32x32x16_bf16 v[224:239], v[164:167], v[156:159], 0
    v_exp_f32 v208, v208
    v_exp_f32 v209, v209
    s_cmp_ge_u32 s58, 5
    s_cselect_b32 s48, s65, 4048109440
    v_mov_b32 v79, s48
    ds_read2st64_b64 v[168:171], v64 offset0:15 offset1:16
    s_mov_b64 exec, s[62:63]
    ds_read_b64 v[78:79], v64 offset:8704
    s_mov_b64 exec, s[60:61]
    ds_read_b128 v[88:91], v65 offset:2560
    ds_read_b128 v[92:95], v65 offset:3200
    s_mov_b64 exec, -1
    v_exp_f32 v210, v210
    v_exp_f32 v211, v211
    v_smfmac_f32_32x32x32_bf16 v[96:111], v[80:83], v[240:247], v66
    v_exp_f32 v212, v212
    v_exp_f32 v213, v213
    s_add_u32 s50, s34, 22900736
    buffer_load_dwordx4 v[188:191], v67, s[20:23], s50 offen sc1
    v_exp_f32 v214, v214
    v_exp_f32 v215, v215
    v_mfma_f32_32x32x8_bf16 v[224:239], v[76:77], v[160:161], v[224:239]
    v_exp_f32 v216, v216
    v_exp_f32 v217, v217
    v_exp_f32 v218, v218
    v_exp_f32 v219, v219
    v_smfmac_f32_32x32x32_bf16 v[96:111], v[84:87], v[248:255], v66
    v_exp_f32 v220, v220
    v_exp_f32 v221, v221
    v_exp_f32 v222, v222
    v_exp_f32 v223, v223
    s_setprio 3
    s_waitcnt lgkmcnt(0)
    v_mfma_f32_32x32x16_bf16 v[240:255], v[168:171], v[156:159], 0
    v_exp_f32 v224, v224
    v_exp_f32 v225, v225
    s_cmp_ge_u32 s58, 4
    s_cselect_b32 s48, s65, 4048109440
    v_mov_b32 v77, s48
    ds_read2st64_b64 v[164:167], v64 offset0:20 offset1:21
    s_mov_b64 exec, s[62:63]
    ds_read_b64 v[76:77], v64 offset:11264
    s_mov_b64 exec, s[60:61]
    ds_read_b128 v[80:83], v65 offset:5120
    ds_read_b128 v[84:87], v65 offset:5760
    s_mov_b64 exec, -1
    v_exp_f32 v226, v226
    v_exp_f32 v227, v227
    v_smfmac_f32_32x32x32_bf16 v[96:111], v[88:91], v[208:215], v66
    v_exp_f32 v228, v228
    v_exp_f32 v229, v229
    s_add_u32 s50, s34, 22908928
    buffer_load_dwordx4 v[192:195], v67, s[20:23], s50 offen sc1
    v_exp_f32 v230, v230
    v_exp_f32 v231, v231
    v_mfma_f32_32x32x8_bf16 v[240:255], v[78:79], v[160:161], v[240:255]
    v_exp_f32 v232, v232
    v_exp_f32 v233, v233
    v_exp_f32 v234, v234
    v_exp_f32 v235, v235
    v_smfmac_f32_32x32x32_bf16 v[96:111], v[92:95], v[216:223], v66
    v_exp_f32 v236, v236
    v_exp_f32 v237, v237
    v_exp_f32 v238, v238
    v_exp_f32 v239, v239
    s_setprio 2
    s_waitcnt lgkmcnt(0)
    v_mfma_f32_32x32x16_bf16 v[208:223], v[164:167], v[156:159], 0
    v_exp_f32 v240, v240
    v_exp_f32 v241, v241
    s_cmp_ge_u32 s58, 3
    s_cselect_b32 s48, s65, 4048109440
    v_mov_b32 v79, s48
    ds_read2st64_b64 v[168:171], v64 offset0:25 offset1:26
    s_mov_b64 exec, s[62:63]
    ds_read_b64 v[78:79], v64 offset:13824
    s_mov_b64 exec, s[60:61]
    ds_read_b128 v[88:91], v65 offset:7680
    ds_read_b128 v[92:95], v65 offset:8320
    s_mov_b64 exec, -1
    v_exp_f32 v242, v242
    v_exp_f32 v243, v243
    v_smfmac_f32_32x32x32_bf16 v[96:111], v[80:83], v[224:231], v66
    v_exp_f32 v244, v244
    v_exp_f32 v245, v245
    s_add_u32 s50, s34, 22917120
    buffer_load_dwordx4 v[196:199], v67, s[20:23], s50 offen sc1
    v_exp_f32 v246, v246
    v_exp_f32 v247, v247
    v_mfma_f32_32x32x8_bf16 v[208:223], v[76:77], v[160:161], v[208:223]
    v_exp_f32 v248, v248
    v_exp_f32 v249, v249
    v_exp_f32 v250, v250
    v_exp_f32 v251, v251
    v_smfmac_f32_32x32x32_bf16 v[96:111], v[84:87], v[232:239], v66
    v_exp_f32 v252, v252
    v_exp_f32 v253, v253
    v_exp_f32 v254, v254
    v_exp_f32 v255, v255
    s_setprio 1
    s_waitcnt lgkmcnt(0)
    v_mfma_f32_32x32x16_bf16 v[224:239], v[168:171], v[156:159], 0
    v_exp_f32 v208, v208
    v_exp_f32 v209, v209
    s_cmp_ge_u32 s58, 2
    s_cselect_b32 s48, s65, 4048109440
    v_mov_b32 v77, s48
    ds_read2st64_b64 v[164:167], v64 offset0:30 offset1:31
    s_mov_b64 exec, s[62:63]
    ds_read_b64 v[76:77], v64 offset:16384
    s_mov_b64 exec, s[60:61]
    ds_read_b128 v[80:83], v65 offset:10240
    ds_read_b128 v[84:87], v65 offset:10880
    s_mov_b64 exec, -1
    v_exp_f32 v210, v210
    v_exp_f32 v211, v211
    v_smfmac_f32_32x32x32_bf16 v[96:111], v[88:91], v[240:247], v66
    v_exp_f32 v212, v212
    v_exp_f32 v213, v213
    s_add_u32 s50, s34, 22925312
    buffer_load_dwordx4 v[200:203], v67, s[20:23], s50 offen sc1
    v_exp_f32 v214, v214
    v_exp_f32 v215, v215
    v_mfma_f32_32x32x8_bf16 v[224:239], v[78:79], v[160:161], v[224:239]
    v_exp_f32 v216, v216
    v_exp_f32 v217, v217
    v_exp_f32 v218, v218
    v_exp_f32 v219, v219
    v_smfmac_f32_32x32x32_bf16 v[96:111], v[92:95], v[248:255], v66
    v_exp_f32 v220, v220
    v_exp_f32 v221, v221
    v_exp_f32 v222, v222
    v_exp_f32 v223, v223
    s_setprio 0
    s_waitcnt lgkmcnt(0)
    v_mfma_f32_32x32x16_bf16 v[240:255], v[164:167], v[156:159], 0
    v_exp_f32 v224, v224
    v_exp_f32 v225, v225
    s_cmp_ge_u32 s58, 1
    s_cselect_b32 s48, s65, 4048109440
    v_mov_b32 v79, s48
    ds_read2st64_b64 v[168:171], v64 offset0:35 offset1:36
    s_mov_b64 exec, s[62:63]
    ds_read_b64 v[78:79], v64 offset:18944
    s_mov_b64 exec, s[60:61]
    ds_read_b128 v[88:91], v65 offset:12800
    ds_read_b128 v[92:95], v65 offset:13440
    s_mov_b64 exec, -1
    v_exp_f32 v226, v226
    v_exp_f32 v227, v227
    v_smfmac_f32_32x32x32_bf16 v[96:111], v[80:83], v[208:215], v66
    v_exp_f32 v228, v228
    v_exp_f32 v229, v229
    s_add_u32 s50, s34, 22933504
    buffer_load_dwordx4 v[204:207], v67, s[20:23], s50 offen sc1
    v_exp_f32 v230, v230
    v_exp_f32 v231, v231
    v_mfma_f32_32x32x8_bf16 v[240:255], v[76:77], v[160:161], v[240:255]
    v_exp_f32 v232, v232
    v_exp_f32 v233, v233
    v_exp_f32 v234, v234
    v_exp_f32 v235, v235
    v_smfmac_f32_32x32x32_bf16 v[96:111], v[84:87], v[216:223], v66
    v_exp_f32 v236, v236
    v_exp_f32 v237, v237
    v_exp_f32 v238, v238
    v_exp_f32 v239, v239
    s_cmp_lg_u32 s40, 0
    s_cbranch_scc1 L_w_20
    s_mov_b32 s17, 21004288
    buffer_load_dword v8, v74, s[20:23], s17 offen sc1
L_w_20:
    s_setprio 3
    s_waitcnt lgkmcnt(0)
    v_mfma_f32_32x32x16_bf16 v[208:223], v[168:171], v[156:159], 0
    v_exp_f32 v240, v240
    v_exp_f32 v241, v241
    s_cmp_ge_u32 s58, 0
    s_cselect_b32 s48, s65, 4048109440
    v_mov_b32 v77, s48
    ds_read2st64_b64 v[164:167], v64 offset0:40 offset1:41
    s_mov_b64 exec, s[62:63]
    ds_read_b64 v[76:77], v64 offset:21504
    s_mov_b64 exec, s[60:61]
    ds_read_b128 v[80:83], v65 offset:15360
    ds_read_b128 v[84:87], v65 offset:16000
    s_mov_b64 exec, -1
    v_exp_f32 v242, v242
    v_exp_f32 v243, v243
    v_smfmac_f32_32x32x32_bf16 v[96:111], v[88:91], v[224:231], v66
    v_exp_f32 v244, v244
    v_exp_f32 v245, v245
    v_exp_f32 v246, v246
    v_exp_f32 v247, v247
    v_mfma_f32_32x32x8_bf16 v[208:223], v[78:79], v[160:161], v[208:223]
    v_exp_f32 v248, v248
    v_exp_f32 v249, v249
    v_exp_f32 v250, v250
    v_exp_f32 v251, v251
    v_smfmac_f32_32x32x32_bf16 v[96:111], v[92:95], v[232:239], v66
    v_exp_f32 v252, v252
    v_exp_f32 v253, v253
    v_exp_f32 v254, v254
    v_exp_f32 v255, v255
    s_setprio 2
    s_waitcnt lgkmcnt(0)
    v_mfma_f32_32x32x16_bf16 v[224:239], v[164:167], v[156:159], v[112:127]
    v_exp_f32 v208, v208
    v_exp_f32 v209, v209
    s_sub_u32 s48, 81920, s69
    v_add_u32 v64, s48, v64
    s_cmp_ge_u32 s58, 0
    s_cselect_b32 s48, s65, 4048109440
    v_mov_b32 v79, s48
    ds_read2st64_b64 v[168:171], v64 offset0:60 offset1:61
    s_mov_b64 exec, s[62:63]
    ds_read_b64 v[78:79], v64 offset:31744
    s_mov_b64 exec, s[60:61]
    ds_read_b128 v[88:91], v65 offset:17920
    ds_read_b128 v[92:95], v65 offset:18560
    s_mov_b64 exec, -1
    v_exp_f32 v210, v210
    v_exp_f32 v211, v211
    v_smfmac_f32_32x32x32_bf16 v[96:111], v[80:83], v[240:247], v66
    v_exp_f32 v212, v212
    v_exp_f32 v213, v213
    v_exp_f32 v214, v214
    v_exp_f32 v215, v215
    v_mfma_f32_32x32x8_bf16 v[224:239], v[76:77], v[160:161], v[224:239]
    v_exp_f32 v216, v216
    v_exp_f32 v217, v217
    v_exp_f32 v218, v218
    v_exp_f32 v219, v219
    v_smfmac_f32_32x32x32_bf16 v[96:111], v[84:87], v[248:255], v66
    v_exp_f32 v220, v220
    v_exp_f32 v221, v221
    v_exp_f32 v222, v222
    v_exp_f32 v223, v223
    s_setprio 1
    s_waitcnt lgkmcnt(0)
    v_mfma_f32_32x32x16_bf16 v[240:255], v[168:171], v[144:147], 0
    v_exp_f32 v224, v224
    v_exp_f32 v225, v225
    s_mov_b64 exec, s[60:61]
    ds_read_b128 v[80:83], v65 offset:20480
    ds_read_b128 v[84:87], v65 offset:21120
    s_mov_b64 exec, -1
    v_exp_f32 v226, v226
    v_exp_f32 v227, v227
    v_smfmac_f32_32x32x32_bf16 v[96:111], v[88:91], v[208:215], v66
    v_exp_f32 v228, v228
    v_exp_f32 v229, v229
    v_exp_f32 v230, v230
    v_exp_f32 v231, v231
    v_mfma_f32_32x32x8_bf16 v[240:255], v[78:79], v[148:149], v[240:255]
    v_exp_f32 v232, v232
    v_exp_f32 v233, v233
    v_exp_f32 v234, v234
    v_exp_f32 v235, v235
    v_smfmac_f32_32x32x32_bf16 v[96:111], v[92:95], v[216:223], v66
    v_exp_f32 v236, v236
    v_exp_f32 v237, v237
    v_exp_f32 v238, v238
    v_exp_f32 v239, v239
    s_setprio 0
    s_waitcnt lgkmcnt(0)
    v_mfma_f32_32x32x16_bf16 v[208:223], v[168:171], v[150:153], 0
    v_exp_f32 v240, v240
    v_exp_f32 v241, v241
    s_sub_u32 s48, 81920, s69
    v_add_u32 v65, s48, v65
    ds_read2st64_b64 v[164:167], v64 offset0:70 offset1:71
    s_mov_b64 exec, s[62:63]
    ds_read_b64 v[76:77], v64 offset:36864
    s_mov_b64 exec, s[60:61]
    ds_read_b128 v[88:91], v65 offset:30720
    ds_read_b128 v[92:95], v65 offset:31360
    s_mov_b64 exec, -1
    v_exp_f32 v242, v242
    v_exp_f32 v243, v243
    v_smfmac_f32_32x32x32_bf16 v[96:111], v[80:83], v[224:231], v66
    v_exp_f32 v244, v244
    v_exp_f32 v245, v245
    v_exp_f32 v246, v246
    v_exp_f32 v247, v247
    v_mfma_f32_32x32x8_bf16 v[208:223], v[78:79], v[154:155], v[208:223]
    v_exp_f32 v248, v248
    v_exp_f32 v249, v249
    v_exp_f32 v250, v250
    v_exp_f32 v251, v251
    v_smfmac_f32_32x32x32_bf16 v[96:111], v[84:87], v[232:239], v66
    v_exp_f32 v252, v252
    v_exp_f32 v253, v253
    v_exp_f32 v254, v254
    v_exp_f32 v255, v255
    s_cmp_lg_u32 s40, 0
    s_cbranch_scc1 L_w_21
    s_mov_b32 s70, 0x20000
    s_waitcnt vmcnt(0)
L_spin_22:
    v_cmp_eq_u32 s[32:33], s3, v8
    s_cmp_eq_u64 s[32:33], -1
    s_cbranch_scc1 L_w_21
    s_sleep 4
    s_mov_b32 s17, 21004288
    buffer_load_dword v8, v74, s[20:23], s17 offen sc1
    s_sub_u32 s70, s70, 1
    s_cmp_lg_u32 s70, 0
    s_waitcnt vmcnt(0)
    s_cbranch_scc1 L_spin_22
L_w_21:
    s_setprio 3
    s_waitcnt lgkmcnt(0)
    v_mfma_f32_32x32x16_bf16 v[224:239], v[164:167], v[144:147], 0
    v_exp_f32 v208, v208
    v_exp_f32 v209, v209
    v_exp_f32 v210, v210
    v_exp_f32 v211, v211
    v_smfmac_f32_32x32x32_bf16 v[128:143], v[88:91], v[240:247], v66
    v_exp_f32 v212, v212
    v_exp_f32 v213, v213
    v_mov_b32 v17, 0x7f800000
    v_maximum3_f32 v15, abs(v96), abs(v97), abs(v98)
    v_maximum3_f32 v16, abs(v99), abs(v100), abs(v101)
    v_maximum3_f32 v15, v15, abs(v102), abs(v103)
    v_exp_f32 v214, v214
    v_exp_f32 v215, v215
    v_mfma_f32_32x32x8_bf16 v[224:239], v[76:77], v[148:149], v[224:239]
    v_exp_f32 v216, v216
    v_exp_f32 v217, v217
    v_maximum3_f32 v16, v16, abs(v104), abs(v105)
    v_maximum3_f32 v15, v15, abs(v106), abs(v107)
    v_maximum3_f32 v15, v15, v16, abs(v108)
    v_cmp_nlt_f32 vcc, v15, v17
    v_cmp_gt_f32 s[52:53], s46, v108
    s_or_b64 vcc, vcc, s[52:53]
    s_cmp_lg_u64 vcc, 0
    s_cselect_b32 s47, 1, 0
    v_exp_f32 v218, v218
    v_exp_f32 v219, v219
    v_smfmac_f32_32x32x32_bf16 v[128:143], v[92:95], v[248:255], v66
    v_exp_f32 v220, v220
    v_exp_f32 v221, v221
    v_rcp_f32 v15, v108
    s_add_u32 s49, s28, 0
    s_add_u32 s51, s29, 0
    v_mul_f32 v96, v96, v15
    v_mul_f32 v97, v97, v15
    v_mul_f32 v98, v98, v15
    v_mul_f32 v99, v99, v15
    v_mul_f32 v100, v100, v15
    v_mul_f32 v101, v101, v15
    v_exp_f32 v222, v222
    v_exp_f32 v223, v223
    s_setprio 2
    s_waitcnt lgkmcnt(0)
    v_mfma_f32_32x32x16_bf16 v[240:255], v[164:167], v[150:153], 0
    v_exp_f32 v224, v224
    v_exp_f32 v225, v225
    v_add_u32 v64, 40960, v64
    ds_read2st64_b64 v[168:171], v64 offset0:0 offset1:1
    s_mov_b64 exec, s[62:63]
    ds_read_b64 v[78:79], v64 offset:1024
    s_mov_b64 exec, s[60:61]
    ds_read_b128 v[80:83], v65 offset:35840
    ds_read_b128 v[84:87], v65 offset:36480
    s_mov_b64 exec, -1
    v_exp_f32 v226, v226
    v_exp_f32 v227, v227
    v_smfmac_f32_32x32x32_bf16 v[172:187], v[88:91], v[208:215], v66
    v_exp_f32 v228, v228
    v_exp_f32 v229, v229
    v_mul_f32 v102, v102, v15
    v_mul_f32 v103, v103, v15
    v_mul_f32 v104, v104, v15
    v_mul_f32 v105, v105, v15
    v_mul_f32 v106, v106, v15
    v_mul_f32 v107, v107, v15
    v_cvt_pk_bf16_f32 v18, v96, v97
    v_cvt_pk_bf16_f32 v19, v98, v99
    v_cvt_pk_bf16_f32 v20, v100, v101
    v_cvt_pk_bf16_f32 v21, v102, v103
    v_cvt_pk_bf16_f32 v22, v104, v105
    v_cvt_pk_bf16_f32 v23, v106, v107
    s_cmp_lg_u32 s47, 0
    s_cbranch_scc1 L_nostA
    buffer_store_dwordx4 v[18:21], v67, s[20:23], s49 offen sc1
    s_mov_b64 exec, s[62:63]
    buffer_store_dwordx2 v[22:23], v67, s[20:23], s51 offen sc1
    s_mov_b64 exec, -1
L_nostA:
    v_exp_f32 v230, v230
    v_exp_f32 v231, v231
    v_mfma_f32_32x32x8_bf16 v[240:255], v[76:77], v[154:155], v[240:255]
    v_exp_f32 v232, v232
    v_exp_f32 v233, v233
    v_exp_f32 v234, v234
    v_exp_f32 v235, v235
    v_smfmac_f32_32x32x32_bf16 v[172:187], v[92:95], v[216:223], v66
    v_exp_f32 v236, v236
    v_exp_f32 v237, v237
    v_exp_f32 v238, v238
    v_exp_f32 v239, v239
    s_setprio 1
    s_waitcnt lgkmcnt(0)
    v_mfma_f32_32x32x16_bf16 v[208:223], v[168:171], v[144:147], 0
    v_exp_f32 v240, v240
    v_exp_f32 v241, v241
    v_exp_f32 v242, v242
    v_exp_f32 v243, v243
    v_smfmac_f32_32x32x32_bf16 v[128:143], v[80:83], v[224:231], v66
    v_exp_f32 v244, v244
    v_exp_f32 v245, v245
    v_exp_f32 v246, v246
    v_exp_f32 v247, v247
    v_mfma_f32_32x32x8_bf16 v[208:223], v[78:79], v[148:149], v[208:223]
    v_exp_f32 v248, v248
    v_exp_f32 v249, v249
    v_exp_f32 v250, v250
    v_exp_f32 v251, v251
    v_smfmac_f32_32x32x32_bf16 v[128:143], v[84:87], v[232:239], v66
    v_exp_f32 v252, v252
    v_exp_f32 v253, v253
    v_exp_f32 v254, v254
    v_exp_f32 v255, v255
    s_setprio 0
    s_waitcnt lgkmcnt(0)
    v_mfma_f32_32x32x16_bf16 v[224:239], v[168:171], v[150:153], 0
    v_exp_f32 v208, v208
    v_exp_f32 v209, v209
    v_add_u32 v65, 40960, v65
    ds_read2st64_b64 v[164:167], v64 offset0:10 offset1:11
    s_mov_b64 exec, s[62:63]
    ds_read_b64 v[76:77], v64 offset:6144
    s_mov_b64 exec, s[60:61]
    ds_read_b128 v[88:91], v65 offset:0
    ds_read_b128 v[92:95], v65 offset:640
    s_mov_b64 exec, -1
    v_exp_f32 v210, v210
    v_exp_f32 v211, v211
    v_smfmac_f32_32x32x32_bf16 v[172:187], v[80:83], v[240:247], v66
    v_exp_f32 v212, v212
    v_exp_f32 v213, v213
    v_exp_f32 v214, v214
    v_exp_f32 v215, v215
    v_mfma_f32_32x32x8_bf16 v[224:239], v[78:79], v[154:155], v[224:239]
    v_exp_f32 v216, v216
    v_exp_f32 v217, v217
    v_exp_f32 v218, v218
    v_exp_f32 v219, v219
    v_smfmac_f32_32x32x32_bf16 v[172:187], v[84:87], v[248:255], v66
    v_exp_f32 v220, v220
    v_exp_f32 v221, v221
    v_exp_f32 v222, v222
    v_exp_f32 v223, v223
    s_barrier
    s_setprio 3
    s_waitcnt lgkmcnt(0)
    v_mfma_f32_32x32x16_bf16 v[240:255], v[164:167], v[144:147], 0
    v_exp_f32 v224, v224
    v_exp_f32 v225, v225
    v_exp_f32 v226, v226
    v_exp_f32 v227, v227
    v_smfmac_f32_32x32x32_bf16 v[128:143], v[88:91], v[208:215], v66
    v_exp_f32 v228, v228
    v_exp_f32 v229, v229
    s_add_u32 m0, s59, 20480
    s_add_u32 s50, s34, 22020096
    buffer_load_dwordx4 v67, s[20:23], s50 offen sc1 lds
    v_exp_f32 v230, v230
    v_exp_f32 v231, v231
    v_mfma_f32_32x32x8_bf16 v[240:255], v[76:77], v[148:149], v[240:255]
    v_exp_f32 v232, v232
    v_exp_f32 v233, v233
    s_add_u32 m0, s59, 28672
    s_add_u32 s50, s34, 22028288
    buffer_load_dwordx4 v67, s[20:23], s50 offen sc1 lds
    v_exp_f32 v234, v234
    v_exp_f32 v235, v235
    v_smfmac_f32_32x32x32_bf16 v[128:143], v[92:95], v[216:223], v66
    v_exp_f32 v236, v236
    v_exp_f32 v237, v237
    v_exp_f32 v238, v238
    v_exp_f32 v239, v239
    s_setprio 2
    s_waitcnt lgkmcnt(0)
    v_mfma_f32_32x32x16_bf16 v[208:223], v[164:167], v[150:153], 0
    v_exp_f32 v240, v240
    v_exp_f32 v241, v241
    ds_read2st64_b64 v[168:171], v64 offset0:20 offset1:21
    s_mov_b64 exec, s[62:63]
    ds_read_b64 v[78:79], v64 offset:11264
    s_mov_b64 exec, s[60:61]
    ds_read_b128 v[80:83], v65 offset:5120
    ds_read_b128 v[84:87], v65 offset:5760
    s_mov_b64 exec, -1
    v_exp_f32 v242, v242
    v_exp_f32 v243, v243
    v_smfmac_f32_32x32x32_bf16 v[172:187], v[88:91], v[224:231], v66
    v_exp_f32 v244, v244
    v_exp_f32 v245, v245
    s_add_u32 m0, s59, 36864
    s_add_u32 s50, s34, 22036480
    buffer_load_dwordx4 v67, s[20:23], s50 offen sc1 lds
    v_exp_f32 v246, v246
    v_exp_f32 v247, v247
    v_mfma_f32_32x32x8_bf16 v[208:223], v[76:77], v[154:155], v[208:223]
    v_exp_f32 v248, v248
    v_exp_f32 v249, v249
    s_add_u32 m0, s59, 45056
    s_add_u32 s50, s34, 22044672
    buffer_load_dwordx4 v67, s[20:23], s50 offen sc1 lds
    v_exp_f32 v250, v250
    v_exp_f32 v251, v251
    v_smfmac_f32_32x32x32_bf16 v[172:187], v[92:95], v[232:239], v66
    v_exp_f32 v252, v252
    v_exp_f32 v253, v253
    v_exp_f32 v254, v254
    v_exp_f32 v255, v255
    s_setprio 1
    s_waitcnt lgkmcnt(0)
    v_mfma_f32_32x32x16_bf16 v[224:239], v[168:171], v[144:147], 0
    v_exp_f32 v208, v208
    v_exp_f32 v209, v209
    v_exp_f32 v210, v210
    v_exp_f32 v211, v211
    v_smfmac_f32_32x32x32_bf16 v[128:143], v[80:83], v[240:247], v66
    v_exp_f32 v212, v212
    v_exp_f32 v213, v213
    s_add_u32 m0, s59, 53248
    s_add_u32 s50, s34, 22052864
    buffer_load_dwordx4 v67, s[20:23], s50 offen sc1 lds
    v_exp_f32 v214, v214
    v_exp_f32 v215, v215
    v_mfma_f32_32x32x8_bf16 v[224:239], v[78:79], v[148:149], v[224:239]
    v_exp_f32 v216, v216
    v_exp_f32 v217, v217
    s_add_u32 m0, s59, 61440
    s_add_u32 s50, s34, 22061056
    buffer_load_dwordx4 v67, s[20:23], s50 offen sc1 lds
    v_exp_f32 v218, v218
    v_exp_f32 v219, v219
    v_smfmac_f32_32x32x32_bf16 v[128:143], v[84:87], v[248:255], v66
    v_exp_f32 v220, v220
    v_exp_f32 v221, v221
    v_exp_f32 v222, v222
    v_exp_f32 v223, v223
    s_setprio 0
    s_waitcnt lgkmcnt(0)
    v_mfma_f32_32x32x16_bf16 v[240:255], v[168:171], v[150:153], 0
    v_exp_f32 v224, v224
    v_exp_f32 v225, v225
    ds_read2st64_b64 v[164:167], v64 offset0:30 offset1:31
    s_mov_b64 exec, s[62:63]
    ds_read_b64 v[76:77], v64 offset:16384
    s_mov_b64 exec, s[60:61]
    ds_read_b128 v[88:91], v65 offset:10240
    ds_read_b128 v[92:95], v65 offset:10880
    s_mov_b64 exec, -1
    v_exp_f32 v226, v226
    v_exp_f32 v227, v227
    v_smfmac_f32_32x32x32_bf16 v[172:187], v[80:83], v[208:215], v66
    v_exp_f32 v228, v228
    v_exp_f32 v229, v229
    s_add_u32 m0, s59, 69632
    s_add_u32 s50, s34, 22069248
    buffer_load_dwordx4 v67, s[20:23], s50 offen sc1 lds
    v_exp_f32 v230, v230
    v_exp_f32 v231, v231
    v_mfma_f32_32x32x8_bf16 v[240:255], v[78:79], v[154:155], v[240:255]
    v_exp_f32 v232, v232
    v_exp_f32 v233, v233
    s_add_u32 m0, s59, 77824
    s_add_u32 s50, s34, 22077440
    buffer_load_dwordx4 v67, s[20:23], s50 offen sc1 lds
    v_exp_f32 v234, v234
    v_exp_f32 v235, v235
    v_smfmac_f32_32x32x32_bf16 v[172:187], v[84:87], v[216:223], v66
    v_exp_f32 v236, v236
    v_exp_f32 v237, v237
    v_exp_f32 v238, v238
    v_exp_f32 v239, v239
    s_setprio 3
    s_waitcnt lgkmcnt(0)
    v_mfma_f32_32x32x16_bf16 v[208:223], v[164:167], v[144:147], 0
    v_exp_f32 v240, v240
    v_exp_f32 v241, v241
    v_exp_f32 v242, v242
    v_exp_f32 v243, v243
    v_smfmac_f32_32x32x32_bf16 v[128:143], v[88:91], v[224:231], v66
    v_exp_f32 v244, v244
    v_exp_f32 v245, v245
    s_add_u32 m0, s59, 86016
    s_add_u32 s50, s34, 22085632
    buffer_load_dwordx4 v67, s[20:23], s50 offen sc1 lds
    v_exp_f32 v246, v246
    v_exp_f32 v247, v247
    v_mfma_f32_32x32x8_bf16 v[208:223], v[76:77], v[148:149], v[208:223]
    v_exp_f32 v248, v248
    v_exp_f32 v249, v249
    s_add_u32 m0, s59, 94208
    s_add_u32 s50, s34, 22093824
    buffer_load_dwordx4 v67, s[20:23], s50 offen sc1 lds
    v_exp_f32 v250, v250
    v_exp_f32 v251, v251
    v_smfmac_f32_32x32x32_bf16 v[128:143], v[92:95], v[232:239], v66
    v_exp_f32 v252, v252
    v_exp_f32 v253, v253
    v_exp_f32 v254, v254
    v_exp_f32 v255, v255
    s_setprio 2
    s_waitcnt lgkmcnt(0)
    v_mfma_f32_32x32x16_bf16 v[224:239], v[164:167], v[150:153], 0
    v_exp_f32 v208, v208
    v_exp_f32 v209, v209
    ds_read2st64_b64 v[168:171], v64 offset0:40 offset1:41
    s_mov_b64 exec, s[62:63]
    ds_read_b64 v[78:79], v64 offset:21504
    s_mov_b64 exec, s[60:61]
    ds_read_b128 v[80:83], v65 offset:15360
    ds_read_b128 v[84:87], v65 offset:16000
    s_mov_b64 exec, -1
    v_exp_f32 v210, v210
    v_exp_f32 v211, v211
    v_smfmac_f32_32x32x32_bf16 v[172:187], v[88:91], v[240:247], v66
    v_exp_f32 v212, v212
    v_exp_f32 v213, v213
    s_add_u32 m0, s59, 102400
    s_add_u32 s50, s34, 22102016
    buffer_load_dwordx4 v67, s[20:23], s50 offen sc1 lds
    v_exp_f32 v214, v214
    v_exp_f32 v215, v215
    v_mfma_f32_32x32x8_bf16 v[224:239], v[76:77], v[154:155], v[224:239]
    v_exp_f32 v216, v216
    v_exp_f32 v217, v217
    s_add_u32 m0, s59, 110592
    s_add_u32 s50, s34, 22110208
    buffer_load_dwordx4 v67, s[20:23], s50 offen sc1 lds
    v_exp_f32 v218, v218
    v_exp_f32 v219, v219
    v_smfmac_f32_32x32x32_bf16 v[172:187], v[92:95], v[248:255], v66
    v_exp_f32 v220, v220
    v_exp_f32 v221, v221
    v_exp_f32 v222, v222
    v_exp_f32 v223, v223
    s_setprio 1
    s_waitcnt lgkmcnt(0)
    v_mfma_f32_32x32x16_bf16 v[240:255], v[168:171], v[144:147], 0
    v_exp_f32 v224, v224
    v_exp_f32 v225, v225
    v_exp_f32 v226, v226
    v_exp_f32 v227, v227
    v_smfmac_f32_32x32x32_bf16 v[128:143], v[80:83], v[208:215], v66
    v_exp_f32 v228, v228
    v_exp_f32 v229, v229
    s_cmp_ge_u32 s40, 4
    s_cbranch_scc1 L_wo_10
    s_add_u32 m0, s59, 118784
    s_add_u32 s50, s34, 22118400
    buffer_load_dwordx4 v67, s[20:23], s50 offen sc1 lds
L_wo_10:
    v_exp_f32 v230, v230
    v_exp_f32 v231, v231
    v_mfma_f32_32x32x8_bf16 v[240:255], v[78:79], v[148:149], v[240:255]
    v_exp_f32 v232, v232
    v_exp_f32 v233, v233
    s_add_u32 m0, s59, 0
    s_add_u32 s50, s34, 22839296
    buffer_load_dwordx4 v67, s[20:23], s50 offen sc1 lds
    v_exp_f32 v234, v234
    v_exp_f32 v235, v235
    v_smfmac_f32_32x32x32_bf16 v[128:143], v[84:87], v[216:223], v66
    v_exp_f32 v236, v236
    v_exp_f32 v237, v237
    v_exp_f32 v238, v238
    v_exp_f32 v239, v239
    s_setprio 0
    s_waitcnt lgkmcnt(0)
    v_mfma_f32_32x32x16_bf16 v[208:223], v[168:171], v[150:153], 0
    v_exp_f32 v240, v240
    v_exp_f32 v241, v241
    ds_read2st64_b64 v[164:167], v64 offset0:50 offset1:51
    s_mov_b64 exec, s[62:63]
    ds_read_b64 v[76:77], v64 offset:26624
    s_mov_b64 exec, s[60:61]
    ds_read_b128 v[88:91], v65 offset:20480
    ds_read_b128 v[92:95], v65 offset:21120
    s_mov_b64 exec, -1
    v_exp_f32 v242, v242
    v_exp_f32 v243, v243
    v_smfmac_f32_32x32x32_bf16 v[172:187], v[80:83], v[224:231], v66
    v_exp_f32 v244, v244
    v_exp_f32 v245, v245
    s_add_u32 m0, s59, 8192
    s_add_u32 s50, s34, 22847488
    buffer_load_dwordx4 v67, s[20:23], s50 offen sc1 lds
    v_exp_f32 v246, v246
    v_exp_f32 v247, v247
    v_mfma_f32_32x32x8_bf16 v[208:223], v[78:79], v[154:155], v[208:223]
    v_exp_f32 v248, v248
    v_exp_f32 v249, v249
    s_cmp_ge_u32 s40, 4
    s_cbranch_scc1 L_wo_11
    s_add_u32 m0, s59, 16384
    s_add_u32 s50, s34, 22855680
    buffer_load_dwordx4 v67, s[20:23], s50 offen sc1 lds
L_wo_11:
    v_exp_f32 v250, v250
    v_exp_f32 v251, v251
    v_smfmac_f32_32x32x32_bf16 v[172:187], v[84:87], v[232:239], v66
    v_exp_f32 v252, v252
    v_exp_f32 v253, v253
    v_exp_f32 v254, v254
    v_exp_f32 v255, v255
    s_setprio 3
    s_waitcnt lgkmcnt(0)
    v_mfma_f32_32x32x16_bf16 v[224:239], v[164:167], v[144:147], 0
    v_exp_f32 v208, v208
    v_exp_f32 v209, v209
    v_exp_f32 v210, v210
    v_exp_f32 v211, v211
    v_smfmac_f32_32x32x32_bf16 v[128:143], v[88:91], v[240:247], v66
    v_exp_f32 v212, v212
    v_exp_f32 v213, v213
    v_exp_f32 v214, v214
    v_exp_f32 v215, v215
    v_mfma_f32_32x32x8_bf16 v[224:239], v[76:77], v[148:149], v[224:239]
    v_exp_f32 v216, v216
    v_exp_f32 v217, v217
    v_exp_f32 v218, v218
    v_exp_f32 v219, v219
    v_smfmac_f32_32x32x32_bf16 v[128:143], v[92:95], v[248:255], v66
    v_exp_f32 v220, v220
    v_exp_f32 v221, v221
    v_exp_f32 v222, v222
    v_exp_f32 v223, v223
    s_setprio 2
    s_waitcnt lgkmcnt(0)
    v_mfma_f32_32x32x16_bf16 v[240:255], v[164:167], v[150:153], 0
    v_exp_f32 v224, v224
    v_exp_f32 v225, v225
    ds_read2st64_b64 v[168:171], v64 offset0:60 offset1:61
    s_mov_b64 exec, s[62:63]
    ds_read_b64 v[78:79], v64 offset:31744
    s_mov_b64 exec, s[60:61]
    ds_read_b128 v[80:83], v65 offset:25600
    ds_read_b128 v[84:87], v65 offset:26240
    s_mov_b64 exec, -1
    v_exp_f32 v226, v226
    v_exp_f32 v227, v227
    v_smfmac_f32_32x32x32_bf16 v[172:187], v[88:91], v[208:215], v66
    v_exp_f32 v228, v228
    v_exp_f32 v229, v229
    s_add_u32 s53, s30, 0
    buffer_load_dwordx4 v[24:27], v69, s[20:23], s53 offen offset:0 sc1
    v_exp_f32 v230, v230
    v_exp_f32 v231, v231
    v_mfma_f32_32x32x8_bf16 v[240:255], v[76:77], v[154:155], v[240:255]
    v_exp_f32 v232, v232
    v_exp_f32 v233, v233
    s_add_u32 s53, s30, 0
    buffer_load_dwordx4 v[28:31], v69, s[20:23], s53 offen offset:2048 sc1
    v_exp_f32 v234, v234
    v_exp_f32 v235, v235
    v_smfmac_f32_32x32x32_bf16 v[172:187], v[92:95], v[216:223], v66
    v_exp_f32 v236, v236
    v_exp_f32 v237, v237
    v_exp_f32 v238, v238
    v_exp_f32 v239, v239
    s_setprio 1
    s_waitcnt lgkmcnt(0)
    v_mfma_f32_32x32x16_bf16 v[208:223], v[168:171], v[144:147], 0
    v_exp_f32 v240, v240
    v_exp_f32 v241, v241
    v_exp_f32 v242, v242
    v_exp_f32 v243, v243
    v_smfmac_f32_32x32x32_bf16 v[128:143], v[80:83], v[224:231], v66
    v_exp_f32 v244, v244
    v_exp_f32 v245, v245
    s_add_u32 s53, s30, 4096
    buffer_load_dwordx4 v[32:35], v69, s[20:23], s53 offen offset:0 sc1
    v_exp_f32 v246, v246
    v_exp_f32 v247, v247
    v_mfma_f32_32x32x8_bf16 v[208:223], v[78:79], v[148:149], v[208:223]
    v_exp_f32 v248, v248
    v_exp_f32 v249, v249
    s_add_u32 s53, s30, 4096
    buffer_load_dwordx4 v[36:39], v69, s[20:23], s53 offen offset:2048 sc1
    v_exp_f32 v250, v250
    v_exp_f32 v251, v251
    v_smfmac_f32_32x32x32_bf16 v[128:143], v[84:87], v[232:239], v66
    v_exp_f32 v252, v252
    v_exp_f32 v253, v253
    v_exp_f32 v254, v254
    v_exp_f32 v255, v255
    s_barrier
    s_setprio 3
    s_waitcnt lgkmcnt(0)
    v_mfma_f32_32x32x16_bf16 v[224:239], v[168:171], v[150:153], 0
    v_exp_f32 v208, v208
    v_exp_f32 v209, v209
    ds_read2st64_b64 v[164:167], v64 offset0:70 offset1:71
    s_mov_b64 exec, s[62:63]
    ds_read_b64 v[76:77], v64 offset:36864
    s_mov_b64 exec, s[60:61]
    ds_read_b128 v[88:91], v65 offset:30720
    ds_read_b128 v[92:95], v65 offset:31360
    s_mov_b64 exec, -1
    v_exp_f32 v210, v210
    v_exp_f32 v211, v211
    v_smfmac_f32_32x32x32_bf16 v[172:187], v[80:83], v[240:247], v66
    v_exp_f32 v212, v212
    v_exp_f32 v213, v213
    s_add_u32 s53, s30, 8192
    buffer_load_dwordx4 v[40:43], v69, s[20:23], s53 offen offset:0 sc1
    v_exp_f32 v214, v214
    v_exp_f32 v215, v215
    v_mfma_f32_32x32x8_bf16 v[224:239], v[78:79], v[154:155], v[224:239]
    v_exp_f32 v216, v216
    v_exp_f32 v217, v217
    s_add_u32 s53, s30, 8192
    buffer_load_dwordx4 v[44:47], v69, s[20:23], s53 offen offset:2048 sc1
    v_exp_f32 v218, v218
    v_exp_f32 v219, v219
    v_smfmac_f32_32x32x32_bf16 v[172:187], v[84:87], v[248:255], v66
    v_exp_f32 v220, v220
    v_exp_f32 v221, v221
    v_exp_f32 v222, v222
    v_exp_f32 v223, v223
    s_setprio 2
    s_waitcnt lgkmcnt(0)
    v_mfma_f32_32x32x16_bf16 v[240:255], v[164:167], v[144:147], 0
    v_exp_f32 v224, v224
    v_exp_f32 v225, v225
    v_exp_f32 v226, v226
    v_exp_f32 v227, v227
    v_smfmac_f32_32x32x32_bf16 v[128:143], v[88:91], v[208:215], v66
    v_exp_f32 v228, v228
    v_exp_f32 v229, v229
    s_add_u32 s53, s30, 12288
    buffer_load_dwordx4 v[48:51], v69, s[20:23], s53 offen offset:0 sc1
    v_exp_f32 v230, v230
    v_exp_f32 v231, v231
    v_mfma_f32_32x32x8_bf16 v[240:255], v[76:77], v[148:149], v[240:255]
    v_exp_f32 v232, v232
    v_exp_f32 v233, v233
    s_add_u32 s53, s30, 12288
    buffer_load_dwordx4 v[52:55], v69, s[20:23], s53 offen offset:2048 sc1
    v_exp_f32 v234, v234
    v_exp_f32 v235, v235
    v_smfmac_f32_32x32x32_bf16 v[128:143], v[92:95], v[216:223], v66
    v_exp_f32 v236, v236
    v_exp_f32 v237, v237
    v_exp_f32 v238, v238
    v_exp_f32 v239, v239
    s_setprio 1
    s_waitcnt lgkmcnt(0)
    v_mfma_f32_32x32x16_bf16 v[208:223], v[164:167], v[150:153], 0
    v_exp_f32 v240, v240
    v_exp_f32 v241, v241
    s_mov_b64 exec, s[60:61]
    ds_read_b128 v[80:83], v65 offset:35840
    ds_read_b128 v[84:87], v65 offset:36480
    s_mov_b64 exec, -1
    v_exp_f32 v242, v242
    v_exp_f32 v243, v243
    v_smfmac_f32_32x32x32_bf16 v[172:187], v[88:91], v[224:231], v66
    v_exp_f32 v244, v244
    v_exp_f32 v245, v245
    s_add_u32 s53, s31, 0
    buffer_load_dwordx4 v[56:59], v69, s[20:23], s53 offen offset:0 sc1
    v_exp_f32 v246, v246
    v_exp_f32 v247, v247
    v_mfma_f32_32x32x8_bf16 v[208:223], v[76:77], v[154:155], v[208:223]
    v_exp_f32 v248, v248
    v_exp_f32 v249, v249
    s_add_u32 s53, s31, 0
    buffer_load_dwordx4 v[60:63], v69, s[20:23], s53 offen offset:2048 sc1
    v_exp_f32 v250, v250
    v_exp_f32 v251, v251
    v_smfmac_f32_32x32x32_bf16 v[172:187], v[92:95], v[232:239], v66
    v_exp_f32 v252, v252
    v_exp_f32 v253, v253
    v_exp_f32 v254, v254
    v_exp_f32 v255, v255
    s_setprio 0
    s_waitcnt lgkmcnt(0)
    v_smfmac_f32_32x32x32_bf16 v[128:143], v[80:83], v[240:247], v66
    v_exp_f32 v208, v208
    v_exp_f32 v209, v209
    v_exp_f32 v210, v210
    v_exp_f32 v211, v211
    v_smfmac_f32_32x32x32_bf16 v[128:143], v[84:87], v[248:255], v66
    v_exp_f32 v212, v212
    v_exp_f32 v213, v213
    v_exp_f32 v214, v214
    v_exp_f32 v215, v215
    v_exp_f32 v216, v216
    v_exp_f32 v217, v217
    v_exp_f32 v218, v218
    v_exp_f32 v219, v219
    v_exp_f32 v220, v220
    v_exp_f32 v221, v221
    v_exp_f32 v222, v222
    v_exp_f32 v223, v223
    s_setprio 3
    s_waitcnt lgkmcnt(0)
    s_nop 1
    v_smfmac_f32_32x32x32_bf16 v[172:187], v[80:83], v[208:215], v66
    v_smfmac_f32_32x32x32_bf16 v[172:187], v[84:87], v[216:223], v66
    s_setprio 0
    s_mul_i32 s48, s41, 3328
    s_add_u32 s48, s48, 122880
    v_add_u32 v10, s48, v67
    v_lshl_add_u32 v11, v0, 2, s48
    v_add_u32 v12, 61440, v70
    s_nop 4
    s_cmp_ge_u32 s40, 4
    s_cbranch_scc1 L_cb1
    ds_write_b128 v10, v[172:175] offset:0
    ds_write_b128 v10, v[176:179] offset:1024
    ds_write_b128 v10, v[180:183] offset:2048
    ds_write_b32 v11, v184 offset:3072
    s_waitcnt lgkmcnt(0) vmcnt(10)
    s_barrier
    ds_read_b32 v236, v11 offset:16384
    ds_read_b128 v[224:227], v10 offset:13312
    ds_read_b128 v[228:231], v10 offset:14336
    ds_read_b128 v[232:235], v10 offset:15360
    s_waitcnt lgkmcnt(3)
    v_add_f32 v140, v140, v236
    s_waitcnt lgkmcnt(2)
    v_add_f32 v128, v128, v224
    v_add_f32 v129, v129, v225
    v_add_f32 v130, v130, v226
    v_add_f32 v131, v131, v227
    s_waitcnt lgkmcnt(1)
    v_add_f32 v132, v132, v228
    v_add_f32 v133, v133, v229
    v_add_f32 v134, v134, v230
    v_add_f32 v135, v135, v231
    s_waitcnt lgkmcnt(0)
    v_add_f32 v136, v136, v232
    v_add_f32 v137, v137, v233
    v_add_f32 v138, v138, v234
    v_add_f32 v139, v139, v235
    s_branch L_cb2
L_cb1:
    ds_write_b128 v10, v[128:131] offset:13312
    ds_write_b128 v10, v[132:135] offset:14336
    ds_write_b128 v10, v[136:139] offset:15360
    ds_write_b32 v11, v140 offset:16384
    s_waitcnt lgkmcnt(0) vmcnt(10)
    s_barrier
    ds_read_b32 v236, v11 offset:3072
    ds_read_b128 v[224:227], v10 offset:0
    ds_read_b128 v[228:231], v10 offset:1024
    ds_read_b128 v[232:235], v10 offset:2048
    s_waitcnt lgkmcnt(3)
    v_add_f32 v140, v184, v236
    s_waitcnt lgkmcnt(2)
    v_add_f32 v128, v172, v224
    v_add_f32 v129, v173, v225
    v_add_f32 v130, v174, v226
    v_add_f32 v131, v175, v227
    s_waitcnt lgkmcnt(1)
    v_add_f32 v132, v176, v228
    v_add_f32 v133, v177, v229
    v_add_f32 v134, v178, v230
    v_add_f32 v135, v179, v231
    s_waitcnt lgkmcnt(0)
    v_add_f32 v136, v180, v232
    v_add_f32 v137, v181, v233
    v_add_f32 v138, v182, v234
    v_add_f32 v139, v183, v235
    v_mov_b32 v144, v150
    v_mov_b32 v145, v151
    v_mov_b32 v146, v152
    v_mov_b32 v147, v153
    v_mov_b32 v148, v154
    v_mov_b32 v149, v155
L_cb2:
    s_cmp_lg_u32 s47, 0
    s_cbranch_scc1 L_slowA
L_chkB:
    v_mov_b32 v17, 0x7f800000
    v_maximum3_f32 v15, abs(v128), abs(v129), abs(v130)
    v_maximum3_f32 v16, abs(v131), abs(v132), abs(v133)
    v_maximum3_f32 v15, v15, abs(v134), abs(v135)
    v_maximum3_f32 v16, v16, abs(v136), abs(v137)
    v_maximum3_f32 v15, v15, abs(v138), abs(v139)
    v_maximum3_f32 v15, v15, v16, abs(v140)
    v_cmp_nlt_f32 vcc, v15, v17
    v_cmp_gt_f32 s[52:53], s46, v140
    s_or_b64 vcc, vcc, s[52:53]
    s_cbranch_vccnz L_slowB
L_epiB:
    ds_read_b128 v[76:79], v70 offset:20480
    ds_read_b128 v[80:83], v70 offset:21504
    ds_read_b128 v[84:87], v70 offset:22528
    ds_read_b128 v[88:91], v70 offset:23552
    ds_read_b128 v[92:95], v70 offset:24576
    ds_read_b128 v[96:99], v70 offset:30720
    ds_read_b128 v[100:103], v70 offset:31744
    ds_read_b128 v[104:107], v70 offset:32768
    ds_read_b128 v[108:111], v70 offset:33792
    ds_read_b128 v[112:115], v70 offset:34816
    v_rcp_f32 v15, v140
    s_add_u32 s49, s28, 2621440
    s_add_u32 s51, s29, 2621440
    v_mul_f32 v128, v128, v15
    v_mul_f32 v129, v129, v15
    v_mul_f32 v130, v130, v15
    v_mul_f32 v131, v131, v15
    v_mul_f32 v132, v132, v15
    v_mul_f32 v133, v133, v15
    v_mul_f32 v134, v134, v15
    v_mul_f32 v135, v135, v15
    v_mul_f32 v136, v136, v15
    v_mul_f32 v137, v137, v15
    v_mul_f32 v138, v138, v15
    v_mul_f32 v139, v139, v15
    v_cvt_pk_bf16_f32 v18, v128, v129
    v_cvt_pk_bf16_f32 v19, v130, v131
    v_cvt_pk_bf16_f32 v20, v132, v133
    v_cvt_pk_bf16_f32 v21, v134, v135
    v_cvt_pk_bf16_f32 v22, v136, v137
    v_cvt_pk_bf16_f32 v23, v138, v139
    buffer_store_dwordx4 v[18:21], v67, s[20:23], s49 offen sc1
    s_mov_b64 exec, s[62:63]
    buffer_store_dwordx2 v[22:23], v67, s[20:23], s51 offen sc1
    s_mov_b64 exec, -1
    s_mov_b32 s70, 0x20000
    s_waitcnt vmcnt(11)
L_gw0_0:
    v_max3_u32 v10, v24, v25, v26
    v_max_u32 v10, v10, v27
    v_cmp_eq_u32 vcc, -1, v10
    s_cbranch_vccnz L_gr0_0
L_gc0_0:
    s_waitcnt lgkmcnt(5)
    v_mfma_f32_16x16x32_bf16 v[208:211], v[76:79], v[24:27], 0
    ds_read_b128 v[116:119], v70 offset:40960
    v_mfma_f32_16x16x32_bf16 v[212:215], v[80:83], v[24:27], 0
    ds_read_b128 v[120:123], v70 offset:41984
    v_mfma_f32_16x16x32_bf16 v[216:219], v[84:87], v[24:27], 0
    ds_read_b128 v[124:127], v70 offset:43008
    v_mfma_f32_16x16x32_bf16 v[220:223], v[88:91], v[24:27], 0
    ds_read_b128 v[128:131], v70 offset:44032
    v_mfma_f32_16x16x32_bf16 v[224:227], v[92:95], v[24:27], 0
    ds_read_b128 v[132:135], v70 offset:45056
    s_barrier
    s_waitcnt vmcnt(10)
L_gw0_1:
    v_max3_u32 v10, v28, v29, v30
    v_max_u32 v10, v10, v31
    v_cmp_eq_u32 vcc, -1, v10
    s_cbranch_vccnz L_gr0_1
L_gc0_1:
    s_waitcnt lgkmcnt(5)
    v_mfma_f32_16x16x32_bf16 v[208:211], v[96:99], v[28:31], v[208:211]
    ds_read_b128 v[76:79], v70 offset:51200
    v_mfma_f32_16x16x32_bf16 v[212:215], v[100:103], v[28:31], v[212:215]
    ds_read_b128 v[80:83], v70 offset:52224
    v_mfma_f32_16x16x32_bf16 v[216:219], v[104:107], v[28:31], v[216:219]
    ds_read_b128 v[84:87], v70 offset:53248
    v_mfma_f32_16x16x32_bf16 v[220:223], v[108:111], v[28:31], v[220:223]
    ds_read_b128 v[88:91], v70 offset:54272
    v_mfma_f32_16x16x32_bf16 v[224:227], v[112:115], v[28:31], v[224:227]
    ds_read_b128 v[92:95], v70 offset:55296
    s_add_u32 m0, s59, 122880
    s_add_u32 s50, s34, 22859776
    buffer_load_dwordx4 v67, s[20:23], s50 offen sc1 lds
    s_waitcnt vmcnt(10)
L_gw0_2:
    v_max3_u32 v10, v32, v33, v34
    v_max_u32 v10, v10, v35
    v_cmp_eq_u32 vcc, -1, v10
    s_cbranch_vccnz L_gr0_2
L_gc0_2:
    s_waitcnt lgkmcnt(5)
    v_mfma_f32_16x16x32_bf16 v[208:211], v[116:119], v[32:35], v[208:211]
    ds_read_b128 v[96:99], v12 offset:0
    v_mfma_f32_16x16x32_bf16 v[212:215], v[120:123], v[32:35], v[212:215]
    ds_read_b128 v[100:103], v12 offset:1024
    v_mfma_f32_16x16x32_bf16 v[216:219], v[124:127], v[32:35], v[216:219]
    ds_read_b128 v[104:107], v12 offset:2048
    v_mfma_f32_16x16x32_bf16 v[220:223], v[128:131], v[32:35], v[220:223]
    ds_read_b128 v[108:111], v12 offset:3072
    v_mfma_f32_16x16x32_bf16 v[224:227], v[132:135], v[32:35], v[224:227]
    ds_read_b128 v[112:115], v12 offset:4096
    s_add_u32 m0, s59, 131072
    s_add_u32 s50, s34, 22867968
    buffer_load_dwordx4 v67, s[20:23], s50 offen sc1 lds
    s_waitcnt vmcnt(10)
L_gw0_3:
    v_max3_u32 v10, v36, v37, v38
    v_max_u32 v10, v10, v39
    v_cmp_eq_u32 vcc, -1, v10
    s_cbranch_vccnz L_gr0_3
L_gc0_3:
    s_waitcnt lgkmcnt(5)
    v_mfma_f32_16x16x32_bf16 v[208:211], v[76:79], v[36:39], v[208:211]
    ds_read_b128 v[116:119], v12 offset:10240
    v_mfma_f32_16x16x32_bf16 v[212:215], v[80:83], v[36:39], v[212:215]
    ds_read_b128 v[120:123], v12 offset:11264
    v_mfma_f32_16x16x32_bf16 v[216:219], v[84:87], v[36:39], v[216:219]
    ds_read_b128 v[124:127], v12 offset:12288
    v_mfma_f32_16x16x32_bf16 v[220:223], v[88:91], v[36:39], v[220:223]
    ds_read_b128 v[128:131], v12 offset:13312
    v_mfma_f32_16x16x32_bf16 v[224:227], v[92:95], v[36:39], v[224:227]
    ds_read_b128 v[132:135], v12 offset:14336
    s_add_u32 m0, s59, 139264
    s_add_u32 s50, s34, 22876160
    buffer_load_dwordx4 v67, s[20:23], s50 offen sc1 lds
    s_waitcnt vmcnt(10)
L_gw0_4:
    v_max3_u32 v10, v40, v41, v42
    v_max_u32 v10, v10, v43
    v_cmp_eq_u32 vcc, -1, v10
    s_cbranch_vccnz L_gr0_4
L_gc0_4:
    s_waitcnt lgkmcnt(5)
    v_mfma_f32_16x16x32_bf16 v[208:211], v[96:99], v[40:43], v[208:211]
    ds_read_b128 v[76:79], v12 offset:20480
    v_mfma_f32_16x16x32_bf16 v[212:215], v[100:103], v[40:43], v[212:215]
    ds_read_b128 v[80:83], v12 offset:21504
    v_mfma_f32_16x16x32_bf16 v[216:219], v[104:107], v[40:43], v[216:219]
    ds_read_b128 v[84:87], v12 offset:22528
    v_mfma_f32_16x16x32_bf16 v[220:223], v[108:111], v[40:43], v[220:223]
    ds_read_b128 v[88:91], v12 offset:23552
    v_mfma_f32_16x16x32_bf16 v[224:227], v[112:115], v[40:43], v[224:227]
    ds_read_b128 v[92:95], v12 offset:24576
    s_add_u32 m0, s59, 147456
    s_add_u32 s50, s34, 22884352
    buffer_load_dwordx4 v67, s[20:23], s50 offen sc1 lds
    s_waitcnt vmcnt(10)
L_gw0_5:
    v_max3_u32 v10, v44, v45, v46
    v_max_u32 v10, v10, v47
    v_cmp_eq_u32 vcc, -1, v10
    s_cbranch_vccnz L_gr0_5
L_gc0_5:
    s_waitcnt lgkmcnt(5)
    v_mfma_f32_16x16x32_bf16 v[208:211], v[116:119], v[44:47], v[208:211]
    ds_read_b128 v[96:99], v12 offset:30720
    v_mfma_f32_16x16x32_bf16 v[212:215], v[120:123], v[44:47], v[212:215]
    ds_read_b128 v[100:103], v12 offset:31744
    v_mfma_f32_16x16x32_bf16 v[216:219], v[124:127], v[44:47], v[216:219]
    ds_read_b128 v[104:107], v12 offset:32768
    v_mfma_f32_16x16x32_bf16 v[220:223], v[128:131], v[44:47], v[220:223]
    ds_read_b128 v[108:111], v12 offset:33792
    v_mfma_f32_16x16x32_bf16 v[224:227], v[132:135], v[44:47], v[224:227]
    ds_read_b128 v[112:115], v12 offset:34816
    s_add_u32 m0, s59, 155648
    s_add_u32 s50, s34, 22892544
    buffer_load_dwordx4 v67, s[20:23], s50 offen sc1 lds
    s_waitcnt vmcnt(10)
L_gw0_6:
    v_max3_u32 v10, v48, v49, v50
    v_max_u32 v10, v10, v51
    v_cmp_eq_u32 vcc, -1, v10
    s_cbranch_vccnz L_gr0_6
L_gc0_6:
    s_waitcnt lgkmcnt(5)
    v_mfma_f32_16x16x32_bf16 v[208:211], v[76:79], v[48:51], v[208:211]
    ds_read_b128 v[116:119], v12 offset:40960
    v_mfma_f32_16x16x32_bf16 v[212:215], v[80:83], v[48:51], v[212:215]
    ds_read_b128 v[120:123], v12 offset:41984
    v_mfma_f32_16x16x32_bf16 v[216:219], v[84:87], v[48:51], v[216:219]
    ds_read_b128 v[124:127], v12 offset:43008
    v_mfma_f32_16x16x32_bf16 v[220:223], v[88:91], v[48:51], v[220:223]
    ds_read_b128 v[128:131], v12 offset:44032
    v_mfma_f32_16x16x32_bf16 v[224:227], v[92:95], v[48:51], v[224:227]
    ds_read_b128 v[132:135], v12 offset:45056
    s_add_u32 s53, s30, 2621440
    buffer_load_dwordx4 v[144:147], v69, s[20:23], s53 offen offset:0 sc1
    s_add_u32 s53, s30, 2621440
    buffer_load_dwordx4 v[148:151], v69, s[20:23], s53 offen offset:2048 sc1
    s_add_u32 s53, s30, 2625536
    buffer_load_dwordx4 v[152:155], v69, s[20:23], s53 offen offset:0 sc1
    s_waitcnt vmcnt(12)
L_gw0_7:
    v_max3_u32 v10, v52, v53, v54
    v_max_u32 v10, v10, v55
    v_cmp_eq_u32 vcc, -1, v10
    s_cbranch_vccnz L_gr0_7
L_gc0_7:
    s_waitcnt lgkmcnt(5)
    v_mfma_f32_16x16x32_bf16 v[208:211], v[96:99], v[52:55], v[208:211]
    ds_read_b128 v[76:79], v12 offset:51200
    v_mfma_f32_16x16x32_bf16 v[212:215], v[100:103], v[52:55], v[212:215]
    ds_read_b128 v[80:83], v12 offset:52224
    v_mfma_f32_16x16x32_bf16 v[216:219], v[104:107], v[52:55], v[216:219]
    ds_read_b128 v[84:87], v12 offset:53248
    v_mfma_f32_16x16x32_bf16 v[220:223], v[108:111], v[52:55], v[220:223]
    ds_read_b128 v[88:91], v12 offset:54272
    v_mfma_f32_16x16x32_bf16 v[224:227], v[112:115], v[52:55], v[224:227]
    ds_read_b128 v[92:95], v12 offset:55296
    s_add_u32 s53, s30, 2625536
    buffer_load_dwordx4 v[156:159], v69, s[20:23], s53 offen offset:2048 sc1
    s_add_u32 s53, s30, 2629632
    buffer_load_dwordx4 v[160:163], v69, s[20:23], s53 offen offset:0 sc1
    s_add_u32 s53, s30, 2629632
    buffer_load_dwordx4 v[164:167], v69, s[20:23], s53 offen offset:2048 sc1
    s_waitcnt vmcnt(14)
L_gw0_8:
    v_max3_u32 v10, v56, v57, v58
    v_max_u32 v10, v10, v59
    v_cmp_eq_u32 vcc, -1, v10
    s_cbranch_vccnz L_gr0_8
L_gc0_8:
    s_waitcnt lgkmcnt(5)
    v_mfma_f32_16x16x32_bf16 v[208:211], v[116:119], v[56:59], v[208:211]
    v_mfma_f32_16x16x32_bf16 v[212:215], v[120:123], v[56:59], v[212:215]
    v_mfma_f32_16x16x32_bf16 v[216:219], v[124:127], v[56:59], v[216:219]
    v_mfma_f32_16x16x32_bf16 v[220:223], v[128:131], v[56:59], v[220:223]
    v_mfma_f32_16x16x32_bf16 v[224:227], v[132:135], v[56:59], v[224:227]
    s_add_u32 s53, s30, 2633728
    buffer_load_dwordx4 v[168:171], v69, s[20:23], s53 offen offset:0 sc1
    s_add_u32 s53, s30, 2633728
    buffer_load_dwordx4 v[172:175], v69, s[20:23], s53 offen offset:2048 sc1
    s_add_u32 s53, s31, 2621440
    buffer_load_dwordx4 v[176:179], v69, s[20:23], s53 offen offset:0 sc1
    s_waitcnt vmcnt(16)
L_gw0_9:
    v_max3_u32 v10, v60, v61, v62
    v_max_u32 v10, v10, v63
    v_cmp_eq_u32 vcc, -1, v10
    s_cbranch_vccnz L_gr0_9
L_gc0_9:
    s_waitcnt lgkmcnt(0)
    v_mfma_f32_16x16x32_bf16 v[208:211], v[76:79], v[60:63], v[208:211]
    v_mfma_f32_16x16x32_bf16 v[212:215], v[80:83], v[60:63], v[212:215]
    v_mfma_f32_16x16x32_bf16 v[216:219], v[84:87], v[60:63], v[216:219]
    v_mfma_f32_16x16x32_bf16 v[220:223], v[88:91], v[60:63], v[220:223]
    v_mfma_f32_16x16x32_bf16 v[224:227], v[92:95], v[60:63], v[224:227]
    s_add_u32 s53, s31, 2621440
    buffer_load_dwordx4 v[180:183], v69, s[20:23], s53 offen offset:2048 sc1
    v_add_u32 v12, 122880, v70
    s_add_u32 s48, s59, 20480
    v_add_u32 v11, s48, v67
    s_waitcnt vmcnt(10)
    s_barrier
    ds_write_b128 v11, v[188:191] offset:0
    ds_write_b128 v11, v[192:195] offset:8192
    ds_write_b128 v11, v[196:199] offset:16384
    ds_write_b128 v11, v[200:203] offset:24576
    ds_write_b128 v11, v[204:207] offset:32768
    s_cmp_lt_u32 s40, 4
    s_cbranch_scc1 L_pb1
    v_add_u32 v10, 61440, v72
    ds_write_b128 v10, v[208:211] offset:0
    ds_write_b128 v10, v[212:215] offset:1024
    ds_write_b128 v10, v[216:219] offset:2048
    ds_write_b128 v10, v[220:223] offset:3072
    ds_write_b128 v10, v[224:227] offset:4096
L_pb1:
    ds_read_b128 v[76:79], v70 offset:0
    ds_read_b128 v[80:83], v70 offset:1024
    ds_read_b128 v[84:87], v70 offset:2048
    ds_read_b128 v[88:91], v70 offset:3072
    ds_read_b128 v[92:95], v70 offset:4096
    ds_read_b128 v[96:99], v70 offset:10240
    ds_read_b128 v[100:103], v70 offset:11264
    ds_read_b128 v[104:107], v70 offset:12288
    ds_read_b128 v[108:111], v70 offset:13312
    ds_read_b128 v[112:115], v70 offset:14336
    s_waitcnt vmcnt(9)
L_gw1_0:
    v_max3_u32 v10, v144, v145, v146
    v_max_u32 v10, v10, v147
    v_cmp_eq_u32 vcc, -1, v10
    s_cbranch_vccnz L_gr1_0
L_gc1_0:
    s_waitcnt lgkmcnt(5)
    v_mfma_f32_16x16x32_bf16 v[228:231], v[76:79], v[144:147], 0
    ds_read_b128 v[116:119], v12 offset:0
    v_mfma_f32_16x16x32_bf16 v[232:235], v[80:83], v[144:147], 0
    ds_read_b128 v[120:123], v12 offset:1024
    v_mfma_f32_16x16x32_bf16 v[236:239], v[84:87], v[144:147], 0
    ds_read_b128 v[124:127], v12 offset:2048
    v_mfma_f32_16x16x32_bf16 v[240:243], v[88:91], v[144:147], 0
    ds_read_b128 v[128:131], v12 offset:3072
    v_mfma_f32_16x16x32_bf16 v[244:247], v[92:95], v[144:147], 0
    ds_read_b128 v[132:135], v12 offset:4096
    s_barrier
    s_cmp_ge_u32 s40, 4
    s_cbranch_scc1 L_pb2
    v_add_u32 v10, 61440, v72
    ds_read_b128 v[24:27], v10 offset:0
    ds_read_b128 v[28:31], v10 offset:1024
    ds_read_b128 v[32:35], v10 offset:2048
    ds_read_b128 v[36:39], v10 offset:3072
    ds_read_b128 v[40:43], v10 offset:4096
    s_lshl_b32 s48, s56, 2
    s_add_u32 s48, s48, s41
    s_mul_i32 s48, s48, 40960
    s_mul_i32 s49, s57, 160
    s_add_u32 s48, s48, s49
    s_add_u32 s48, s48, 0
    s_waitcnt lgkmcnt(3)
    v_add_f32 v24, v24, v208
    v_add_f32 v25, v25, v209
    v_add_f32 v26, v26, v210
    v_add_f32 v27, v27, v211
    v_add_f32 v28, v28, v212
    v_add_f32 v29, v29, v213
    v_add_f32 v30, v30, v214
    v_add_f32 v31, v31, v215
    v_cvt_pk_bf16_f32 v44, v24, v25
    v_cvt_pk_bf16_f32 v45, v26, v27
    v_cvt_pk_bf16_f32 v46, v28, v29
    v_cvt_pk_bf16_f32 v47, v30, v31
    buffer_store_dwordx4 v[44:47], v71, s[36:39], s48 offen offset:0
    s_waitcnt lgkmcnt(1)
    v_add_f32 v32, v32, v216
    v_add_f32 v33, v33, v217
    v_add_f32 v34, v34, v218
    v_add_f32 v35, v35, v219
    v_add_f32 v36, v36, v220
    v_add_f32 v37, v37, v221
    v_add_f32 v38, v38, v222
    v_add_f32 v39, v39, v223
    v_cvt_pk_bf16_f32 v48, v32, v33
    v_cvt_pk_bf16_f32 v49, v34, v35
    v_cvt_pk_bf16_f32 v50, v36, v37
    v_cvt_pk_bf16_f32 v51, v38, v39
    buffer_store_dwordx4 v[48:51], v71, s[36:39], s48 offen offset:64
    s_waitcnt lgkmcnt(0)
    v_add_f32 v40, v40, v224
    v_add_f32 v41, v41, v225
    v_add_f32 v42, v42, v226
    v_add_f32 v43, v43, v227
    v_cvt_pk_bf16_f32 v52, v40, v41
    v_cvt_pk_bf16_f32 v53, v42, v43
    buffer_store_dwordx2 v[52:53], v73, s[36:39], s48 offen offset:128
L_pb2:
    s_waitcnt vmcnt(8)
L_gw1_1:
    v_max3_u32 v10, v148, v149, v150
    v_max_u32 v10, v10, v151
    v_cmp_eq_u32 vcc, -1, v10
    s_cbranch_vccnz L_gr1_1
L_gc1_1:
    s_waitcnt lgkmcnt(5)
    v_mfma_f32_16x16x32_bf16 v[228:231], v[96:99], v[148:151], v[228:231]
    ds_read_b128 v[76:79], v12 offset:10240
    v_mfma_f32_16x16x32_bf16 v[232:235], v[100:103], v[148:151], v[232:235]
    ds_read_b128 v[80:83], v12 offset:11264
    v_mfma_f32_16x16x32_bf16 v[236:239], v[104:107], v[148:151], v[236:239]
    ds_read_b128 v[84:87], v12 offset:12288
    v_mfma_f32_16x16x32_bf16 v[240:243], v[108:111], v[148:151], v[240:243]
    ds_read_b128 v[88:91], v12 offset:13312
    v_mfma_f32_16x16x32_bf16 v[244:247], v[112:115], v[148:151], v[244:247]
    ds_read_b128 v[92:95], v12 offset:14336
    s_waitcnt vmcnt(7)
L_gw1_2:
    v_max3_u32 v10, v152, v153, v154
    v_max_u32 v10, v10, v155
    v_cmp_eq_u32 vcc, -1, v10
    s_cbranch_vccnz L_gr1_2
L_gc1_2:
    s_waitcnt lgkmcnt(5)
    v_mfma_f32_16x16x32_bf16 v[228:231], v[116:119], v[152:155], v[228:231]
    ds_read_b128 v[96:99], v12 offset:20480
    v_mfma_f32_16x16x32_bf16 v[232:235], v[120:123], v[152:155], v[232:235]
    ds_read_b128 v[100:103], v12 offset:21504
    v_mfma_f32_16x16x32_bf16 v[236:239], v[124:127], v[152:155], v[236:239]
    ds_read_b128 v[104:107], v12 offset:22528
    v_mfma_f32_16x16x32_bf16 v[240:243], v[128:131], v[152:155], v[240:243]
    ds_read_b128 v[108:111], v12 offset:23552
    v_mfma_f32_16x16x32_bf16 v[244:247], v[132:135], v[152:155], v[244:247]
    ds_read_b128 v[112:115], v12 offset:24576
    s_waitcnt vmcnt(6)
L_gw1_3:
    v_max3_u32 v10, v156, v157, v158
    v_max_u32 v10, v10, v159
    v_cmp_eq_u32 vcc, -1, v10
    s_cbranch_vccnz L_gr1_3
L_gc1_3:
    s_waitcnt lgkmcnt(5)
    v_mfma_f32_16x16x32_bf16 v[228:231], v[76:79], v[156:159], v[228:231]
    ds_read_b128 v[116:119], v12 offset:30720
    v_mfma_f32_16x16x32_bf16 v[232:235], v[80:83], v[156:159], v[232:235]
    ds_read_b128 v[120:123], v12 offset:31744
    v_mfma_f32_16x16x32_bf16 v[236:239], v[84:87], v[156:159], v[236:239]
    ds_read_b128 v[124:127], v12 offset:32768
    v_mfma_f32_16x16x32_bf16 v[240:243], v[88:91], v[156:159], v[240:243]
    ds_read_b128 v[128:131], v12 offset:33792
    v_mfma_f32_16x16x32_bf16 v[244:247], v[92:95], v[156:159], v[244:247]
    ds_read_b128 v[132:135], v12 offset:34816
    s_waitcnt vmcnt(5)
L_gw1_4:
    v_max3_u32 v10, v160, v161, v162
    v_max_u32 v10, v10, v163
    v_cmp_eq_u32 vcc, -1, v10
    s_cbranch_vccnz L_gr1_4
L_gc1_4:
    s_waitcnt lgkmcnt(5)
    v_mfma_f32_16x16x32_bf16 v[228:231], v[96:99], v[160:163], v[228:231]
    ds_read_b128 v[76:79], v70 offset:20480
    v_mfma_f32_16x16x32_bf16 v[232:235], v[100:103], v[160:163], v[232:235]
    ds_read_b128 v[80:83], v70 offset:21504
    v_mfma_f32_16x16x32_bf16 v[236:239], v[104:107], v[160:163], v[236:239]
    ds_read_b128 v[84:87], v70 offset:22528
    v_mfma_f32_16x16x32_bf16 v[240:243], v[108:111], v[160:163], v[240:243]
    ds_read_b128 v[88:91], v70 offset:23552
    v_mfma_f32_16x16x32_bf16 v[244:247], v[112:115], v[160:163], v[244:247]
    ds_read_b128 v[92:95], v70 offset:24576
    s_waitcnt vmcnt(4)
L_gw1_5:
    v_max3_u32 v10, v164, v165, v166
    v_max_u32 v10, v10, v167
    v_cmp_eq_u32 vcc, -1, v10
    s_cbranch_vccnz L_gr1_5
L_gc1_5:
    s_waitcnt lgkmcnt(5)
    v_mfma_f32_16x16x32_bf16 v[228:231], v[116:119], v[164:167], v[228:231]
    ds_read_b128 v[96:99], v70 offset:30720
    v_mfma_f32_16x16x32_bf16 v[232:235], v[120:123], v[164:167], v[232:235]
    ds_read_b128 v[100:103], v70 offset:31744
    v_mfma_f32_16x16x32_bf16 v[236:239], v[124:127], v[164:167], v[236:239]
    ds_read_b128 v[104:107], v70 offset:32768
    v_mfma_f32_16x16x32_bf16 v[240:243], v[128:131], v[164:167], v[240:243]
    ds_read_b128 v[108:111], v70 offset:33792
    v_mfma_f32_16x16x32_bf16 v[244:247], v[132:135], v[164:167], v[244:247]
    ds_read_b128 v[112:115], v70 offset:34816
    s_waitcnt vmcnt(3)
L_gw1_6:
    v_max3_u32 v10, v168, v169, v170
    v_max_u32 v10, v10, v171
    v_cmp_eq_u32 vcc, -1, v10
    s_cbranch_vccnz L_gr1_6
L_gc1_6:
    s_waitcnt lgkmcnt(5)
    v_mfma_f32_16x16x32_bf16 v[228:231], v[76:79], v[168:171], v[228:231]
    ds_read_b128 v[116:119], v70 offset:40960
    v_mfma_f32_16x16x32_bf16 v[232:235], v[80:83], v[168:171], v[232:235]
    ds_read_b128 v[120:123], v70 offset:41984
    v_mfma_f32_16x16x32_bf16 v[236:239], v[84:87], v[168:171], v[236:239]
    ds_read_b128 v[124:127], v70 offset:43008
    v_mfma_f32_16x16x32_bf16 v[240:243], v[88:91], v[168:171], v[240:243]
    ds_read_b128 v[128:131], v70 offset:44032
    v_mfma_f32_16x16x32_bf16 v[244:247], v[92:95], v[168:171], v[244:247]
    ds_read_b128 v[132:135], v70 offset:45056
    s_waitcnt vmcnt(2)
L_gw1_7:
    v_max3_u32 v10, v172, v173, v174
    v_max_u32 v10, v10, v175
    v_cmp_eq_u32 vcc, -1, v10
    s_cbranch_vccnz L_gr1_7
L_gc1_7:
    s_waitcnt lgkmcnt(5)
    v_mfma_f32_16x16x32_bf16 v[228:231], v[96:99], v[172:175], v[228:231]
    ds_read_b128 v[76:79], v70 offset:51200
    v_mfma_f32_16x16x32_bf16 v[232:235], v[100:103], v[172:175], v[232:235]
    ds_read_b128 v[80:83], v70 offset:52224
    v_mfma_f32_16x16x32_bf16 v[236:239], v[104:107], v[172:175], v[236:239]
    ds_read_b128 v[84:87], v70 offset:53248
    v_mfma_f32_16x16x32_bf16 v[240:243], v[108:111], v[172:175], v[240:243]
    ds_read_b128 v[88:91], v70 offset:54272
    v_mfma_f32_16x16x32_bf16 v[244:247], v[112:115], v[172:175], v[244:247]
    ds_read_b128 v[92:95], v70 offset:55296
    s_waitcnt vmcnt(1)
L_gw1_8:
    v_max3_u32 v10, v176, v177, v178
    v_max_u32 v10, v10, v179
    v_cmp_eq_u32 vcc, -1, v10
    s_cbranch_vccnz L_gr1_8
L_gc1_8:
    s_waitcnt lgkmcnt(5)
    v_mfma_f32_16x16x32_bf16 v[228:231], v[116:119], v[176:179], v[228:231]
    v_mfma_f32_16x16x32_bf16 v[232:235], v[120:123], v[176:179], v[232:235]
    v_mfma_f32_16x16x32_bf16 v[236:239], v[124:127], v[176:179], v[236:239]
    v_mfma_f32_16x16x32_bf16 v[240:243], v[128:131], v[176:179], v[240:243]
    v_mfma_f32_16x16x32_bf16 v[244:247], v[132:135], v[176:179], v[244:247]
    s_waitcnt vmcnt(0)
L_gw1_9:
    v_max3_u32 v10, v180, v181, v182
    v_max_u32 v10, v10, v183
    v_cmp_eq_u32 vcc, -1, v10
    s_cbranch_vccnz L_gr1_9
L_gc1_9:
    s_waitcnt lgkmcnt(0)
    v_mfma_f32_16x16x32_bf16 v[228:231], v[76:79], v[180:183], v[228:231]
    v_mfma_f32_16x16x32_bf16 v[232:235], v[80:83], v[180:183], v[232:235]
    v_mfma_f32_16x16x32_bf16 v[236:239], v[84:87], v[180:183], v[236:239]
    v_mfma_f32_16x16x32_bf16 v[240:243], v[88:91], v[180:183], v[240:243]
    v_mfma_f32_16x16x32_bf16 v[244:247], v[92:95], v[180:183], v[244:247]
    s_lshl_b32 s48, s56, 2
    s_add_u32 s48, s48, s41
    s_mul_i32 s48, s48, 40960
    s_mul_i32 s49, s57, 160
    s_add_u32 s48, s48, s49
    s_add_u32 s48, s48, 1280
    s_cmp_lt_u32 s40, 4
    s_cbranch_scc1 L_fin1
    v_add_u32 v10, 81920, v72
    ds_write_b128 v10, v[228:231] offset:0
    ds_write_b128 v10, v[232:235] offset:1024
    ds_write_b128 v10, v[244:247] offset:4096
    s_waitcnt lgkmcnt(0)
    s_barrier
    ds_read_b128 v[32:35], v10 offset:2048
    ds_read_b128 v[36:39], v10 offset:3072
    s_waitcnt lgkmcnt(0)
    v_add_f32 v32, v32, v236
    v_add_f32 v33, v33, v237
    v_add_f32 v34, v34, v238
    v_add_f32 v35, v35, v239
    v_add_f32 v36, v36, v240
    v_add_f32 v37, v37, v241
    v_add_f32 v38, v38, v242
    v_add_f32 v39, v39, v243
    v_cvt_pk_bf16_f32 v48, v32, v33
    v_cvt_pk_bf16_f32 v49, v34, v35
    v_cvt_pk_bf16_f32 v50, v36, v37
    v_cvt_pk_bf16_f32 v51, v38, v39
    buffer_store_dwordx4 v[48:51], v71, s[36:39], s48 offen offset:64
    s_branch L_fin2
L_fin1:
    v_add_u32 v10, 81920, v72
    ds_write_b128 v10, v[236:239] offset:2048
    ds_write_b128 v10, v[240:243] offset:3072
    s_waitcnt lgkmcnt(0)
    s_barrier
    ds_read_b128 v[24:27], v10 offset:0
    ds_read_b128 v[28:31], v10 offset:1024
    ds_read_b128 v[40:43], v10 offset:4096
    s_waitcnt lgkmcnt(1)
    v_add_f32 v24, v24, v228
    v_add_f32 v25, v25, v229
    v_add_f32 v26, v26, v230
    v_add_f32 v27, v27, v231
    v_add_f32 v28, v28, v232
    v_add_f32 v29, v29, v233
    v_add_f32 v30, v30, v234
    v_add_f32 v31, v31, v235
    v_cvt_pk_bf16_f32 v44, v24, v25
    v_cvt_pk_bf16_f32 v45, v26, v27
    v_cvt_pk_bf16_f32 v46, v28, v29
    v_cvt_pk_bf16_f32 v47, v30, v31
    buffer_store_dwordx4 v[44:47], v71, s[36:39], s48 offen offset:0
    s_waitcnt lgkmcnt(0)
    v_add_f32 v40, v40, v244
    v_add_f32 v41, v41, v245
    v_add_f32 v42, v42, v246
    v_add_f32 v43, v43, v247
    v_cvt_pk_bf16_f32 v52, v40, v41
    v_cvt_pk_bf16_f32 v53, v42, v43
    buffer_store_dwordx2 v[52:53], v73, s[36:39], s48 offen offset:128
L_fin2:
    s_cmp_lg_u32 s40, 4
    s_cbranch_scc1 L_w_23
    s_cmp_lg_u32 s2, 0
    s_cbranch_scc1 L_w_23
    v_mov_b32 v1, s3
    s_mov_b32 s52, 21008384
    s_mov_b64 exec, 1
    buffer_store_dword v1, off, s[20:23], s52 sc1
    s_mov_b64 exec, -1
L_w_23:
L_done:
    s_endpgm
L_gr0_0:
    s_sub_u32 s70, s70, 1
    s_cmp_eq_u32 s70, 0
    s_cbranch_scc1 L_gq0_0
    s_waitcnt vmcnt(0)
    s_sleep 1
    s_add_u32 s53, s30, 0
    buffer_load_dwordx4 v[24:27], v69, s[20:23], s53 offen offset:0 sc1
    s_add_u32 s53, s30, 0
    buffer_load_dwordx4 v[28:31], v69, s[20:23], s53 offen offset:2048 sc1
    s_add_u32 s53, s30, 4096
    buffer_load_dwordx4 v[32:35], v69, s[20:23], s53 offen offset:0 sc1
    s_add_u32 s53, s30, 4096
    buffer_load_dwordx4 v[36:39], v69, s[20:23], s53 offen offset:2048 sc1
    s_add_u32 s53, s30, 8192
    buffer_load_dwordx4 v[40:43], v69, s[20:23], s53 offen offset:0 sc1
    s_add_u32 s53, s30, 8192
    buffer_load_dwordx4 v[44:47], v69, s[20:23], s53 offen offset:2048 sc1
    s_add_u32 s53, s30, 12288
    buffer_load_dwordx4 v[48:51], v69, s[20:23], s53 offen offset:0 sc1
    s_add_u32 s53, s30, 12288
    buffer_load_dwordx4 v[52:55], v69, s[20:23], s53 offen offset:2048 sc1
    s_add_u32 s53, s31, 0
    buffer_load_dwordx4 v[56:59], v69, s[20:23], s53 offen offset:0 sc1
    s_add_u32 s53, s31, 0
    buffer_load_dwordx4 v[60:63], v69, s[20:23], s53 offen offset:2048 sc1
    s_waitcnt vmcnt(0)
    s_branch L_gw0_0
L_gq0_0:
    s_mov_b32 s70, 1
    s_branch L_gc0_0
L_gr0_1:
    s_sub_u32 s70, s70, 1
    s_cmp_eq_u32 s70, 0
    s_cbranch_scc1 L_gq0_1
    s_waitcnt vmcnt(0)
    s_sleep 1
    s_add_u32 s53, s30, 0
    buffer_load_dwordx4 v[28:31], v69, s[20:23], s53 offen offset:2048 sc1
    s_add_u32 s53, s30, 4096
    buffer_load_dwordx4 v[32:35], v69, s[20:23], s53 offen offset:0 sc1
    s_add_u32 s53, s30, 4096
    buffer_load_dwordx4 v[36:39], v69, s[20:23], s53 offen offset:2048 sc1
    s_add_u32 s53, s30, 8192
    buffer_load_dwordx4 v[40:43], v69, s[20:23], s53 offen offset:0 sc1
    s_add_u32 s53, s30, 8192
    buffer_load_dwordx4 v[44:47], v69, s[20:23], s53 offen offset:2048 sc1
    s_add_u32 s53, s30, 12288
    buffer_load_dwordx4 v[48:51], v69, s[20:23], s53 offen offset:0 sc1
    s_add_u32 s53, s30, 12288
    buffer_load_dwordx4 v[52:55], v69, s[20:23], s53 offen offset:2048 sc1
    s_add_u32 s53, s31, 0
    buffer_load_dwordx4 v[56:59], v69, s[20:23], s53 offen offset:0 sc1
    s_add_u32 s53, s31, 0
    buffer_load_dwordx4 v[60:63], v69, s[20:23], s53 offen offset:2048 sc1
    s_waitcnt vmcnt(0)
    s_branch L_gw0_1
L_gq0_1:
    s_mov_b32 s70, 1
    s_branch L_gc0_1
L_gr0_2:
    s_sub_u32 s70, s70, 1
    s_cmp_eq_u32 s70, 0
    s_cbranch_scc1 L_gq0_2
    s_waitcnt vmcnt(0)
    s_sleep 1
    s_add_u32 s53, s30, 4096
    buffer_load_dwordx4 v[32:35], v69, s[20:23], s53 offen offset:0 sc1
    s_add_u32 s53, s30, 4096
    buffer_load_dwordx4 v[36:39], v69, s[20:23], s53 offen offset:2048 sc1
    s_add_u32 s53, s30, 8192
    buffer_load_dwordx4 v[40:43], v69, s[20:23], s53 offen offset:0 sc1
    s_add_u32 s53, s30, 8192
    buffer_load_dwordx4 v[44:47], v69, s[20:23], s53 offen offset:2048 sc1
    s_add_u32 s53, s30, 12288
    buffer_load_dwordx4 v[48:51], v69, s[20:23], s53 offen offset:0 sc1
    s_add_u32 s53, s30, 12288
    buffer_load_dwordx4 v[52:55], v69, s[20:23], s53 offen offset:2048 sc1
    s_add_u32 s53, s31, 0
    buffer_load_dwordx4 v[56:59], v69, s[20:23], s53 offen offset:0 sc1
    s_add_u32 s53, s31, 0
    buffer_load_dwordx4 v[60:63], v69, s[20:23], s53 offen offset:2048 sc1
    s_waitcnt vmcnt(0)
    s_branch L_gw0_2
L_gq0_2:
    s_mov_b32 s70, 1
    s_branch L_gc0_2
L_gr0_3:
    s_sub_u32 s70, s70, 1
    s_cmp_eq_u32 s70, 0
    s_cbranch_scc1 L_gq0_3
    s_waitcnt vmcnt(0)
    s_sleep 1
    s_add_u32 s53, s30, 4096
    buffer_load_dwordx4 v[36:39], v69, s[20:23], s53 offen offset:2048 sc1
    s_add_u32 s53, s30, 8192
    buffer_load_dwordx4 v[40:43], v69, s[20:23], s53 offen offset:0 sc1
    s_add_u32 s53, s30, 8192
    buffer_load_dwordx4 v[44:47], v69, s[20:23], s53 offen offset:2048 sc1
    s_add_u32 s53, s30, 12288
    buffer_load_dwordx4 v[48:51], v69, s[20:23], s53 offen offset:0 sc1
    s_add_u32 s53, s30, 12288
    buffer_load_dwordx4 v[52:55], v69, s[20:23], s53 offen offset:2048 sc1
    s_add_u32 s53, s31, 0
    buffer_load_dwordx4 v[56:59], v69, s[20:23], s53 offen offset:0 sc1
    s_add_u32 s53, s31, 0
    buffer_load_dwordx4 v[60:63], v69, s[20:23], s53 offen offset:2048 sc1
    s_waitcnt vmcnt(0)
    s_branch L_gw0_3
L_gq0_3:
    s_mov_b32 s70, 1
    s_branch L_gc0_3
L_gr0_4:
    s_sub_u32 s70, s70, 1
    s_cmp_eq_u32 s70, 0
    s_cbranch_scc1 L_gq0_4
    s_waitcnt vmcnt(0)
    s_sleep 1
    s_add_u32 s53, s30, 8192
    buffer_load_dwordx4 v[40:43], v69, s[20:23], s53 offen offset:0 sc1
    s_add_u32 s53, s30, 8192
    buffer_load_dwordx4 v[44:47], v69, s[20:23], s53 offen offset:2048 sc1
    s_add_u32 s53, s30, 12288
    buffer_load_dwordx4 v[48:51], v69, s[20:23], s53 offen offset:0 sc1
    s_add_u32 s53, s30, 12288
    buffer_load_dwordx4 v[52:55], v69, s[20:23], s53 offen offset:2048 sc1
    s_add_u32 s53, s31, 0
    buffer_load_dwordx4 v[56:59], v69, s[20:23], s53 offen offset:0 sc1
    s_add_u32 s53, s31, 0
    buffer_load_dwordx4 v[60:63], v69, s[20:23], s53 offen offset:2048 sc1
    s_waitcnt vmcnt(0)
    s_branch L_gw0_4
L_gq0_4:
    s_mov_b32 s70, 1
    s_branch L_gc0_4
L_gr0_5:
    s_sub_u32 s70, s70, 1
    s_cmp_eq_u32 s70, 0
    s_cbranch_scc1 L_gq0_5
    s_waitcnt vmcnt(0)
    s_sleep 1
    s_add_u32 s53, s30, 8192
    buffer_load_dwordx4 v[44:47], v69, s[20:23], s53 offen offset:2048 sc1
    s_add_u32 s53, s30, 12288
    buffer_load_dwordx4 v[48:51], v69, s[20:23], s53 offen offset:0 sc1
    s_add_u32 s53, s30, 12288
    buffer_load_dwordx4 v[52:55], v69, s[20:23], s53 offen offset:2048 sc1
    s_add_u32 s53, s31, 0
    buffer_load_dwordx4 v[56:59], v69, s[20:23], s53 offen offset:0 sc1
    s_add_u32 s53, s31, 0
    buffer_load_dwordx4 v[60:63], v69, s[20:23], s53 offen offset:2048 sc1
    s_waitcnt vmcnt(0)
    s_branch L_gw0_5
L_gq0_5:
    s_mov_b32 s70, 1
    s_branch L_gc0_5
L_gr0_6:
    s_sub_u32 s70, s70, 1
    s_cmp_eq_u32 s70, 0
    s_cbranch_scc1 L_gq0_6
    s_waitcnt vmcnt(0)
    s_sleep 1
    s_add_u32 s53, s30, 12288
    buffer_load_dwordx4 v[48:51], v69, s[20:23], s53 offen offset:0 sc1
    s_add_u32 s53, s30, 12288
    buffer_load_dwordx4 v[52:55], v69, s[20:23], s53 offen offset:2048 sc1
    s_add_u32 s53, s31, 0
    buffer_load_dwordx4 v[56:59], v69, s[20:23], s53 offen offset:0 sc1
    s_add_u32 s53, s31, 0
    buffer_load_dwordx4 v[60:63], v69, s[20:23], s53 offen offset:2048 sc1
    s_waitcnt vmcnt(0)
    s_branch L_gw0_6
L_gq0_6:
    s_mov_b32 s70, 1
    s_branch L_gc0_6
L_gr0_7:
    s_sub_u32 s70, s70, 1
    s_cmp_eq_u32 s70, 0
    s_cbranch_scc1 L_gq0_7
    s_waitcnt vmcnt(0)
    s_sleep 1
    s_add_u32 s53, s30, 12288
    buffer_load_dwordx4 v[52:55], v69, s[20:23], s53 offen offset:2048 sc1
    s_add_u32 s53, s31, 0
    buffer_load_dwordx4 v[56:59], v69, s[20:23], s53 offen offset:0 sc1
    s_add_u32 s53, s31, 0
    buffer_load_dwordx4 v[60:63], v69, s[20:23], s53 offen offset:2048 sc1
    s_waitcnt vmcnt(0)
    s_branch L_gw0_7
L_gq0_7:
    s_mov_b32 s70, 1
    s_branch L_gc0_7
L_gr0_8:
    s_sub_u32 s70, s70, 1
    s_cmp_eq_u32 s70, 0
    s_cbranch_scc1 L_gq0_8
    s_waitcnt vmcnt(0)
    s_sleep 1
    s_add_u32 s53, s31, 0
    buffer_load_dwordx4 v[56:59], v69, s[20:23], s53 offen offset:0 sc1
    s_add_u32 s53, s31, 0
    buffer_load_dwordx4 v[60:63], v69, s[20:23], s53 offen offset:2048 sc1
    s_waitcnt vmcnt(0)
    s_branch L_gw0_8
L_gq0_8:
    s_mov_b32 s70, 1
    s_branch L_gc0_8
L_gr0_9:
    s_sub_u32 s70, s70, 1
    s_cmp_eq_u32 s70, 0
    s_cbranch_scc1 L_gq0_9
    s_waitcnt vmcnt(0)
    s_sleep 1
    s_add_u32 s53, s31, 0
    buffer_load_dwordx4 v[60:63], v69, s[20:23], s53 offen offset:2048 sc1
    s_waitcnt vmcnt(0)
    s_branch L_gw0_9
L_gq0_9:
    s_mov_b32 s70, 1
    s_branch L_gc0_9
L_gr1_0:
    s_sub_u32 s70, s70, 1
    s_cmp_eq_u32 s70, 0
    s_cbranch_scc1 L_gq1_0
    s_waitcnt vmcnt(0)
    s_sleep 1
    s_add_u32 s53, s30, 2621440
    buffer_load_dwordx4 v[144:147], v69, s[20:23], s53 offen offset:0 sc1
    s_add_u32 s53, s30, 2621440
    buffer_load_dwordx4 v[148:151], v69, s[20:23], s53 offen offset:2048 sc1
    s_add_u32 s53, s30, 2625536
    buffer_load_dwordx4 v[152:155], v69, s[20:23], s53 offen offset:0 sc1
    s_add_u32 s53, s30, 2625536
    buffer_load_dwordx4 v[156:159], v69, s[20:23], s53 offen offset:2048 sc1
    s_add_u32 s53, s30, 2629632
    buffer_load_dwordx4 v[160:163], v69, s[20:23], s53 offen offset:0 sc1
    s_add_u32 s53, s30, 2629632
    buffer_load_dwordx4 v[164:167], v69, s[20:23], s53 offen offset:2048 sc1
    s_add_u32 s53, s30, 2633728
    buffer_load_dwordx4 v[168:171], v69, s[20:23], s53 offen offset:0 sc1
    s_add_u32 s53, s30, 2633728
    buffer_load_dwordx4 v[172:175], v69, s[20:23], s53 offen offset:2048 sc1
    s_add_u32 s53, s31, 2621440
    buffer_load_dwordx4 v[176:179], v69, s[20:23], s53 offen offset:0 sc1
    s_add_u32 s53, s31, 2621440
    buffer_load_dwordx4 v[180:183], v69, s[20:23], s53 offen offset:2048 sc1
    s_waitcnt vmcnt(9)
    s_branch L_gw1_0
L_gq1_0:
    s_mov_b32 s70, 1
    s_branch L_gc1_0
L_gr1_1:
    s_sub_u32 s70, s70, 1
    s_cmp_eq_u32 s70, 0
    s_cbranch_scc1 L_gq1_1
    s_waitcnt vmcnt(0)
    s_sleep 1
    s_add_u32 s53, s30, 2621440
    buffer_load_dwordx4 v[148:151], v69, s[20:23], s53 offen offset:2048 sc1
    s_add_u32 s53, s30, 2625536
    buffer_load_dwordx4 v[152:155], v69, s[20:23], s53 offen offset:0 sc1
    s_add_u32 s53, s30, 2625536
    buffer_load_dwordx4 v[156:159], v69, s[20:23], s53 offen offset:2048 sc1
    s_add_u32 s53, s30, 2629632
    buffer_load_dwordx4 v[160:163], v69, s[20:23], s53 offen offset:0 sc1
    s_add_u32 s53, s30, 2629632
    buffer_load_dwordx4 v[164:167], v69, s[20:23], s53 offen offset:2048 sc1
    s_add_u32 s53, s30, 2633728
    buffer_load_dwordx4 v[168:171], v69, s[20:23], s53 offen offset:0 sc1
    s_add_u32 s53, s30, 2633728
    buffer_load_dwordx4 v[172:175], v69, s[20:23], s53 offen offset:2048 sc1
    s_add_u32 s53, s31, 2621440
    buffer_load_dwordx4 v[176:179], v69, s[20:23], s53 offen offset:0 sc1
    s_add_u32 s53, s31, 2621440
    buffer_load_dwordx4 v[180:183], v69, s[20:23], s53 offen offset:2048 sc1
    s_waitcnt vmcnt(8)
    s_branch L_gw1_1
L_gq1_1:
    s_mov_b32 s70, 1
    s_branch L_gc1_1
L_gr1_2:
    s_sub_u32 s70, s70, 1
    s_cmp_eq_u32 s70, 0
    s_cbranch_scc1 L_gq1_2
    s_waitcnt vmcnt(0)
    s_sleep 1
    s_add_u32 s53, s30, 2625536
    buffer_load_dwordx4 v[152:155], v69, s[20:23], s53 offen offset:0 sc1
    s_add_u32 s53, s30, 2625536
    buffer_load_dwordx4 v[156:159], v69, s[20:23], s53 offen offset:2048 sc1
    s_add_u32 s53, s30, 2629632
    buffer_load_dwordx4 v[160:163], v69, s[20:23], s53 offen offset:0 sc1
    s_add_u32 s53, s30, 2629632
    buffer_load_dwordx4 v[164:167], v69, s[20:23], s53 offen offset:2048 sc1
    s_add_u32 s53, s30, 2633728
    buffer_load_dwordx4 v[168:171], v69, s[20:23], s53 offen offset:0 sc1
    s_add_u32 s53, s30, 2633728
    buffer_load_dwordx4 v[172:175], v69, s[20:23], s53 offen offset:2048 sc1
    s_add_u32 s53, s31, 2621440
    buffer_load_dwordx4 v[176:179], v69, s[20:23], s53 offen offset:0 sc1
    s_add_u32 s53, s31, 2621440
    buffer_load_dwordx4 v[180:183], v69, s[20:23], s53 offen offset:2048 sc1
    s_waitcnt vmcnt(7)
    s_branch L_gw1_2
L_gq1_2:
    s_mov_b32 s70, 1
    s_branch L_gc1_2
L_gr1_3:
    s_sub_u32 s70, s70, 1
    s_cmp_eq_u32 s70, 0
    s_cbranch_scc1 L_gq1_3
    s_waitcnt vmcnt(0)
    s_sleep 1
    s_add_u32 s53, s30, 2625536
    buffer_load_dwordx4 v[156:159], v69, s[20:23], s53 offen offset:2048 sc1
    s_add_u32 s53, s30, 2629632
    buffer_load_dwordx4 v[160:163], v69, s[20:23], s53 offen offset:0 sc1
    s_add_u32 s53, s30, 2629632
    buffer_load_dwordx4 v[164:167], v69, s[20:23], s53 offen offset:2048 sc1
    s_add_u32 s53, s30, 2633728
    buffer_load_dwordx4 v[168:171], v69, s[20:23], s53 offen offset:0 sc1
    s_add_u32 s53, s30, 2633728
    buffer_load_dwordx4 v[172:175], v69, s[20:23], s53 offen offset:2048 sc1
    s_add_u32 s53, s31, 2621440
    buffer_load_dwordx4 v[176:179], v69, s[20:23], s53 offen offset:0 sc1
    s_add_u32 s53, s31, 2621440
    buffer_load_dwordx4 v[180:183], v69, s[20:23], s53 offen offset:2048 sc1
    s_waitcnt vmcnt(6)
    s_branch L_gw1_3
L_gq1_3:
    s_mov_b32 s70, 1
    s_branch L_gc1_3
L_gr1_4:
    s_sub_u32 s70, s70, 1
    s_cmp_eq_u32 s70, 0
    s_cbranch_scc1 L_gq1_4
    s_waitcnt vmcnt(0)
    s_sleep 1
    s_add_u32 s53, s30, 2629632
    buffer_load_dwordx4 v[160:163], v69, s[20:23], s53 offen offset:0 sc1
    s_add_u32 s53, s30, 2629632
    buffer_load_dwordx4 v[164:167], v69, s[20:23], s53 offen offset:2048 sc1
    s_add_u32 s53, s30, 2633728
    buffer_load_dwordx4 v[168:171], v69, s[20:23], s53 offen offset:0 sc1
    s_add_u32 s53, s30, 2633728
    buffer_load_dwordx4 v[172:175], v69, s[20:23], s53 offen offset:2048 sc1
    s_add_u32 s53, s31, 2621440
    buffer_load_dwordx4 v[176:179], v69, s[20:23], s53 offen offset:0 sc1
    s_add_u32 s53, s31, 2621440
    buffer_load_dwordx4 v[180:183], v69, s[20:23], s53 offen offset:2048 sc1
    s_waitcnt vmcnt(5)
    s_branch L_gw1_4
L_gq1_4:
    s_mov_b32 s70, 1
    s_branch L_gc1_4
L_gr1_5:
    s_sub_u32 s70, s70, 1
    s_cmp_eq_u32 s70, 0
    s_cbranch_scc1 L_gq1_5
    s_waitcnt vmcnt(0)
    s_sleep 1
    s_add_u32 s53, s30, 2629632
    buffer_load_dwordx4 v[164:167], v69, s[20:23], s53 offen offset:2048 sc1
    s_add_u32 s53, s30, 2633728
    buffer_load_dwordx4 v[168:171], v69, s[20:23], s53 offen offset:0 sc1
    s_add_u32 s53, s30, 2633728
    buffer_load_dwordx4 v[172:175], v69, s[20:23], s53 offen offset:2048 sc1
    s_add_u32 s53, s31, 2621440
    buffer_load_dwordx4 v[176:179], v69, s[20:23], s53 offen offset:0 sc1
    s_add_u32 s53, s31, 2621440
    buffer_load_dwordx4 v[180:183], v69, s[20:23], s53 offen offset:2048 sc1
    s_waitcnt vmcnt(4)
    s_branch L_gw1_5
L_gq1_5:
    s_mov_b32 s70, 1
    s_branch L_gc1_5
L_gr1_6:
    s_sub_u32 s70, s70, 1
    s_cmp_eq_u32 s70, 0
    s_cbranch_scc1 L_gq1_6
    s_waitcnt vmcnt(0)
    s_sleep 1
    s_add_u32 s53, s30, 2633728
    buffer_load_dwordx4 v[168:171], v69, s[20:23], s53 offen offset:0 sc1
    s_add_u32 s53, s30, 2633728
    buffer_load_dwordx4 v[172:175], v69, s[20:23], s53 offen offset:2048 sc1
    s_add_u32 s53, s31, 2621440
    buffer_load_dwordx4 v[176:179], v69, s[20:23], s53 offen offset:0 sc1
    s_add_u32 s53, s31, 2621440
    buffer_load_dwordx4 v[180:183], v69, s[20:23], s53 offen offset:2048 sc1
    s_waitcnt vmcnt(3)
    s_branch L_gw1_6
L_gq1_6:
    s_mov_b32 s70, 1
    s_branch L_gc1_6
L_gr1_7:
    s_sub_u32 s70, s70, 1
    s_cmp_eq_u32 s70, 0
    s_cbranch_scc1 L_gq1_7
    s_waitcnt vmcnt(0)
    s_sleep 1
    s_add_u32 s53, s30, 2633728
    buffer_load_dwordx4 v[172:175], v69, s[20:23], s53 offen offset:2048 sc1
    s_add_u32 s53, s31, 2621440
    buffer_load_dwordx4 v[176:179], v69, s[20:23], s53 offen offset:0 sc1
    s_add_u32 s53, s31, 2621440
    buffer_load_dwordx4 v[180:183], v69, s[20:23], s53 offen offset:2048 sc1
    s_waitcnt vmcnt(2)
    s_branch L_gw1_7
L_gq1_7:
    s_mov_b32 s70, 1
    s_branch L_gc1_7
L_gr1_8:
    s_sub_u32 s70, s70, 1
    s_cmp_eq_u32 s70, 0
    s_cbranch_scc1 L_gq1_8
    s_waitcnt vmcnt(0)
    s_sleep 1
    s_add_u32 s53, s31, 2621440
    buffer_load_dwordx4 v[176:179], v69, s[20:23], s53 offen offset:0 sc1
    s_add_u32 s53, s31, 2621440
    buffer_load_dwordx4 v[180:183], v69, s[20:23], s53 offen offset:2048 sc1
    s_waitcnt vmcnt(1)
    s_branch L_gw1_8
L_gq1_8:
    s_mov_b32 s70, 1
    s_branch L_gc1_8
L_gr1_9:
    s_sub_u32 s70, s70, 1
    s_cmp_eq_u32 s70, 0
    s_cbranch_scc1 L_gq1_9
    s_waitcnt vmcnt(0)
    s_sleep 1
    s_add_u32 s53, s31, 2621440
    buffer_load_dwordx4 v[180:183], v69, s[20:23], s53 offen offset:2048 sc1
    s_waitcnt vmcnt(0)
    s_branch L_gw1_9
L_gq1_9:
    s_mov_b32 s70, 1
    s_branch L_gc1_9
L_idle:
    s_mov_b32 s4, s28
    s_mov_b32 s5, s29
    s_mov_b32 s6, 819200
    v_add_u32 v10, 0, v0
    v_mul_u32_u24 v11, 6554, v10
    v_lshrrev_b32 v11, 16, v11
    v_mul_u32_u24 v12, 10, v11
    v_sub_u32 v12, v10, v12
    v_mul_u32_u24 v11, 1280, v11
    v_lshl_add_u32 v24, v12, 4, v11
    v_add_u32 v10, 64, v0
    v_mul_u32_u24 v11, 6554, v10
    v_lshrrev_b32 v11, 16, v11
    v_mul_u32_u24 v12, 10, v11
    v_sub_u32 v12, v10, v12
    v_mul_u32_u24 v11, 1280, v11
    v_lshl_add_u32 v25, v12, 4, v11
    v_add_u32 v10, 128, v0
    v_mul_u32_u24 v11, 6554, v10
    v_lshrrev_b32 v11, 16, v11
    v_mul_u32_u24 v12, 10, v11
    v_sub_u32 v12, v10, v12
    v_mul_u32_u24 v11, 1280, v11
    v_lshl_add_u32 v26, v12, 4, v11
    v_add_u32 v10, 192, v0
    v_mul_u32_u24 v11, 6554, v10
    v_lshrrev_b32 v11, 16, v11
    v_mul_u32_u24 v12, 10, v11
    v_sub_u32 v12, v10, v12
    v_mul_u32_u24 v11, 1280, v11
    v_lshl_add_u32 v27, v12, 4, v11
    v_add_u32 v10, 256, v0
    v_mul_u32_u24 v11, 6554, v10
    v_lshrrev_b32 v11, 16, v11
    v_mul_u32_u24 v12, 10, v11
    v_sub_u32 v12, v10, v12
    v_mul_u32_u24 v11, 1280, v11
    v_lshl_add_u32 v28, v12, 4, v11
    s_mul_i32 s48, s42, 160
    s_mul_i32 s49, s40, 40960
    s_add_u32 s48, s48, s49
    s_mul_i32 s49, s40, 5120
    s_add_u32 s50, s48, 0
    s_add_u32 m0, s49, 0
    s_nop 0
    buffer_load_dwordx4 v24, s[4:7], s50 offen lds
    s_add_u32 m0, s49, 1024
    s_nop 0
    buffer_load_dwordx4 v25, s[4:7], s50 offen lds
    s_add_u32 m0, s49, 2048
    s_nop 0
    buffer_load_dwordx4 v26, s[4:7], s50 offen lds
    s_add_u32 m0, s49, 3072
    s_nop 0
    buffer_load_dwordx4 v27, s[4:7], s50 offen lds
    s_add_u32 m0, s49, 4096
    s_nop 0
    buffer_load_dwordx4 v28, s[4:7], s50 offen lds
L_id_24:
    s_add_u32 s50, s48, 327680
    s_add_u32 m0, s49, 40960
    s_nop 0
    buffer_load_dwordx4 v24, s[4:7], s50 offen lds
    s_add_u32 m0, s49, 41984
    s_nop 0
    buffer_load_dwordx4 v25, s[4:7], s50 offen lds
    s_add_u32 m0, s49, 43008
    s_nop 0
    buffer_load_dwordx4 v26, s[4:7], s50 offen lds
    s_add_u32 m0, s49, 44032
    s_nop 0
    buffer_load_dwordx4 v27, s[4:7], s50 offen lds
    s_add_u32 m0, s49, 45056
    s_nop 0
    buffer_load_dwordx4 v28, s[4:7], s50 offen lds
L_id_25:
    s_cmp_ge_u32 s40, 4
    s_cbranch_scc1 L_id_26
    s_add_u32 s50, s48, 655360
    s_add_u32 m0, s49, 81920
    s_nop 0
    buffer_load_dwordx4 v24, s[4:7], s50 offen lds
    s_add_u32 m0, s49, 82944
    s_nop 0
    buffer_load_dwordx4 v25, s[4:7], s50 offen lds
    s_add_u32 m0, s49, 83968
    s_nop 0
    buffer_load_dwordx4 v26, s[4:7], s50 offen lds
    s_add_u32 m0, s49, 84992
    s_nop 0
    buffer_load_dwordx4 v27, s[4:7], s50 offen lds
    s_add_u32 m0, s49, 86016
    s_nop 0
    buffer_load_dwordx4 v28, s[4:7], s50 offen lds
L_id_26:
    s_lshl_b32 s48, s42, 2
    s_lshr_b32 s49, s40, 2
    s_lshl_b32 s49, s49, 1
    s_add_u32 s48, s48, s49
    s_lshl_b32 s49, s16, 11
    s_add_u32 s48, s48, s49
    s_mul_i32 s52, s43, 52
    s_lshr_b32 s52, s52, 8
    s_min_u32 s49, s52, 1
    s_lshl_b32 s51, 1280, s49
    s_mul_i32 s54, s48, s51
    s_mul_i32 s48, s49, 5242880
    s_add_u32 s54, s54, s48
    s_mov_b32 s55, s51
    s_lshl_b32 s51, s51, 6
    s_mul_i32 s48, s52, 5
    s_sub_u32 s53, s43, s48
    s_lshl_b32 s48, s53, 5
    s_lshl_b32 s49, s41, 3
    s_add_u32 s48, s48, s49
    v_add_u32 v10, s48, v17
    s_lshl_b32 s48, s48, 2
    v_add_u32 v11, s48, v16
    v_lshlrev_b32 v12, 4, v16
    v_mul_u32_u24 v13, 320, v17
    v_add_u32 v13, 1280, v13
    v_mul_u32_u24 v14, 205, v10
    v_lshrrev_b32 v14, 10, v14
    v_mul_u32_u24 v15, 5, v14
    v_sub_u32 v15, v10, v15
    v_mul_lo_u32 v14, v14, s51
    v_lshl_add_u32 v15, v15, 8, v12
    v_add_u32 v18, v14, v15
    v_mul_u32_u24 v14, 3277, v11
    v_lshrrev_b32 v14, 16, v14
    v_mul_u32_u24 v15, 20, v14
    v_sub_u32 v15, v11, v15
    v_mul_lo_u32 v14, v14, s51
    v_lshl_add_u32 v15, v15, 4, v13
    v_add_u32 v1, v14, v15
    v_cmp_le_u32 vcc, 2, s52
    v_add_u32 v10, 4, v10
    v_add_u32 v11, 16, v11
    v_cndmask_b32 v18, v18, v1, vcc
    v_mul_u32_u24 v14, 205, v10
    v_lshrrev_b32 v14, 10, v14
    v_mul_u32_u24 v15, 5, v14
    v_sub_u32 v15, v10, v15
    v_mul_lo_u32 v14, v14, s51
    v_lshl_add_u32 v15, v15, 8, v12
    v_add_u32 v19, v14, v15
    v_mul_u32_u24 v14, 3277, v11
    v_lshrrev_b32 v14, 16, v14
    v_mul_u32_u24 v15, 20, v14
    v_sub_u32 v15, v11, v15
    v_mul_lo_u32 v14, v14, s51
    v_lshl_add_u32 v15, v15, 4, v13
    v_add_u32 v1, v14, v15
    v_cmp_le_u32 vcc, 2, s52
    v_add_u32 v10, 4, v10
    v_add_u32 v11, 16, v11
    v_cndmask_b32 v19, v19, v1, vcc
    s_mul_i32 s48, s53, 205
    s_lshr_b32 s48, s48, 5
    s_lshl_b32 s48, s48, 9
    s_lshl_b32 s49, s52, 7
    s_add_u32 s48, s48, s49
    s_lshl_b32 s49, s42, 3
    s_add_u32 s48, s48, s49
    s_lshl_b32 s49, s16, 14
    s_add_u32 s48, s48, s49
    v_lshl_add_u32 v5, v0, 9, s48
    s_min_u32 s49, s53, 1
    s_lshl_b32 s49, s49, 2
    v_mov_b32 v10, s49
    v_cmp_eq_u32 vcc, 0, v0
    s_xor_b32 s48, s53, 2
    s_min_u32 s48, s48, 1
    v_cndmask_b32 v10, 0, v10, vcc
    v_add_u32 v5, v10, v5
    s_lshr_b32 s24, 0xff, s48
    s_mov_b32 s25, 0
    s_mul_i32 s48, s56, 20
    s_add_u32 s49, s48, 19
    s_xor_b32 s48, s48, s49
    s_lshr_b32 s48, s48, 7
    s_min_u32 s48, s48, 1
    s_sub_u32 s26, 0, s48
    s_mov_b32 s27, s26
    s_lshl_b32 s48, s56, 9
    v_lshl_add_u32 v6, v0, 3, s48
    s_lshl_b32 s58, s57, 2
    s_add_u32 s58, s58, s41
    s_and_b32 s48, s40, 4
    s_lshl_b32 s48, s48, 3
    s_add_u32 s58, s58, s48
    s_lshl_b32 s59, s40, 10
    s_mov_b32 s60, 0x000fffff
    s_mov_b32 s61, 0x000fffff
    s_mov_b32 s62, -1
    s_mov_b32 s63, 0
    s_mov_b32 s12, 0x00ff00ff
    s_mov_b32 s13, 0x000000ff
    s_mov_b32 s64, 1051011932
    s_mov_b32 s65, 0x3f80
    s_mul_i32 s66, s56, 163840
    s_add_u32 s66, s66, 5242880
    s_add_u32 s71, s66, s59
    s_add_u32 s3, s3, 0x9e3779b1
    s_mul_i32 s48, s58, 40960
    s_add_u32 s48, s48, 15728640
    s_lshl_b32 s28, s56, 10
    s_add_u32 s28, s28, s48
    s_lshr_b32 s29, s56, 2
    s_add_u32 s29, s29, 32
    s_lshl_b32 s29, s29, 10
    s_add_u32 s29, s29, s48
    s_and_b32 s48, s56, 1
    s_lshl_b32 s48, s48, 9
    s_add_u32 s29, s29, s48
    s_and_b32 s48, s56, 2
    s_lshl_b32 s48, s48, 2
    s_add_u32 s29, s29, s48
    s_lshl_b32 s48, s56, 1
    s_lshr_b32 s49, s41, 1
    s_add_u32 s48, s48, s49
    s_mul_i32 s48, s48, 40960
    s_and_b32 s49, s41, 1
    s_lshl_b32 s49, s49, 8
    s_add_u32 s48, s48, s49
    s_add_u32 s48, s48, 15728640
    s_lshr_b32 s49, s40, 2
    s_lshl_b32 s31, s49, 12
    s_add_u32 s31, s31, s48
    s_add_u32 s31, s31, 32768
    s_mul_i32 s67, s49, 2560
    s_mul_i32 s69, s49, 28160
    s_lshl_b32 s49, s49, 14
    s_add_u32 s30, s48, s49
    s_mul_i32 s48, s41, 2560
    s_add_u32 s69, s69, s48
    s_mul_i32 s34, s57, 102400
    s_add_u32 s34, s34, s59
    s_mul_i32 s35, s57, 10240
    s_sub_u32 s35, s35, 20480
    s_add_u32 s35, s35, s59
    v_lshrrev_b32 v11, 5, v0
    v_and_b32 v12, 31, v0
    v_and_b32 v17, 0x1b, v12
    v_cmp_eq_u32 vcc, 24, v17
    v_mov_b32 v16, 0x3f803f80
    v_lshlrev_b32 v13, 4, v11
    v_cndmask_b32 v17, 0, v16, vcc
    v_sub_u32 v13, v12, v13
    v_mov_b32 v14, 4048155338
    v_lshlrev_b32 v67, 4, v0
    v_and_b32 v15, 15, v12
    v_lshlrev_b32 v15, 4, v15
    v_lshrrev_b32 v16, 4, v12
    v_lshl_add_u32 v15, v16, 3, v15
    v_lshl_add_u32 v68, v11, 8, v15
    v_and_b32 v10, 3, v12
    v_lshrrev_b32 v15, 3, v12
    v_lshl_add_u32 v10, v15, 2, v10
    v_bfe_u32 v15, v12, 2, 1
    v_lshlrev_b32 v10, 4, v10
    v_lshl_add_u32 v16, v15, 3, v10
    v_lshl_add_u32 v16, v11, 8, v16
    v_add_u32 v64, s67, v16
    v_mul_u32_u24 v16, 20, v11
    v_add_u32 v16, v16, v12
    v_lshlrev_b32 v16, 4, v16
    s_add_u32 s48, s67, 1280
    v_add_u32 v65, s48, v16
    v_mov_b32 v66, 0xdddddddd
    v_lshrrev_b32 v10, 4, v0
    v_lshlrev_b32 v16, 9, v10
    v_and_b32 v15, 15, v0
    v_lshl_add_u32 v69, v15, 4, v16
    v_mul_u32_u24 v15, 2560, v15
    v_lshl_add_u32 v71, v10, 4, v15
    v_lshl_add_u32 v73, v10, 3, v15
    s_lshl_b32 s48, s67, 1
    v_add_u32 v70, s48, v67
    s_mul_i32 s48, s41, 5120
    v_add_u32 v72, s48, v67
    s_and_b32 s48, s56, 14
    s_lshl_b32 s48, s48, 7
    v_lshl_add_u32 v74, v12, 2, s48
    v_mov_b32 v76, 0x3f803f80
    v_mov_b32 v77, 0x00003f80
    v_mov_b32 v78, 0x3f803f80
    v_mov_b32 v79, 0x00003f80
    v_mov_b32 v80, v17
    v_mov_b32 v81, v17
    v_mov_b32 v82, v17
    v_mov_b32 v83, v17
    v_mov_b32 v84, v17
    v_mov_b32 v85, v17
    v_mov_b32 v86, v17
    v_mov_b32 v87, v17
    v_mov_b32 v88, v17
    v_mov_b32 v89, v17
    v_mov_b32 v90, v17
    v_mov_b32 v91, v17
    v_mov_b32 v92, v17
    v_mov_b32 v93, v17
    v_mov_b32 v94, v17
    v_mov_b32 v95, v17
    v_cmp_le_i32 vcc, 0, v13
    v_cmp_le_i32 s[52:53], 1, v13
    s_nop 0
    v_cndmask_b32 v96, 0, v14, vcc
    v_cndmask_b32 v97, 0, v14, s[52:53]
    v_sub_f32 v112, v14, v96
    v_cmp_le_i32 vcc, 2, v13
    v_cmp_le_i32 s[52:53], 3, v13
    v_sub_f32 v113, v14, v97
    v_cndmask_b32 v98, 0, v14, vcc
    v_cndmask_b32 v99, 0, v14, s[52:53]
    v_sub_f32 v114, v14, v98
    v_cmp_le_i32 vcc, 4, v13
    v_cmp_le_i32 s[52:53], 5, v13
    v_sub_f32 v115, v14, v99
    v_cndmask_b32 v100, 0, v14, vcc
    v_cndmask_b32 v101, 0, v14, s[52:53]
    v_sub_f32 v116, v14, v100
    v_cmp_le_i32 vcc, 6, v13
    v_cmp_le_i32 s[52:53], 7, v13
    v_sub_f32 v117, v14, v101
    v_cndmask_b32 v102, 0, v14, vcc
    v_cndmask_b32 v103, 0, v14, s[52:53]
    v_sub_f32 v118, v14, v102
    v_cmp_le_i32 vcc, 8, v13
    v_cmp_le_i32 s[52:53], 9, v13
    v_sub_f32 v119, v14, v103
    v_cndmask_b32 v104, 0, v14, vcc
    v_cndmask_b32 v105, 0, v14, s[52:53]
    v_sub_f32 v120, v14, v104
    v_cmp_le_i32 vcc, 10, v13
    v_cmp_le_i32 s[52:53], 11, v13
    v_sub_f32 v121, v14, v105
    v_cndmask_b32 v106, 0, v14, vcc
    v_cndmask_b32 v107, 0, v14, s[52:53]
    v_sub_f32 v122, v14, v106
    v_cmp_le_i32 vcc, 12, v13
    v_cmp_le_i32 s[52:53], 13, v13
    v_sub_f32 v123, v14, v107
    v_cndmask_b32 v108, 0, v14, vcc
    v_cndmask_b32 v109, 0, v14, s[52:53]
    v_sub_f32 v124, v14, v108
    v_cmp_le_i32 vcc, 14, v13
    v_cmp_le_i32 s[52:53], 15, v13
    v_sub_f32 v125, v14, v109
    v_cndmask_b32 v110, 0, v14, vcc
    v_cndmask_b32 v111, 0, v14, s[52:53]
    v_sub_f32 v126, v14, v110
    v_sub_f32 v127, v14, v111
    v_lshrrev_b32 v10, 5, v0
    v_bfe_u32 v11, v0, 4, 1
    v_bfe_u32 v12, v0, 2, 2
    v_and_b32 v13, 3, v0
    v_lshlrev_b32 v33, 3, v13
    v_lshlrev_b32 v13, 4, v13
    v_mul_u32_u24 v14, 20, v10
    v_lshl_add_u32 v14, v11, 2, v14
    v_add_u32 v14, v14, v12
    v_mul_u32_u24 v14, 160, v14
    v_add_u32 v30, v14, v13
    v_mul_u32_u24 v14, 80, v10
    v_mul_u32_u24 v11, 20, v11
    v_add3_u32 v14, v14, v11, v12
    v_add_u32 v14, 16, v14
    v_mul_u32_u24 v14, 160, v14
    v_add_u32 v31, v14, v13
    s_mul_i32 s48, s40, 6400
    v_add_u32 v30, s48, v30
    s_mul_i32 s48, s40, 25600
    v_add_u32 v31, s48, v31
    v_sub_u32 v34, v30, v33
    v_sub_u32 v35, v31, v33
    s_lshl_b32 s52, s16, 3
    s_add_u32 s52, s52, s42
    s_mul_i32 s48, s52, 102400
    s_add_u32 s48, s48, 22020096
    s_mul_i32 s49, s40, 10240
    s_add_u32 s49, s49, s48
    s_lshr_b32 s50, s40, 1
    s_mul_i32 s50, s50, 5120
    s_and_b32 s51, s40, 1
    s_mul_i32 s51, s51, 10240
    s_add_u32 s50, s50, s51
    s_add_u32 s50, s50, s48
    s_add_u32 s50, s50, 81920
    s_waitcnt vmcnt(0)
    s_barrier
    ds_read_b64_tr_b16 v[188:189], v30 offset:0
    ds_read_b64_tr_b16 v[190:191], v30 offset:1280
    ds_read_b64_tr_b16 v[192:193], v30 offset:8
    ds_read_b64_tr_b16 v[194:195], v30 offset:1288
    ds_read_b64_tr_b16 v[196:197], v30 offset:64
    ds_read_b64_tr_b16 v[198:199], v30 offset:1344
    ds_read_b64_tr_b16 v[200:201], v30 offset:72
    ds_read_b64_tr_b16 v[202:203], v30 offset:1352
    ds_read_b64_tr_b16 v[204:205], v34 offset:128
    ds_read_b64_tr_b16 v[206:207], v34 offset:1408
    s_waitcnt lgkmcnt(0)
    buffer_store_dwordx4 v[188:191], v67, s[20:23], s49 offen offset:0 sc1
    buffer_store_dwordx4 v[192:195], v67, s[20:23], s49 offen offset:1024 sc1
    buffer_store_dwordx4 v[196:199], v67, s[20:23], s49 offen offset:2048 sc1
    buffer_store_dwordx4 v[200:203], v67, s[20:23], s49 offen offset:3072 sc1
    s_add_u32 s51, s49, 4096
    buffer_store_dwordx4 v[204:207], v67, s[20:23], s51 offen sc1
L_id_27:
    ds_read_b64_tr_b16 v[208:209], v30 offset:51200
    ds_read_b64_tr_b16 v[210:211], v30 offset:52480
    ds_read_b64_tr_b16 v[212:213], v30 offset:51208
    ds_read_b64_tr_b16 v[214:215], v30 offset:52488
    ds_read_b64_tr_b16 v[216:217], v30 offset:51264
    ds_read_b64_tr_b16 v[218:219], v30 offset:52544
    ds_read_b64_tr_b16 v[220:221], v30 offset:51272
    ds_read_b64_tr_b16 v[222:223], v30 offset:52552
    ds_read_b64_tr_b16 v[224:225], v34 offset:51328
    ds_read_b64_tr_b16 v[226:227], v34 offset:52608
    s_waitcnt lgkmcnt(0)
    s_add_u32 s49, s49, 5120
    buffer_store_dwordx4 v[208:211], v67, s[20:23], s49 offen offset:0 sc1
    buffer_store_dwordx4 v[212:215], v67, s[20:23], s49 offen offset:1024 sc1
    buffer_store_dwordx4 v[216:219], v67, s[20:23], s49 offen offset:2048 sc1
    buffer_store_dwordx4 v[220:223], v67, s[20:23], s49 offen offset:3072 sc1
    s_add_u32 s51, s49, 4096
    buffer_store_dwordx4 v[224:227], v67, s[20:23], s51 offen sc1
L_id_28:
    s_cmp_ge_u32 s40, 4
    s_cbranch_scc1 L_id_29
    ds_read_b64_tr_b16 v[228:229], v31 offset:0
    ds_read_b64_tr_b16 v[230:231], v31 offset:6400
    ds_read_b64_tr_b16 v[232:233], v31 offset:8
    ds_read_b64_tr_b16 v[234:235], v31 offset:6408
    ds_read_b64_tr_b16 v[236:237], v31 offset:64
    ds_read_b64_tr_b16 v[238:239], v31 offset:6464
    ds_read_b64_tr_b16 v[240:241], v31 offset:72
    ds_read_b64_tr_b16 v[242:243], v31 offset:6472
    ds_read_b64_tr_b16 v[244:245], v35 offset:128
    ds_read_b64_tr_b16 v[246:247], v35 offset:6528
    s_waitcnt lgkmcnt(0)
    buffer_store_dwordx4 v[228:231], v67, s[20:23], s50 offen offset:0 sc1
    buffer_store_dwordx4 v[232:235], v67, s[20:23], s50 offen offset:1024 sc1
    buffer_store_dwordx4 v[236:239], v67, s[20:23], s50 offen offset:2048 sc1
    buffer_store_dwordx4 v[240:243], v67, s[20:23], s50 offen offset:3072 sc1
    s_add_u32 s51, s50, 4096
    buffer_store_dwordx4 v[244:247], v67, s[20:23], s51 offen sc1
L_id_29:
    s_waitcnt vmcnt(0)
    s_barrier
    s_cmp_lg_u32 s40, 1
    s_cbranch_scc1 L_w_30
    s_lshl_b32 s52, s52, 3
    s_add_u32 s52, s52, 20971904
    v_lshlrev_b32 v10, 9, v0
    v_mov_b32 v12, s3
    v_mov_b32 v13, s3
    s_mov_b64 exec, s[62:63]
    buffer_store_dwordx2 v[12:13], v10, s[20:23], s52 offen sc1
    s_mov_b64 exec, -1
L_w_30:
    s_cmp_lg_u32 s40, 0
    s_cbranch_scc1 L_w_31
    s_mov_b32 s17, 20987904
    buffer_load_dwordx2 v[8:9], v6, s[20:23], s17 offen sc1
L_w_31:
    s_cmp_lg_u32 s40, 0
    s_cbranch_scc1 L_w_32
    s_mov_b32 s70, 0x20000
    s_waitcnt vmcnt(0)
L_spin_33:
    v_cmp_eq_u32 s[32:33], s3, v8
    v_cmp_eq_u32 s[18:19], s3, v9
    s_orn2_b64 s[18:19], s[18:19], s[26:27]
    s_and_b64 s[32:33], s[32:33], s[18:19]
    s_orn2_b64 s[32:33], s[32:33], s[12:13]
    s_cmp_eq_u64 s[32:33], -1
    s_cbranch_scc1 L_w_32
    s_sleep 8
    s_mov_b32 s17, 20987904
    buffer_load_dwordx2 v[8:9], v6, s[20:23], s17 offen sc1
    s_sub_u32 s70, s70, 1
    s_cmp_lg_u32 s70, 0
    s_waitcnt vmcnt(0)
    s_cbranch_scc1 L_spin_33
L_w_32:
    s_barrier
    s_mul_i32 s50, s56, 64
    s_and_b32 s17, s58, 31
    s_add_u32 s50, s50, s17
    s_mul_i32 s50, s50, 1280
    s_add_u32 s50, s50, 2621440
    buffer_load_dwordx2 v[144:145], v68, s[20:23], s50 offen sc1
    buffer_load_dwordx2 v[146:147], v68, s[20:23], s50 offen offset:512 sc1
    s_mov_b64 exec, s[62:63]
    buffer_load_dwordx2 v[148:149], v68, s[20:23], s50 offen offset:1024 sc1
    s_mov_b64 exec, -1
    s_add_u32 m0, s59, 0
    s_add_u32 s50, s71, 5242880
    buffer_load_dwordx4 v67, s[20:23], s50 offen sc1 lds
    s_add_u32 m0, s59, 8192
    s_add_u32 s50, s71, 5251072
    buffer_load_dwordx4 v67, s[20:23], s50 offen sc1 lds
    s_add_u32 m0, s59, 16384
    s_add_u32 s50, s71, 5259264
    buffer_load_dwordx4 v67, s[20:23], s50 offen sc1 lds
    s_add_u32 m0, s59, 24576
    s_add_u32 s50, s71, 5267456
    buffer_load_dwordx4 v67, s[20:23], s50 offen sc1 lds
    s_add_u32 m0, s59, 32768
    s_add_u32 s50, s71, 5275648
    buffer_load_dwordx4 v67, s[20:23], s50 offen sc1 lds
    s_add_u32 m0, s59, 40960
    s_add_u32 s50, s71, 5283840
    buffer_load_dwordx4 v67, s[20:23], s50 offen sc1 lds
    s_add_u32 m0, s59, 49152
    s_add_u32 s50, s71, 5292032
    buffer_load_dwordx4 v67, s[20:23], s50 offen sc1 lds
    s_add_u32 m0, s59, 57344
    s_add_u32 s50, s71, 5300224
    buffer_load_dwordx4 v67, s[20:23], s50 offen sc1 lds
    s_add_u32 m0, s59, 65536
    s_add_u32 s50, s71, 5308416
    buffer_load_dwordx4 v67, s[20:23], s50 offen sc1 lds
    s_add_u32 m0, s59, 73728
    s_add_u32 s50, s71, 5316608
    buffer_load_dwordx4 v67, s[20:23], s50 offen sc1 lds
    s_waitcnt vmcnt(0)
    s_branch L_attn
L_slowA:
    v_sub_f32 v224, 4048155338, v112
    v_sub_f32 v225, 4048155338, v113
    v_sub_f32 v226, 4048155338, v114
    v_sub_f32 v227, 4048155338, v115
    v_sub_f32 v228, 4048155338, v116
    v_sub_f32 v229, 4048155338, v117
    v_sub_f32 v230, 4048155338, v118
    v_sub_f32 v231, 4048155338, v119
    v_sub_f32 v232, 4048155338, v120
    v_sub_f32 v233, 4048155338, v121
    v_sub_f32 v234, 4048155338, v122
    v_sub_f32 v235, 4048155338, v123
    v_sub_f32 v236, 4048155338, v124
    v_sub_f32 v237, 4048155338, v125
    v_sub_f32 v238, 4048155338, v126
    v_sub_f32 v239, 4048155338, v127
    v_mov_b32 v15, 0x3f800000
    v_cndmask_b32 v160, 0, v160, s[62:63]
    v_cndmask_b32 v161, v15, v161, s[62:63]
    s_add_u32 s48, s67, 122880
    v_subrev_u32 v3, s48, v64
    v_subrev_u32 v4, s48, v65
    v_mov_b32 v2, 0xff800000
    s_cmp_ge_u32 s58, 8
    s_cselect_b32 s48, s65, 4048109440
    v_mov_b32 v77, s48
    s_add_i32 s50, s58, -8
    s_max_i32 s50, s50, 0
    s_mul_i32 s50, s50, 2560
    s_add_u32 s50, s50, s66
    buffer_load_dwordx2 v[164:165], v3, s[20:23], s50 offen sc1
    buffer_load_dwordx2 v[166:167], v3, s[20:23], s50 offen offset:512 sc1
    s_mov_b64 exec, s[62:63]
    buffer_load_dwordx2 v[76:77], v3, s[20:23], s50 offen offset:1024 sc1
    s_mov_b64 exec, -1
    s_waitcnt vmcnt(0)
    v_mfma_f32_32x32x16_bf16 v[208:223], v[164:167], v[156:159], v[224:239]
    v_mfma_f32_32x32x8_bf16 v[208:223], v[76:77], v[160:161], v[208:223]
    s_nop 15
    v_max3_f32 v2, v2, v208, v209
    v_max3_f32 v2, v2, v210, v211
    v_max3_f32 v2, v2, v212, v213
    v_max3_f32 v2, v2, v214, v215
    v_max3_f32 v2, v2, v216, v217
    v_max3_f32 v2, v2, v218, v219
    v_max3_f32 v2, v2, v220, v221
    v_max3_f32 v2, v2, v222, v223
    s_cmp_ge_u32 s58, 7
    s_cselect_b32 s48, s65, 4048109440
    v_mov_b32 v77, s48
    s_add_i32 s50, s58, -7
    s_max_i32 s50, s50, 0
    s_mul_i32 s50, s50, 2560
    s_add_u32 s50, s50, s66
    buffer_load_dwordx2 v[164:165], v3, s[20:23], s50 offen sc1
    buffer_load_dwordx2 v[166:167], v3, s[20:23], s50 offen offset:512 sc1
    s_mov_b64 exec, s[62:63]
    buffer_load_dwordx2 v[76:77], v3, s[20:23], s50 offen offset:1024 sc1
    s_mov_b64 exec, -1
    s_waitcnt vmcnt(0)
    v_mfma_f32_32x32x16_bf16 v[208:223], v[164:167], v[156:159], 0
    v_mfma_f32_32x32x8_bf16 v[208:223], v[76:77], v[160:161], v[208:223]
    s_nop 15
    v_max3_f32 v2, v2, v208, v209
    v_max3_f32 v2, v2, v210, v211
    v_max3_f32 v2, v2, v212, v213
    v_max3_f32 v2, v2, v214, v215
    v_max3_f32 v2, v2, v216, v217
    v_max3_f32 v2, v2, v218, v219
    v_max3_f32 v2, v2, v220, v221
    v_max3_f32 v2, v2, v222, v223
    s_cmp_ge_u32 s58, 6
    s_cselect_b32 s48, s65, 4048109440
    v_mov_b32 v77, s48
    s_add_i32 s50, s58, -6
    s_max_i32 s50, s50, 0
    s_mul_i32 s50, s50, 2560
    s_add_u32 s50, s50, s66
    buffer_load_dwordx2 v[164:165], v3, s[20:23], s50 offen sc1
    buffer_load_dwordx2 v[166:167], v3, s[20:23], s50 offen offset:512 sc1
    s_mov_b64 exec, s[62:63]
    buffer_load_dwordx2 v[76:77], v3, s[20:23], s50 offen offset:1024 sc1
    s_mov_b64 exec, -1
    s_waitcnt vmcnt(0)
    v_mfma_f32_32x32x16_bf16 v[208:223], v[164:167], v[156:159], 0
    v_mfma_f32_32x32x8_bf16 v[208:223], v[76:77], v[160:161], v[208:223]
    s_nop 15
    v_max3_f32 v2, v2, v208, v209
    v_max3_f32 v2, v2, v210, v211
    v_max3_f32 v2, v2, v212, v213
    v_max3_f32 v2, v2, v214, v215
    v_max3_f32 v2, v2, v216, v217
    v_max3_f32 v2, v2, v218, v219
    v_max3_f32 v2, v2, v220, v221
    v_max3_f32 v2, v2, v222, v223
    s_cmp_ge_u32 s58, 5
    s_cselect_b32 s48, s65, 4048109440
    v_mov_b32 v77, s48
    s_add_i32 s50, s58, -5
    s_max_i32 s50, s50, 0
    s_mul_i32 s50, s50, 2560
    s_add_u32 s50, s50, s66
    buffer_load_dwordx2 v[164:165], v3, s[20:23], s50 offen sc1
    buffer_load_dwordx2 v[166:167], v3, s[20:23], s50 offen offset:512 sc1
    s_mov_b64 exec, s[62:63]
    buffer_load_dwordx2 v[76:77], v3, s[20:23], s50 offen offset:1024 sc1
    s_mov_b64 exec, -1
    s_waitcnt vmcnt(0)
    v_mfma_f32_32x32x16_bf16 v[208:223], v[164:167], v[156:159], 0
    v_mfma_f32_32x32x8_bf16 v[208:223], v[76:77], v[160:161], v[208:223]
    s_nop 15
    v_max3_f32 v2, v2, v208, v209
    v_max3_f32 v2, v2, v210, v211
    v_max3_f32 v2, v2, v212, v213
    v_max3_f32 v2, v2, v214, v215
    v_max3_f32 v2, v2, v216, v217
    v_max3_f32 v2, v2, v218, v219
    v_max3_f32 v2, v2, v220, v221
    v_max3_f32 v2, v2, v222, v223
    s_cmp_ge_u32 s58, 4
    s_cselect_b32 s48, s65, 4048109440
    v_mov_b32 v77, s48
    s_add_i32 s50, s58, -4
    s_max_i32 s50, s50, 0
    s_mul_i32 s50, s50, 2560
    s_add_u32 s50, s50, s66
    buffer_load_dwordx2 v[164:165], v3, s[20:23], s50 offen sc1
    buffer_load_dwordx2 v[166:167], v3, s[20:23], s50 offen offset:512 sc1
    s_mov_b64 exec, s[62:63]
    buffer_load_dwordx2 v[76:77], v3, s[20:23], s50 offen offset:1024 sc1
    s_mov_b64 exec, -1
    s_waitcnt vmcnt(0)
    v_mfma_f32_32x32x16_bf16 v[208:223], v[164:167], v[156:159], 0
    v_mfma_f32_32x32x8_bf16 v[208:223], v[76:77], v[160:161], v[208:223]
    s_nop 15
    v_max3_f32 v2, v2, v208, v209
    v_max3_f32 v2, v2, v210, v211
    v_max3_f32 v2, v2, v212, v213
    v_max3_f32 v2, v2, v214, v215
    v_max3_f32 v2, v2, v216, v217
    v_max3_f32 v2, v2, v218, v219
    v_max3_f32 v2, v2, v220, v221
    v_max3_f32 v2, v2, v222, v223
    s_cmp_ge_u32 s58, 3
    s_cselect_b32 s48, s65, 4048109440
    v_mov_b32 v77, s48
    s_add_i32 s50, s58, -3
    s_max_i32 s50, s50, 0
    s_mul_i32 s50, s50, 2560
    s_add_u32 s50, s50, s66
    buffer_load_dwordx2 v[164:165], v3, s[20:23], s50 offen sc1
    buffer_load_dwordx2 v[166:167], v3, s[20:23], s50 offen offset:512 sc1
    s_mov_b64 exec, s[62:63]
    buffer_load_dwordx2 v[76:77], v3, s[20:23], s50 offen offset:1024 sc1
    s_mov_b64 exec, -1
    s_waitcnt vmcnt(0)
    v_mfma_f32_32x32x16_bf16 v[208:223], v[164:167], v[156:159], 0
    v_mfma_f32_32x32x8_bf16 v[208:223], v[76:77], v[160:161], v[208:223]
    s_nop 15
    v_max3_f32 v2, v2, v208, v209
    v_max3_f32 v2, v2, v210, v211
    v_max3_f32 v2, v2, v212, v213
    v_max3_f32 v2, v2, v214, v215
    v_max3_f32 v2, v2, v216, v217
    v_max3_f32 v2, v2, v218, v219
    v_max3_f32 v2, v2, v220, v221
    v_max3_f32 v2, v2, v222, v223
    s_cmp_ge_u32 s58, 2
    s_cselect_b32 s48, s65, 4048109440
    v_mov_b32 v77, s48
    s_add_i32 s50, s58, -2
    s_max_i32 s50, s50, 0
    s_mul_i32 s50, s50, 2560
    s_add_u32 s50, s50, s66
    buffer_load_dwordx2 v[164:165], v3, s[20:23], s50 offen sc1
    buffer_load_dwordx2 v[166:167], v3, s[20:23], s50 offen offset:512 sc1
    s_mov_b64 exec, s[62:63]
    buffer_load_dwordx2 v[76:77], v3, s[20:23], s50 offen offset:1024 sc1
    s_mov_b64 exec, -1
    s_waitcnt vmcnt(0)
    v_mfma_f32_32x32x16_bf16 v[208:223], v[164:167], v[156:159], 0
    v_mfma_f32_32x32x8_bf16 v[208:223], v[76:77], v[160:161], v[208:223]
    s_nop 15
    v_max3_f32 v2, v2, v208, v209
    v_max3_f32 v2, v2, v210, v211
    v_max3_f32 v2, v2, v212, v213
    v_max3_f32 v2, v2, v214, v215
    v_max3_f32 v2, v2, v216, v217
    v_max3_f32 v2, v2, v218, v219
    v_max3_f32 v2, v2, v220, v221
    v_max3_f32 v2, v2, v222, v223
    s_cmp_ge_u32 s58, 1
    s_cselect_b32 s48, s65, 4048109440
    v_mov_b32 v77, s48
    s_add_i32 s50, s58, -1
    s_max_i32 s50, s50, 0
    s_mul_i32 s50, s50, 2560
    s_add_u32 s50, s50, s66
    buffer_load_dwordx2 v[164:165], v3, s[20:23], s50 offen sc1
    buffer_load_dwordx2 v[166:167], v3, s[20:23], s50 offen offset:512 sc1
    s_mov_b64 exec, s[62:63]
    buffer_load_dwordx2 v[76:77], v3, s[20:23], s50 offen offset:1024 sc1
    s_mov_b64 exec, -1
    s_waitcnt vmcnt(0)
    v_mfma_f32_32x32x16_bf16 v[208:223], v[164:167], v[156:159], 0
    v_mfma_f32_32x32x8_bf16 v[208:223], v[76:77], v[160:161], v[208:223]
    s_nop 15
    v_max3_f32 v2, v2, v208, v209
    v_max3_f32 v2, v2, v210, v211
    v_max3_f32 v2, v2, v212, v213
    v_max3_f32 v2, v2, v214, v215
    v_max3_f32 v2, v2, v216, v217
    v_max3_f32 v2, v2, v218, v219
    v_max3_f32 v2, v2, v220, v221
    v_max3_f32 v2, v2, v222, v223
    s_cmp_ge_u32 s58, 0
    s_cselect_b32 s48, s65, 4048109440
    v_mov_b32 v77, s48
    s_add_i32 s50, s58, 0
    s_max_i32 s50, s50, 0
    s_mul_i32 s50, s50, 2560
    s_add_u32 s50, s50, s66
    buffer_load_dwordx2 v[164:165], v3, s[20:23], s50 offen sc1
    buffer_load_dwordx2 v[166:167], v3, s[20:23], s50 offen offset:512 sc1
    s_mov_b64 exec, s[62:63]
    buffer_load_dwordx2 v[76:77], v3, s[20:23], s50 offen offset:1024 sc1
    s_mov_b64 exec, -1
    s_waitcnt vmcnt(0)
    v_mfma_f32_32x32x16_bf16 v[208:223], v[164:167], v[156:159], v[112:127]
    v_mfma_f32_32x32x8_bf16 v[208:223], v[76:77], v[160:161], v[208:223]
    s_nop 15
    v_max3_f32 v2, v2, v208, v209
    v_max3_f32 v2, v2, v210, v211
    v_max3_f32 v2, v2, v212, v213
    v_max3_f32 v2, v2, v214, v215
    v_max3_f32 v2, v2, v216, v217
    v_max3_f32 v2, v2, v218, v219
    v_max3_f32 v2, v2, v220, v221
    v_max3_f32 v2, v2, v222, v223
    v_mov_b32 v15, v2
    s_nop 1
    v_permlane32_swap_b32 v15, v2
    s_nop 1
    v_max_f32 v15, v15, v2
    v_sub_f32 v15, 0, v15
    v_and_b32 v16, 0xffff0000, v15
    v_sub_f32 v17, v15, v16
    v_and_b32 v14, 0xffff0000, v17
    v_sub_f32 v17, v17, v14
    v_lshrrev_b32 v16, 16, v16
    v_or_b32 v16, v16, v14
    v_lshrrev_b32 v17, 16, v17
    v_or_b32 v17, 0x3f800000, v17
    v_cndmask_b32 v160, v16, v160, s[62:63]
    v_cndmask_b32 v161, v17, v161, s[62:63]
    v_mfma_f32_32x32x8_bf16 v[96:111], v[162:163], v[162:163], 0
    s_cmp_ge_u32 s58, 8
    s_cselect_b32 s48, s65, 4048109440
    v_mov_b32 v77, s48
    s_add_i32 s50, s58, -8
    s_max_i32 s50, s50, 0
    s_mul_i32 s50, s50, 2560
    s_add_u32 s50, s50, s66
    buffer_load_dwordx2 v[164:165], v3, s[20:23], s50 offen sc1
    buffer_load_dwordx2 v[166:167], v3, s[20:23], s50 offen offset:512 sc1
    s_mov_b64 exec, s[62:63]
    buffer_load_dwordx2 v[76:77], v3, s[20:23], s50 offen offset:1024 sc1
    s_mov_b64 exec, s[60:61]
    buffer_load_dwordx4 v[80:83], v4, s[20:23], s50 offen sc1
    buffer_load_dwordx4 v[84:87], v4, s[20:23], s50 offen offset:640 sc1
    s_mov_b64 exec, -1
    s_waitcnt vmcnt(0)
    v_mfma_f32_32x32x16_bf16 v[208:223], v[164:167], v[156:159], v[224:239]
    v_mfma_f32_32x32x8_bf16 v[208:223], v[76:77], v[160:161], v[208:223]
    s_nop 15
    v_exp_f32 v208, v208
    v_exp_f32 v209, v209
    v_exp_f32 v210, v210
    v_exp_f32 v211, v211
    v_exp_f32 v212, v212
    v_exp_f32 v213, v213
    v_exp_f32 v214, v214
    v_exp_f32 v215, v215
    v_exp_f32 v216, v216
    v_exp_f32 v217, v217
    v_exp_f32 v218, v218
    v_exp_f32 v219, v219
    v_exp_f32 v220, v220
    v_exp_f32 v221, v221
    v_exp_f32 v222, v222
    v_exp_f32 v223, v223
    s_nop 1
    v_smfmac_f32_32x32x32_bf16 v[96:111], v[80:83], v[208:215], v66
    v_smfmac_f32_32x32x32_bf16 v[96:111], v[84:87], v[216:223], v66
    s_cmp_ge_u32 s58, 7
    s_cselect_b32 s48, s65, 4048109440
    v_mov_b32 v77, s48
    s_add_i32 s50, s58, -7
    s_max_i32 s50, s50, 0
    s_mul_i32 s50, s50, 2560
    s_add_u32 s50, s50, s66
    buffer_load_dwordx2 v[164:165], v3, s[20:23], s50 offen sc1
    buffer_load_dwordx2 v[166:167], v3, s[20:23], s50 offen offset:512 sc1
    s_mov_b64 exec, s[62:63]
    buffer_load_dwordx2 v[76:77], v3, s[20:23], s50 offen offset:1024 sc1
    s_mov_b64 exec, s[60:61]
    buffer_load_dwordx4 v[80:83], v4, s[20:23], s50 offen sc1
    buffer_load_dwordx4 v[84:87], v4, s[20:23], s50 offen offset:640 sc1
    s_mov_b64 exec, -1
    s_waitcnt vmcnt(0)
    v_mfma_f32_32x32x16_bf16 v[208:223], v[164:167], v[156:159], 0
    v_mfma_f32_32x32x8_bf16 v[208:223], v[76:77], v[160:161], v[208:223]
    s_nop 15
    v_exp_f32 v208, v208
    v_exp_f32 v209, v209
    v_exp_f32 v210, v210
    v_exp_f32 v211, v211
    v_exp_f32 v212, v212
    v_exp_f32 v213, v213
    v_exp_f32 v214, v214
    v_exp_f32 v215, v215
    v_exp_f32 v216, v216
    v_exp_f32 v217, v217
    v_exp_f32 v218, v218
    v_exp_f32 v219, v219
    v_exp_f32 v220, v220
    v_exp_f32 v221, v221
    v_exp_f32 v222, v222
    v_exp_f32 v223, v223
    s_nop 1
    v_smfmac_f32_32x32x32_bf16 v[96:111], v[80:83], v[208:215], v66
    v_smfmac_f32_32x32x32_bf16 v[96:111], v[84:87], v[216:223], v66
    s_cmp_ge_u32 s58, 6
    s_cselect_b32 s48, s65, 4048109440
    v_mov_b32 v77, s48
    s_add_i32 s50, s58, -6
    s_max_i32 s50, s50, 0
    s_mul_i32 s50, s50, 2560
    s_add_u32 s50, s50, s66
    buffer_load_dwordx2 v[164:165], v3, s[20:23], s50 offen sc1
    buffer_load_dwordx2 v[166:167], v3, s[20:23], s50 offen offset:512 sc1
    s_mov_b64 exec, s[62:63]
    buffer_load_dwordx2 v[76:77], v3, s[20:23], s50 offen offset:1024 sc1
    s_mov_b64 exec, s[60:61]
    buffer_load_dwordx4 v[80:83], v4, s[20:23], s50 offen sc1
    buffer_load_dwordx4 v[84:87], v4, s[20:23], s50 offen offset:640 sc1
    s_mov_b64 exec, -1
    s_waitcnt vmcnt(0)
    v_mfma_f32_32x32x16_bf16 v[208:223], v[164:167], v[156:159], 0
    v_mfma_f32_32x32x8_bf16 v[208:223], v[76:77], v[160:161], v[208:223]
    s_nop 15
    v_exp_f32 v208, v208
    v_exp_f32 v209, v209
    v_exp_f32 v210, v210
    v_exp_f32 v211, v211
    v_exp_f32 v212, v212
    v_exp_f32 v213, v213
    v_exp_f32 v214, v214
    v_exp_f32 v215, v215
    v_exp_f32 v216, v216
    v_exp_f32 v217, v217
    v_exp_f32 v218, v218
    v_exp_f32 v219, v219
    v_exp_f32 v220, v220
    v_exp_f32 v221, v221
    v_exp_f32 v222, v222
    v_exp_f32 v223, v223
    s_nop 1
    v_smfmac_f32_32x32x32_bf16 v[96:111], v[80:83], v[208:215], v66
    v_smfmac_f32_32x32x32_bf16 v[96:111], v[84:87], v[216:223], v66
    s_cmp_ge_u32 s58, 5
    s_cselect_b32 s48, s65, 4048109440
    v_mov_b32 v77, s48
    s_add_i32 s50, s58, -5
    s_max_i32 s50, s50, 0
    s_mul_i32 s50, s50, 2560
    s_add_u32 s50, s50, s66
    buffer_load_dwordx2 v[164:165], v3, s[20:23], s50 offen sc1
    buffer_load_dwordx2 v[166:167], v3, s[20:23], s50 offen offset:512 sc1
    s_mov_b64 exec, s[62:63]
    buffer_load_dwordx2 v[76:77], v3, s[20:23], s50 offen offset:1024 sc1
    s_mov_b64 exec, s[60:61]
    buffer_load_dwordx4 v[80:83], v4, s[20:23], s50 offen sc1
    buffer_load_dwordx4 v[84:87], v4, s[20:23], s50 offen offset:640 sc1
    s_mov_b64 exec, -1
    s_waitcnt vmcnt(0)
    v_mfma_f32_32x32x16_bf16 v[208:223], v[164:167], v[156:159], 0
    v_mfma_f32_32x32x8_bf16 v[208:223], v[76:77], v[160:161], v[208:223]
    s_nop 15
    v_exp_f32 v208, v208
    v_exp_f32 v209, v209
    v_exp_f32 v210, v210
    v_exp_f32 v211, v211
    v_exp_f32 v212, v212
    v_exp_f32 v213, v213
    v_exp_f32 v214, v214
    v_exp_f32 v215, v215
    v_exp_f32 v216, v216
    v_exp_f32 v217, v217
    v_exp_f32 v218, v218
    v_exp_f32 v219, v219
    v_exp_f32 v220, v220
    v_exp_f32 v221, v221
    v_exp_f32 v222, v222
    v_exp_f32 v223, v223
    s_nop 1
    v_smfmac_f32_32x32x32_bf16 v[96:111], v[80:83], v[208:215], v66
    v_smfmac_f32_32x32x32_bf16 v[96:111], v[84:87], v[216:223], v66
    s_cmp_ge_u32 s58, 4
    s_cselect_b32 s48, s65, 4048109440
    v_mov_b32 v77, s48
    s_add_i32 s50, s58, -4
    s_max_i32 s50, s50, 0
    s_mul_i32 s50, s50, 2560
    s_add_u32 s50, s50, s66
    buffer_load_dwordx2 v[164:165], v3, s[20:23], s50 offen sc1
    buffer_load_dwordx2 v[166:167], v3, s[20:23], s50 offen offset:512 sc1
    s_mov_b64 exec, s[62:63]
    buffer_load_dwordx2 v[76:77], v3, s[20:23], s50 offen offset:1024 sc1
    s_mov_b64 exec, s[60:61]
    buffer_load_dwordx4 v[80:83], v4, s[20:23], s50 offen sc1
    buffer_load_dwordx4 v[84:87], v4, s[20:23], s50 offen offset:640 sc1
    s_mov_b64 exec, -1
    s_waitcnt vmcnt(0)
    v_mfma_f32_32x32x16_bf16 v[208:223], v[164:167], v[156:159], 0
    v_mfma_f32_32x32x8_bf16 v[208:223], v[76:77], v[160:161], v[208:223]
    s_nop 15
    v_exp_f32 v208, v208
    v_exp_f32 v209, v209
    v_exp_f32 v210, v210
    v_exp_f32 v211, v211
    v_exp_f32 v212, v212
    v_exp_f32 v213, v213
    v_exp_f32 v214, v214
    v_exp_f32 v215, v215
    v_exp_f32 v216, v216
    v_exp_f32 v217, v217
    v_exp_f32 v218, v218
    v_exp_f32 v219, v219
    v_exp_f32 v220, v220
    v_exp_f32 v221, v221
    v_exp_f32 v222, v222
    v_exp_f32 v223, v223
    s_nop 1
    v_smfmac_f32_32x32x32_bf16 v[96:111], v[80:83], v[208:215], v66
    v_smfmac_f32_32x32x32_bf16 v[96:111], v[84:87], v[216:223], v66
    s_cmp_ge_u32 s58, 3
    s_cselect_b32 s48, s65, 4048109440
    v_mov_b32 v77, s48
    s_add_i32 s50, s58, -3
    s_max_i32 s50, s50, 0
    s_mul_i32 s50, s50, 2560
    s_add_u32 s50, s50, s66
    buffer_load_dwordx2 v[164:165], v3, s[20:23], s50 offen sc1
    buffer_load_dwordx2 v[166:167], v3, s[20:23], s50 offen offset:512 sc1
    s_mov_b64 exec, s[62:63]
    buffer_load_dwordx2 v[76:77], v3, s[20:23], s50 offen offset:1024 sc1
    s_mov_b64 exec, s[60:61]
    buffer_load_dwordx4 v[80:83], v4, s[20:23], s50 offen sc1
    buffer_load_dwordx4 v[84:87], v4, s[20:23], s50 offen offset:640 sc1
    s_mov_b64 exec, -1
    s_waitcnt vmcnt(0)
    v_mfma_f32_32x32x16_bf16 v[208:223], v[164:167], v[156:159], 0
    v_mfma_f32_32x32x8_bf16 v[208:223], v[76:77], v[160:161], v[208:223]
    s_nop 15
    v_exp_f32 v208, v208
    v_exp_f32 v209, v209
    v_exp_f32 v210, v210
    v_exp_f32 v211, v211
    v_exp_f32 v212, v212
    v_exp_f32 v213, v213
    v_exp_f32 v214, v214
    v_exp_f32 v215, v215
    v_exp_f32 v216, v216
    v_exp_f32 v217, v217
    v_exp_f32 v218, v218
    v_exp_f32 v219, v219
    v_exp_f32 v220, v220
    v_exp_f32 v221, v221
    v_exp_f32 v222, v222
    v_exp_f32 v223, v223
    s_nop 1
    v_smfmac_f32_32x32x32_bf16 v[96:111], v[80:83], v[208:215], v66
    v_smfmac_f32_32x32x32_bf16 v[96:111], v[84:87], v[216:223], v66
    s_cmp_ge_u32 s58, 2
    s_cselect_b32 s48, s65, 4048109440
    v_mov_b32 v77, s48
    s_add_i32 s50, s58, -2
    s_max_i32 s50, s50, 0
    s_mul_i32 s50, s50, 2560
    s_add_u32 s50, s50, s66
    buffer_load_dwordx2 v[164:165], v3, s[20:23], s50 offen sc1
    buffer_load_dwordx2 v[166:167], v3, s[20:23], s50 offen offset:512 sc1
    s_mov_b64 exec, s[62:63]
    buffer_load_dwordx2 v[76:77], v3, s[20:23], s50 offen offset:1024 sc1
    s_mov_b64 exec, s[60:61]
    buffer_load_dwordx4 v[80:83], v4, s[20:23], s50 offen sc1
    buffer_load_dwordx4 v[84:87], v4, s[20:23], s50 offen offset:640 sc1
    s_mov_b64 exec, -1
    s_waitcnt vmcnt(0)
    v_mfma_f32_32x32x16_bf16 v[208:223], v[164:167], v[156:159], 0
    v_mfma_f32_32x32x8_bf16 v[208:223], v[76:77], v[160:161], v[208:223]
    s_nop 15
    v_exp_f32 v208, v208
    v_exp_f32 v209, v209
    v_exp_f32 v210, v210
    v_exp_f32 v211, v211
    v_exp_f32 v212, v212
    v_exp_f32 v213, v213
    v_exp_f32 v214, v214
    v_exp_f32 v215, v215
    v_exp_f32 v216, v216
    v_exp_f32 v217, v217
    v_exp_f32 v218, v218
    v_exp_f32 v219, v219
    v_exp_f32 v220, v220
    v_exp_f32 v221, v221
    v_exp_f32 v222, v222
    v_exp_f32 v223, v223
    s_nop 1
    v_smfmac_f32_32x32x32_bf16 v[96:111], v[80:83], v[208:215], v66
    v_smfmac_f32_32x32x32_bf16 v[96:111], v[84:87], v[216:223], v66
    s_cmp_ge_u32 s58, 1
    s_cselect_b32 s48, s65, 4048109440
    v_mov_b32 v77, s48
    s_add_i32 s50, s58, -1
    s_max_i32 s50, s50, 0
    s_mul_i32 s50, s50, 2560
    s_add_u32 s50, s50, s66
    buffer_load_dwordx2 v[164:165], v3, s[20:23], s50 offen sc1
    buffer_load_dwordx2 v[166:167], v3, s[20:23], s50 offen offset:512 sc1
    s_mov_b64 exec, s[62:63]
    buffer_load_dwordx2 v[76:77], v3, s[20:23], s50 offen offset:1024 sc1
    s_mov_b64 exec, s[60:61]
    buffer_load_dwordx4 v[80:83], v4, s[20:23], s50 offen sc1
    buffer_load_dwordx4 v[84:87], v4, s[20:23], s50 offen offset:640 sc1
    s_mov_b64 exec, -1
    s_waitcnt vmcnt(0)
    v_mfma_f32_32x32x16_bf16 v[208:223], v[164:167], v[156:159], 0
    v_mfma_f32_32x32x8_bf16 v[208:223], v[76:77], v[160:161], v[208:223]
    s_nop 15
    v_exp_f32 v208, v208
    v_exp_f32 v209, v209
    v_exp_f32 v210, v210
    v_exp_f32 v211, v211
    v_exp_f32 v212, v212
    v_exp_f32 v213, v213
    v_exp_f32 v214, v214
    v_exp_f32 v215, v215
    v_exp_f32 v216, v216
    v_exp_f32 v217, v217
    v_exp_f32 v218, v218
    v_exp_f32 v219, v219
    v_exp_f32 v220, v220
    v_exp_f32 v221, v221
    v_exp_f32 v222, v222
    v_exp_f32 v223, v223
    s_nop 1
    v_smfmac_f32_32x32x32_bf16 v[96:111], v[80:83], v[208:215], v66
    v_smfmac_f32_32x32x32_bf16 v[96:111], v[84:87], v[216:223], v66
    s_cmp_ge_u32 s58, 0
    s_cselect_b32 s48, s65, 4048109440
    v_mov_b32 v77, s48
    s_add_i32 s50, s58, 0
    s_max_i32 s50, s50, 0
    s_mul_i32 s50, s50, 2560
    s_add_u32 s50, s50, s66
    buffer_load_dwordx2 v[164:165], v3, s[20:23], s50 offen sc1
    buffer_load_dwordx2 v[166:167], v3, s[20:23], s50 offen offset:512 sc1
    s_mov_b64 exec, s[62:63]
    buffer_load_dwordx2 v[76:77], v3, s[20:23], s50 offen offset:1024 sc1
    s_mov_b64 exec, s[60:61]
    buffer_load_dwordx4 v[80:83], v4, s[20:23], s50 offen sc1
    buffer_load_dwordx4 v[84:87], v4, s[20:23], s50 offen offset:640 sc1
    s_mov_b64 exec, -1
    s_waitcnt vmcnt(0)
    v_mfma_f32_32x32x16_bf16 v[208:223], v[164:167], v[156:159], v[112:127]
    v_mfma_f32_32x32x8_bf16 v[208:223], v[76:77], v[160:161], v[208:223]
    s_nop 15
    v_exp_f32 v208, v208
    v_exp_f32 v209, v209
    v_exp_f32 v210, v210
    v_exp_f32 v211, v211
    v_exp_f32 v212, v212
    v_exp_f32 v213, v213
    v_exp_f32 v214, v214
    v_exp_f32 v215, v215
    v_exp_f32 v216, v216
    v_exp_f32 v217, v217
    v_exp_f32 v218, v218
    v_exp_f32 v219, v219
    v_exp_f32 v220, v220
    v_exp_f32 v221, v221
    v_exp_f32 v222, v222
    v_exp_f32 v223, v223
    s_nop 1
    v_smfmac_f32_32x32x32_bf16 v[96:111], v[80:83], v[208:215], v66
    v_smfmac_f32_32x32x32_bf16 v[96:111], v[84:87], v[216:223], v66
    s_nop 15
    v_rcp_f32 v15, v108
    s_add_u32 s49, s28, 0
    s_add_u32 s51, s29, 0
    v_mul_f32 v96, v96, v15
    v_mul_f32 v97, v97, v15
    v_mul_f32 v98, v98, v15
    v_mul_f32 v99, v99, v15
    v_mul_f32 v100, v100, v15
    v_mul_f32 v101, v101, v15
    v_mul_f32 v102, v102, v15
    v_mul_f32 v103, v103, v15
    v_mul_f32 v104, v104, v15
    v_mul_f32 v105, v105, v15
    v_mul_f32 v106, v106, v15
    v_mul_f32 v107, v107, v15
    v_cvt_pk_bf16_f32 v18, v96, v97
    v_cvt_pk_bf16_f32 v19, v98, v99
    v_cvt_pk_bf16_f32 v20, v100, v101
    v_cvt_pk_bf16_f32 v21, v102, v103
    v_cvt_pk_bf16_f32 v22, v104, v105
    v_cvt_pk_bf16_f32 v23, v106, v107
    buffer_store_dwordx4 v[18:21], v67, s[20:23], s49 offen sc1
    s_mov_b64 exec, s[62:63]
    buffer_store_dwordx2 v[22:23], v67, s[20:23], s51 offen sc1
    s_mov_b64 exec, -1
    s_branch L_chkB
L_slowB:
    v_mov_b32 v15, 0x3f800000
    v_cndmask_b32 v148, 0, v148, s[62:63]
    v_cndmask_b32 v149, v15, v149, s[62:63]
    s_add_u32 s48, s67, 122880
    v_subrev_u32 v3, s48, v64
    v_subrev_u32 v4, s48, v65
    v_mov_b32 v2, 0xff800000
    s_add_u32 s51, s66, 5406720
    s_sub_u32 s50, s51, 163840
L_slow0:
    buffer_load_dwordx2 v[164:165], v3, s[20:23], s50 offen sc1
    buffer_load_dwordx2 v[166:167], v3, s[20:23], s50 offen offset:512 sc1
    s_mov_b64 exec, s[62:63]
    buffer_load_dwordx2 v[76:77], v3, s[20:23], s50 offen offset:1024 sc1
    s_mov_b64 exec, -1
    s_waitcnt vmcnt(0)
    v_mfma_f32_32x32x16_bf16 v[208:223], v[164:167], v[144:147], 0
    v_mfma_f32_32x32x8_bf16 v[208:223], v[76:77], v[148:149], v[208:223]
    s_nop 15
    v_max3_f32 v2, v2, v208, v209
    v_max3_f32 v2, v2, v210, v211
    v_max3_f32 v2, v2, v212, v213
    v_max3_f32 v2, v2, v214, v215
    v_max3_f32 v2, v2, v216, v217
    v_max3_f32 v2, v2, v218, v219
    v_max3_f32 v2, v2, v220, v221
    v_max3_f32 v2, v2, v222, v223
    s_add_u32 s50, s50, 2560
    s_cmp_lt_u32 s50, s51
    s_cbranch_scc1 L_slow0
    v_mov_b32 v15, v2
    s_nop 1
    v_permlane32_swap_b32 v15, v2
    s_nop 1
    v_max_f32 v15, v15, v2
    v_sub_f32 v15, 0, v15
    v_and_b32 v16, 0xffff0000, v15
    v_sub_f32 v17, v15, v16
    v_and_b32 v14, 0xffff0000, v17
    v_sub_f32 v17, v17, v14
    v_lshrrev_b32 v16, 16, v16
    v_or_b32 v16, v16, v14
    v_lshrrev_b32 v17, 16, v17
    v_or_b32 v17, 0x3f800000, v17
    v_cndmask_b32 v148, v16, v148, s[62:63]
    v_cndmask_b32 v149, v17, v149, s[62:63]
    v_mfma_f32_32x32x8_bf16 v[128:143], v[162:163], v[162:163], 0
    s_sub_u32 s50, s51, 163840
L_slow1:
    buffer_load_dwordx2 v[164:165], v3, s[20:23], s50 offen sc1
    buffer_load_dwordx2 v[166:167], v3, s[20:23], s50 offen offset:512 sc1
    s_mov_b64 exec, s[62:63]
    buffer_load_dwordx2 v[76:77], v3, s[20:23], s50 offen offset:1024 sc1
    s_mov_b64 exec, s[60:61]
    buffer_load_dwordx4 v[80:83], v4, s[20:23], s50 offen sc1
    buffer_load_dwordx4 v[84:87], v4, s[20:23], s50 offen offset:640 sc1
    s_mov_b64 exec, -1
    s_waitcnt vmcnt(0)
    v_mfma_f32_32x32x16_bf16 v[208:223], v[164:167], v[144:147], 0
    v_mfma_f32_32x32x8_bf16 v[208:223], v[76:77], v[148:149], v[208:223]
    s_nop 15
    v_exp_f32 v208, v208
    v_exp_f32 v209, v209
    v_exp_f32 v210, v210
    v_exp_f32 v211, v211
    v_exp_f32 v212, v212
    v_exp_f32 v213, v213
    v_exp_f32 v214, v214
    v_exp_f32 v215, v215
    v_exp_f32 v216, v216
    v_exp_f32 v217, v217
    v_exp_f32 v218, v218
    v_exp_f32 v219, v219
    v_exp_f32 v220, v220
    v_exp_f32 v221, v221
    v_exp_f32 v222, v222
    v_exp_f32 v223, v223
    s_nop 1
    v_smfmac_f32_32x32x32_bf16 v[128:143], v[80:83], v[208:215], v66
    v_smfmac_f32_32x32x32_bf16 v[128:143], v[84:87], v[216:223], v66
    s_add_u32 s50, s50, 2560
    s_cmp_lt_u32 s50, s51
    s_cbranch_scc1 L_slow1
    s_nop 15
    s_branch L_epiB
.section .rodata,"a"
.p2align 6
.amdhsa_kernel concat_heads__sliding_block__softmax_full_mha__prompt_kernel
  .amdhsa_next_free_vgpr 256
  .amdhsa_next_free_sgpr 72
  .amdhsa_accum_offset 256
  .amdhsa_group_segment_fixed_size 0
  .amdhsa_kernarg_size 72
  .amdhsa_user_sgpr_count 2
  .amdhsa_user_sgpr_kernarg_segment_ptr 1
  .amdhsa_system_sgpr_workgroup_id_x 1
.end_amdhsa_kernel
```
